```python
import torch

def _softmax(x, axis=-1):
    return torch.softmax(x, dim=axis)
def _gelu(x):
    return torch.nn.functional.gelu(x, approximate="tanh")
def _silu(x):
    return torch.nn.functional.silu(x)
def _sigmoid(x):
    return torch.sigmoid(x)
def _layernorm(x, axis=-1, eps=1e-5):
    m = x.mean(dim=axis, keepdim=True)
    v = x.var(dim=axis, keepdim=True, unbiased=False)
    return (x - m) / torch.sqrt(v + eps)
def _scatter_add(tgt, idx, src, axis=0):
    return tgt.clone().index_add_(axis, idx, src)
def _segment_sum(src, seg, n):
    out = torch.zeros((n,) + src.shape[1:], dtype=src.dtype)
    return out.index_add_(0, seg, src)
def _pad(x, pw):
    flat = tuple(v for pair in reversed(pw) for v in pair)
    return torch.nn.functional.pad(x, flat)

kernel_name = 'standalone__gqa_block_cached__near_ridge'

def setup_inputs():

    _w = (lambda a: (lambda t: t.to(torch.bfloat16) if t.is_floating_point() else t)(torch.as_tensor(a)))
    B, Sq, D = 16, 224, 512
    Hq, Hkv, Sk, Dh = 32, 32, 512, 128
    assert Hq % Hkv == 0, (Hq, Hkv)
    return {
        "x": _w((lambda *s: torch.randn(*s, dtype=torch.bfloat16) * 0.8)(B, Sq, D)),
        "k_cache": _w((lambda *s: torch.randn(*s, dtype=torch.bfloat16) * 0.8)(B, Hkv, Sk, Dh)),
        "v_cache": _w((lambda *s: torch.randn(*s, dtype=torch.bfloat16) * 0.05)(B, Hkv, Sk, Dh)),
        "wq": _w((lambda *s: torch.randn(*s, dtype=torch.bfloat16) * 0.8)(D, Hq * Dh) * (D ** -0.5)),
        "wo": _w((lambda *s: torch.randn(*s, dtype=torch.bfloat16) * 0.05)(Hq * Dh, D) * ((Hq * Dh) ** -0.5)),
    }

def reference(x, k_cache, v_cache, wq, wo):
    B, Sq, D = x.shape
    Hq, Dh = 32, 128
    Hkv = k_cache.shape[1]
    rep = Hq // Hkv
    q = (lambda x, *d: x.permute(*d))((x @ wq).reshape(B, Sq, Hq, Dh), 0, 2, 1, 3)
    k = (lambda x, n, axis: torch.repeat_interleave(x, n, dim=axis))(k_cache, rep, axis=1)
    v = (lambda x, n, axis: torch.repeat_interleave(x, n, dim=axis))(v_cache, rep, axis=1)
    scores = torch.einsum("bhqd,bhkd->bhqk", q, k) * (Dh ** -0.5)
    p = _softmax(scores, axis=-1)
    o = torch.einsum("bhqk,bhkd->bhqd", p, v)
    return (lambda x, *d: x.permute(*d))(o, 0, 2, 1, 3).reshape(B, Sq, Hq * Dh) @ wo
```

```asm
; @launch grid=(256,1,1) block=(256,1,1) lds=163840
.amdgcn_target "amdgcn-amd-amdhsa--gfx950"
.text
.globl standalone__gqa_block_cached__near_ridge_kernel
.p2align 8
.type standalone__gqa_block_cached__near_ridge_kernel,@function
standalone__gqa_block_cached__near_ridge_kernel:
  s_cmp_ge_u32 s2, 0x100
  s_cbranch_scc1 K1_END
  s_nop 0
  s_load_dwordx16 s[4:19], s[0:1], 0
  v_and_b32_e64 v255, 63, v0
  v_lshrrev_b32_e32 v248, 6, v0
  s_nop 0
  v_readfirstlane_b32 s44, v248
  s_getpc_b64 s[92:93]
PC0:
  s_sub_u32 s92, s92, PC0-standalone__gqa_block_cached__near_ridge_kernel
  s_subb_u32 s93, s93, 0
  s_lshr_b32 s54, s2, 3
  s_lshl_b32 s54, s54, 2
  s_add_u32 s54, s54, s44
  s_lshl_b32 s54, s54, 10
  s_nop 0
  s_min_u32 s54, s54, K1_END-standalone__gqa_block_cached__near_ridge_kernel-1024
  v_lshlrev_b32_e64 v248, 4, v255
  v_add_u32_e64 v248, s54, v248
  global_load_dwordx4 v[4:7], v248, s[92:93]
  v_lshrrev_b32_e64 v248, 4, v255
  v_sub_u32_e64 v248, 0, v248
  v_xor_b32_e64 v248, v248, v255
  v_and_b32_e64 v248, 3, v248
  v_lshlrev_b32_e64 v248, 4, v248
  v_lshrrev_b32_e64 v249, 2, v255
  v_lshl_add_u32 v227, v249, 10, v248
  v_lshrrev_b32_e64 v249, 5, v255
  v_lshlrev_b32_e64 v249, 6, v249
  v_and_b32_e64 v250, 3, v255
  v_lshl_add_u32 v251, v250, 4, v249
  v_bfe_u32 v248, v255, 4, 1
  v_lshl_add_u32 v249, v248, 16, v251
  v_bfe_u32 v248, v255, 2, 2
  v_lshl_add_u32 v229, v248, 13, v249
  s_and_b32 s45, s44, 1
  s_lshr_b32 s46, s44, 1
  s_and_b32 s54, s2, 7
  s_lshr_b32 s55, s2, 3
  s_lshr_b32 s47, s54, 1
  s_lshl_b32 s47, s47, 2
  s_lshr_b32 s66, s55, 3
  s_add_u32 s47, s47, s66
  s_and_b32 s3, s54, 1
  s_lshl_b32 s3, s3, 3
  s_and_b32 s66, s55, 7
  s_add_u32 s3, s3, s66
  s_lshl_b32 s63, s47, 1
  s_add_u32 s63, s63, s3
  s_lshl_b32 s63, s63, 7
  s_sub_u32 s63, s63, 64
  s_lshl_b32 s48, s3, 1
  s_add_u32 s48, s48, s46
  s_mul_i32 s49, s46, 0x14000
  s_lshl_b32 s53, s45, 12
  s_add_u32 s49, s49, s53
  s_lshl_b32 s50, s45, 15
  s_lshl_b32 s54, s48, 8
  s_add_u32 s50, s50, s54
  s_nop 0
  s_mul_i32 s51, s46, 0x1c000
  s_lshl_b32 s54, s45, 16
  s_add_u32 s51, s51, s54
  s_cmp_eq_u32 s45, 0
  s_nop 0
  s_cselect_b32 s52, s51, 0x7f000000
  s_mul_i32 s54, s47, 0x38000
  s_waitcnt lgkmcnt(0)
  s_add_u32 s20, s4, s54
  s_addc_u32 s21, s5, 0
  s_nop 0
  s_mov_b32 s22, 0x38000
  s_mov_b32 s23, 0x20000
  s_mov_b32 s32, s10
  s_mov_b32 s33, s11
  s_mov_b32 s34, 0x400000
  s_mov_b32 s35, 0x20000
  s_add_u32 m0, s49, 0x8000
  s_add_u32 s63, s63, 64
  s_nop 0
  s_and_b32 s63, s63, 0x3ff
  s_lshl_b32 s54, s63, 12
  s_add_u32 s54, s54, s50
  buffer_load_dwordx4 v229, s[32:35], s54 offen offset:0 lds
  s_add_u32 m0, s49, 0x8380
  s_add_u32 s68, s51, s63
  s_add_u32 s69, s52, s63
  buffer_load_dwordx4 v229, s[32:35], s54 offen offset:128 lds
  s_add_u32 m0, s49, 0x8800
  s_add_u32 s54, s54, 0x20000
  buffer_load_dwordx4 v229, s[32:35], s54 offen offset:0 lds
  s_add_u32 m0, s49, 0x8b80
  s_nop 0
  s_nop 0
  buffer_load_dwordx4 v229, s[32:35], s54 offen offset:128 lds
  s_add_u32 m0, s49, 0xa000
  s_add_u32 s55, s68, 0
  s_nop 0
  buffer_load_dwordx4 v227, s[20:23], s55 offen offset:0 lds
  s_add_u32 s55, s68, 0x3c00
  buffer_load_dwordx4 v227, s[20:23], s55 offen offset:1024 lds
  s_add_u32 s55, s68, 0x7800
  buffer_load_dwordx4 v227, s[20:23], s55 offen offset:2048 lds
  s_add_u32 s55, s69, 0xb400
  buffer_load_dwordx4 v227, s[20:23], s55 offen offset:3072 lds
  v_bfe_u32 v248, v255, 2, 3
  v_bfe_u32 v249, v255, 1, 1
  v_bfe_u32 v250, v255, 4, 1
  v_xor_b32_e64 v249, v249, v250
  v_lshrrev_b32_e64 v250, 5, v255
  v_lshl_add_u32 v249, v250, 1, v249
  s_lshr_b32 s54, s3, 2
  v_add_u32_e32 v249, s54, v249
  v_and_b32_e64 v249, 3, v249
  v_lshlrev_b32_e64 v249, 5, v249
  v_and_b32_e64 v250, 1, v255
  v_lshl_add_u32 v249, v250, 4, v249
  v_lshl_add_u32 v254, v248, 10, v249
  s_lshl_b32 s54, s46, 7
  v_add_u32_e32 v254, s54, v254
  v_lshl_add_u32 v228, v248, 8, v251
  v_bfe_u32 v250, v255, 4, 1
  v_lshlrev_b32_e64 v250, 5, v250
  v_xor_b32_e64 v228, v228, v250
  v_bfe_u32 v248, v255, 2, 2
  v_sub_u32_e64 v248, 0, v248
  v_lshrrev_b32_e64 v249, 4, v255
  v_xor_b32_e64 v248, v248, v249
  v_and_b32_e64 v248, 3, v248
  v_lshlrev_b32_e64 v248, 4, v248
  v_and_b32_e64 v250, 15, v255
  v_lshl_add_u32 v232, v250, 6, v248
  v_lshrrev_b32_e64 v248, 5, v255
  v_lshlrev_b32_e64 v248, 11, v248
  v_bfe_u32 v249, v255, 4, 1
  v_lshl_add_u32 v248, v249, 8, v248
  v_bfe_u32 v250, v255, 2, 2
  v_lshl_add_u32 v248, v250, 6, v248
  v_and_b32_e64 v250, 3, v255
  v_lshl_add_u32 v225, v250, 4, v248
  v_lshl_add_u32 v248, v250, 3, v248
  v_lshl_add_u32 v247, v249, 5, v248
  v_lshrrev_b32_e64 v248, 3, v255
  v_and_b32_e64 v249, 6, v248
  v_and_b32_e64 v250, 7, v255
  v_xor_b32_e64 v249, v249, v250
  v_lshlrev_b32_e64 v249, 4, v249
  v_lshl_add_u32 v226, v248, 8, v249
  v_and_b32_e64 v248, 6, v255
  v_lshrrev_b32_e64 v249, 4, v255
  v_xor_b32_e64 v248, v248, v249
  v_lshlrev_b32_e64 v248, 4, v248
  v_and_b32_e64 v249, 7, v255
  v_lshl_add_u32 v248, v249, 7, v248
  v_bfe_u32 v249, v255, 3, 1
  v_lshl_add_u32 v233, v249, 11, v248
  v_lshlrev_b32_e64 v234, 4, v255
  v_add_u32_e64 v224, s49, v234
  s_mul_i32 s54, s45, 0x14000
  s_add_u32 s54, s54, 0x2000
  v_add_u32_e64 v232, s54, v232
  s_mul_i32 s54, s46, 0x14000
  v_add_u32_e64 v225, s54, v225
  v_add_u32_e64 v247, s54, v247
  s_add_u32 s55, s54, 0xc000
  v_add_u32_e64 v233, s55, v233
  v_xor_b32_e64 v235, 64, v233
  v_add_u32_e32 v230, 0xe000, v247
  v_xor_b32_e32 v231, 32, v230
  s_lshl_b32 s54, s47, 5
  s_add_u32 s54, s54, s48
  s_lshl_b32 s54, s54, 17
  s_add_u32 s24, s6, s54
  s_addc_u32 s25, s7, 0
  s_mov_b32 s26, 0x20000
  s_mov_b32 s27, 0x20000
  s_add_u32 s28, s8, s54
  s_addc_u32 s29, s9, 0
  s_mov_b32 s30, 0x20000
  s_mov_b32 s31, 0x20000
  s_mov_b32 s36, s12
  s_mov_b32 s37, s13
  s_mov_b32 s38, 0x400000
  s_mov_b32 s39, 0x20000
  s_mov_b32 s40, s18
  s_mov_b32 s41, s19
  s_mov_b32 s42, 0x3204000
  s_mov_b32 s43, 0x20000
  s_add_u32 s54, s48, 0
  s_and_b32 s54, s54, 7
  s_and_b32 s55, s48, 24
  s_or_b32 s54, s54, s55
  s_lshl_b32 s55, s47, 5
  s_add_u32 s55, s55, s54
  s_lshl_b32 s55, s55, 1
  s_add_u32 s55, s55, s45
  s_mul_i32 s62, s55, 0x7000
  s_lshl_b32 s54, s54, 17
  s_lshl_b32 s55, s45, 14
  s_add_u32 s54, s54, s55
  s_and_b32 s55, s3, 3
  s_lshl_b32 s55, s55, 8
  s_add_u32 s4, s54, s55
  s_add_u32 s54, s48, 2
  s_and_b32 s54, s54, 7
  s_and_b32 s55, s48, 24
  s_or_b32 s54, s54, s55
  s_lshl_b32 s55, s47, 5
  s_add_u32 s55, s55, s54
  s_lshl_b32 s55, s55, 1
  s_add_u32 s55, s55, s45
  s_mul_i32 s8, s55, 0x7000
  s_lshl_b32 s54, s54, 17
  s_lshl_b32 s55, s45, 14
  s_add_u32 s54, s54, s55
  s_and_b32 s55, s3, 3
  s_lshl_b32 s55, s55, 8
  s_add_u32 s5, s54, s55
  s_add_u32 s54, s48, 4
  s_and_b32 s54, s54, 7
  s_and_b32 s55, s48, 24
  s_or_b32 s54, s54, s55
  s_lshl_b32 s55, s47, 5
  s_add_u32 s55, s55, s54
  s_lshl_b32 s55, s55, 1
  s_add_u32 s55, s55, s45
  s_mul_i32 s9, s55, 0x7000
  s_lshl_b32 s54, s54, 17
  s_lshl_b32 s55, s45, 14
  s_add_u32 s54, s54, s55
  s_and_b32 s55, s3, 3
  s_lshl_b32 s55, s55, 8
  s_add_u32 s6, s54, s55
  s_add_u32 s54, s48, 6
  s_and_b32 s54, s54, 7
  s_and_b32 s55, s48, 24
  s_or_b32 s54, s54, s55
  s_lshl_b32 s55, s47, 5
  s_add_u32 s55, s55, s54
  s_lshl_b32 s55, s55, 1
  s_add_u32 s55, s55, s45
  s_mul_i32 s10, s55, 0x7000
  s_lshl_b32 s54, s54, 17
  s_lshl_b32 s55, s45, 14
  s_add_u32 s54, s54, s55
  s_and_b32 s55, s3, 3
  s_lshl_b32 s55, s55, 8
  s_add_u32 s7, s54, s55
  s_lshl_b32 s54, s47, 2
  s_lshr_b32 s55, s3, 2
  s_add_u32 s55, s55, s54
  s_lshl_b32 s55, s55, 7
  s_add_u32 s90, s55, 0x3200000
  s_and_b32 s55, s3, 3
  s_add_u32 s55, s55, s54
  s_lshl_b32 s55, s55, 7
  s_nop 0
  s_add_u32 s91, s55, 0x3202000
  v_mov_b32_e32 v240, 0
  s_and_b32 s67, s3, 3
  s_lshl_b32 s67, s67, 2
  s_add_u32 s67, s67, s90
  buffer_store_dword v240, off, s[40:43], s67 sc1
  s_lshr_b32 s67, s3, 2
  s_lshl_b32 s67, s67, 2
  s_add_u32 s67, s67, s91
  s_nop 0
  buffer_store_dword v240, off, s[40:43], s67 sc1
  v_mov_b32_e64 v241, 0
  v_mov_b32_e64 v242, 0
  v_mov_b32_e64 v243, 0
  v_mov_b32_e64 v244, 0
  v_mov_b32_e64 v245, 0
  v_mov_b32_e64 v246, 0
  v_mov_b32_e32 v236, 0x3f803f80
  v_mov_b32_e32 v237, 0x3f803f80
  v_mov_b32_e32 v238, 0x3f803f80
  v_mov_b32_e32 v239, 0x3f803f80
  s_mov_b32 s64, 0x3e0293ee
  s_mov_b32 s65, 0x3e0293ee
  s_mov_b32 s61, 0x45800000
  s_mov_b32 s56, 0xc000
  s_sub_u32 s11, s49, 0x100
  s_add_u32 m0, s49, 0
  s_add_u32 s63, s63, 64
  s_and_b32 s63, s63, 0x3ff
  s_lshl_b32 s54, s63, 12
  s_add_u32 s54, s54, s50
  buffer_load_dwordx4 v229, s[32:35], s54 offen offset:0 lds
  s_add_u32 m0, s49, 0x380
  s_add_u32 s68, s51, s63
  s_add_u32 s69, s52, s63
  buffer_load_dwordx4 v229, s[32:35], s54 offen offset:128 lds
  s_add_u32 m0, s49, 0x800
  s_add_u32 s54, s54, 0x20000
  buffer_load_dwordx4 v229, s[32:35], s54 offen offset:0 lds
  s_add_u32 m0, s49, 0xb80
  s_nop 0
  s_nop 0
  buffer_load_dwordx4 v229, s[32:35], s54 offen offset:128 lds
  s_add_u32 m0, s49, 0x2000
  s_add_u32 s55, s68, 0
  s_nop 0
  buffer_load_dwordx4 v227, s[20:23], s55 offen offset:0 lds
  s_add_u32 s55, s68, 0x3c00
  buffer_load_dwordx4 v227, s[20:23], s55 offen offset:1024 lds
  s_add_u32 s55, s68, 0x7800
  buffer_load_dwordx4 v227, s[20:23], s55 offen offset:2048 lds
  s_add_u32 s55, s69, 0xb400
  buffer_load_dwordx4 v227, s[20:23], s55 offen offset:3072 lds
  s_waitcnt vmcnt(10)
  s_barrier
  ds_read_b128 a[0:3], v232 offset:32768
  ds_read_b64_tr_b16 a[56:57], v225 offset:32768
  ds_read_b64_tr_b16 a[58:59], v225 offset:36864
  ds_read_b64_tr_b16 a[60:61], v225 offset:32776
  ds_read_b64_tr_b16 a[62:63], v225 offset:36872
  ds_read_b64_tr_b16 a[64:65], v225 offset:33280
  ds_read_b64_tr_b16 a[66:67], v225 offset:37376
  ds_read_b64_tr_b16 a[68:69], v225 offset:33288
  ds_read_b64_tr_b16 a[70:71], v225 offset:37384
  ds_read_b64_tr_b16 a[72:73], v225 offset:33792
  ds_read_b64_tr_b16 a[74:75], v225 offset:37888
  ds_read_b64_tr_b16 a[76:77], v225 offset:33800
  ds_read_b64_tr_b16 a[78:79], v225 offset:37896
  ds_read_b64_tr_b16 a[80:81], v225 offset:34304
  ds_read_b64_tr_b16 a[82:83], v225 offset:38400
  ds_read_b64_tr_b16 a[84:85], v225 offset:34312
  ds_read_b64_tr_b16 a[86:87], v225 offset:38408
  ds_read_b128 a[4:7], v232 offset:33792
  ds_read_b128 a[8:11], v232 offset:34816
  ds_read_b128 a[12:15], v232 offset:35840
  ds_read_b128 a[16:19], v232 offset:36864
  ds_read_b128 a[20:23], v232 offset:37888
  ds_read_b128 a[24:27], v232 offset:38912
  s_waitcnt lgkmcnt(0)
  s_nop 0
  v_mfma_f32_16x16x32_bf16 v[0:3], a[56:59], a[0:3], 0
  s_waitcnt vmcnt(0)
  s_nop 0
  v_mfma_f32_16x16x32_bf16 v[4:7], a[60:63], a[0:3], 0
  s_barrier
  s_nop 0
  v_mfma_f32_16x16x32_bf16 v[8:11], a[64:67], a[0:3], 0
  s_add_u32 m0, s49, 0x4000
  s_add_u32 s63, s63, 64
  s_nop 0
  s_and_b32 s63, s63, 0x3ff
  s_lshl_b32 s54, s63, 12
  s_add_u32 s54, s54, s50
  ds_read_b128 a[28:31], v232 offset:0
  v_mfma_f32_16x16x32_bf16 v[12:15], a[68:71], a[0:3], 0
  buffer_load_dwordx4 v229, s[32:35], s54 offen offset:0 lds
  v_mfma_f32_16x16x32_bf16 v[16:19], a[72:75], a[0:3], 0
  s_add_u32 m0, s49, 0x4380
  s_add_u32 s68, s51, s63
  s_nop 0
  ds_read_b64_tr_b16 a[88:89], v225 offset:0
  v_mfma_f32_16x16x32_bf16 v[20:23], a[76:79], a[0:3], 0
  s_add_u32 s69, s52, s63
  s_nop 0
  ds_read_b64_tr_b16 a[90:91], v225 offset:4096
  v_mfma_f32_16x16x32_bf16 v[24:27], a[80:83], a[0:3], 0
  buffer_load_dwordx4 v229, s[32:35], s54 offen offset:128 lds
  v_mfma_f32_16x16x32_bf16 v[28:31], a[84:87], a[0:3], 0
  s_add_u32 m0, s49, 0x4800
  ds_read_b64_tr_b16 a[92:93], v225 offset:8
  v_mfma_f32_16x16x32_bf16 v[32:35], a[56:59], a[4:7], 0
  s_add_u32 s54, s54, 0x20000
  ds_read_b64_tr_b16 a[94:95], v225 offset:4104
  v_mfma_f32_16x16x32_bf16 v[36:39], a[60:63], a[4:7], 0
  buffer_load_dwordx4 v229, s[32:35], s54 offen offset:0 lds
  v_mfma_f32_16x16x32_bf16 v[40:43], a[64:67], a[4:7], 0
  ds_read_b64_tr_b16 a[96:97], v225 offset:512
  v_mfma_f32_16x16x32_bf16 v[44:47], a[68:71], a[4:7], 0
  s_add_u32 m0, s49, 0x4b80
  ds_read_b64_tr_b16 a[98:99], v225 offset:4608
  v_mfma_f32_16x16x32_bf16 v[48:51], a[72:75], a[4:7], 0
  buffer_load_dwordx4 v229, s[32:35], s54 offen offset:128 lds
  v_mfma_f32_16x16x32_bf16 v[52:55], a[76:79], a[4:7], 0
  s_add_u32 m0, s49, 0x6000
  ds_read_b64_tr_b16 a[100:101], v225 offset:520
  v_mfma_f32_16x16x32_bf16 v[56:59], a[80:83], a[4:7], 0
  s_add_u32 s55, s68, 0
  s_nop 0
  ds_read_b64_tr_b16 a[102:103], v225 offset:4616
  v_mfma_f32_16x16x32_bf16 v[60:63], a[84:87], a[4:7], 0
  buffer_load_dwordx4 v227, s[20:23], s55 offen offset:0 lds
  v_mfma_f32_16x16x32_bf16 v[64:67], a[56:59], a[8:11], 0
  ds_read_b64_tr_b16 a[104:105], v225 offset:1024
  v_mfma_f32_16x16x32_bf16 v[68:71], a[60:63], a[8:11], 0
  s_add_u32 s55, s68, 0x3c00
  ds_read_b64_tr_b16 a[106:107], v225 offset:5120
  v_mfma_f32_16x16x32_bf16 v[72:75], a[64:67], a[8:11], 0
  buffer_load_dwordx4 v227, s[20:23], s55 offen offset:1024 lds
  v_mfma_f32_16x16x32_bf16 v[76:79], a[68:71], a[8:11], 0
  ds_read_b64_tr_b16 a[108:109], v225 offset:1032
  v_mfma_f32_16x16x32_bf16 v[80:83], a[72:75], a[8:11], 0
  s_add_u32 s55, s68, 0x7800
  ds_read_b64_tr_b16 a[110:111], v225 offset:5128
  v_mfma_f32_16x16x32_bf16 v[84:87], a[76:79], a[8:11], 0
  buffer_load_dwordx4 v227, s[20:23], s55 offen offset:2048 lds
  v_mfma_f32_16x16x32_bf16 v[88:91], a[80:83], a[8:11], 0
  ds_read_b64_tr_b16 a[112:113], v225 offset:1536
  v_mfma_f32_16x16x32_bf16 v[92:95], a[84:87], a[8:11], 0
  s_add_u32 s55, s69, 0xb400
  ds_read_b64_tr_b16 a[114:115], v225 offset:5632
  v_mfma_f32_16x16x32_bf16 v[96:99], a[56:59], a[12:15], 0
  buffer_load_dwordx4 v227, s[20:23], s55 offen offset:3072 lds
  v_mfma_f32_16x16x32_bf16 v[100:103], a[60:63], a[12:15], 0
  s_add_u32 m0, s49, 0x8000
  s_add_u32 s63, s63, 64
  s_nop 0
  s_and_b32 s63, s63, 0x3ff
  s_lshl_b32 s54, s63, 12
  s_nop 0
  ds_read_b64_tr_b16 a[116:117], v225 offset:1544
  v_mfma_f32_16x16x32_bf16 v[104:107], a[64:67], a[12:15], 0
  s_add_u32 s54, s54, s50
  s_nop 0
  ds_read_b64_tr_b16 a[118:119], v225 offset:5640
  v_mfma_f32_16x16x32_bf16 v[108:111], a[68:71], a[12:15], 0
  buffer_load_dwordx4 v229, s[32:35], s54 offen offset:0 lds
  v_mfma_f32_16x16x32_bf16 v[112:115], a[72:75], a[12:15], 0
  s_add_u32 m0, s49, 0x8380
  s_add_u32 s68, s51, s63
  s_nop 0
  ds_read_b128 a[32:35], v232 offset:1024
  v_mfma_f32_16x16x32_bf16 v[116:119], a[76:79], a[12:15], 0
  s_add_u32 s69, s52, s63
  s_nop 0
  ds_read_b128 a[36:39], v232 offset:2048
  v_mfma_f32_16x16x32_bf16 v[120:123], a[80:83], a[12:15], 0
  buffer_load_dwordx4 v229, s[32:35], s54 offen offset:128 lds
  v_mfma_f32_16x16x32_bf16 v[124:127], a[84:87], a[12:15], 0
  s_add_u32 m0, s49, 0x8800
  ds_read_b128 a[40:43], v232 offset:3072
  v_mfma_f32_16x16x32_bf16 v[128:131], a[56:59], a[16:19], 0
  s_add_u32 s54, s54, 0x20000
  ds_read_b128 a[44:47], v232 offset:4096
  v_mfma_f32_16x16x32_bf16 v[132:135], a[60:63], a[16:19], 0
  buffer_load_dwordx4 v229, s[32:35], s54 offen offset:0 lds
  v_mfma_f32_16x16x32_bf16 v[136:139], a[64:67], a[16:19], 0
  ds_read_b128 a[48:51], v232 offset:5120
  v_mfma_f32_16x16x32_bf16 v[140:143], a[68:71], a[16:19], 0
  s_add_u32 m0, s49, 0x8b80
  ds_read_b128 a[52:55], v232 offset:6144
  v_mfma_f32_16x16x32_bf16 v[144:147], a[72:75], a[16:19], 0
  buffer_load_dwordx4 v229, s[32:35], s54 offen offset:128 lds
  v_mfma_f32_16x16x32_bf16 v[148:151], a[76:79], a[16:19], 0
  s_add_u32 m0, s49, 0xa000
  v_mfma_f32_16x16x32_bf16 v[152:155], a[80:83], a[16:19], 0
  s_add_u32 s55, s68, 0
  s_nop 0
  v_mfma_f32_16x16x32_bf16 v[156:159], a[84:87], a[16:19], 0
  buffer_load_dwordx4 v227, s[20:23], s55 offen offset:0 lds
  v_mfma_f32_16x16x32_bf16 v[160:163], a[56:59], a[20:23], 0
  v_mfma_f32_16x16x32_bf16 v[164:167], a[60:63], a[20:23], 0
  s_add_u32 s55, s68, 0x3c00
  v_mfma_f32_16x16x32_bf16 v[168:171], a[64:67], a[20:23], 0
  buffer_load_dwordx4 v227, s[20:23], s55 offen offset:1024 lds
  v_mfma_f32_16x16x32_bf16 v[172:175], a[68:71], a[20:23], 0
  v_mfma_f32_16x16x32_bf16 v[176:179], a[72:75], a[20:23], 0
  s_add_u32 s55, s68, 0x7800
  v_mfma_f32_16x16x32_bf16 v[180:183], a[76:79], a[20:23], 0
  buffer_load_dwordx4 v227, s[20:23], s55 offen offset:2048 lds
  v_mfma_f32_16x16x32_bf16 v[184:187], a[80:83], a[20:23], 0
  v_mfma_f32_16x16x32_bf16 v[188:191], a[84:87], a[20:23], 0
  s_add_u32 s55, s69, 0xb400
  v_mfma_f32_16x16x32_bf16 v[192:195], a[56:59], a[24:27], 0
  buffer_load_dwordx4 v227, s[20:23], s55 offen offset:3072 lds
  v_mfma_f32_16x16x32_bf16 v[196:199], a[60:63], a[24:27], 0
  v_mfma_f32_16x16x32_bf16 v[200:203], a[64:67], a[24:27], 0
  v_mfma_f32_16x16x32_bf16 v[204:207], a[68:71], a[24:27], 0
  v_mfma_f32_16x16x32_bf16 v[208:211], a[72:75], a[24:27], 0
  v_mfma_f32_16x16x32_bf16 v[212:215], a[76:79], a[24:27], 0
  v_mfma_f32_16x16x32_bf16 v[216:219], a[80:83], a[24:27], 0
  v_mfma_f32_16x16x32_bf16 v[220:223], a[84:87], a[24:27], 0
  s_waitcnt lgkmcnt(0)
  s_nop 0
  v_mfma_f32_16x16x32_bf16 v[0:3], a[88:91], a[28:31], v[0:3]
  s_waitcnt vmcnt(8)
  s_nop 0
  v_mfma_f32_16x16x32_bf16 v[4:7], a[92:95], a[28:31], v[4:7]
  s_barrier
  s_nop 0
  v_mfma_f32_16x16x32_bf16 v[8:11], a[96:99], a[28:31], v[8:11]
  s_add_u32 m0, s49, 0
  s_add_u32 s63, s63, 64
  s_and_b32 s63, s63, 0x3ff
  s_lshl_b32 s54, s63, 12
  s_add_u32 s54, s54, s50
  ds_read_b128 a[0:3], v232 offset:16384
  v_mfma_f32_16x16x32_bf16 v[12:15], a[100:103], a[28:31], v[12:15]
  buffer_load_dwordx4 v229, s[32:35], s54 offen offset:0 lds
  v_mfma_f32_16x16x32_bf16 v[16:19], a[104:107], a[28:31], v[16:19]
  ds_read_b64_tr_b16 a[56:57], v225 offset:16384
  v_mfma_f32_16x16x32_bf16 v[20:23], a[108:111], a[28:31], v[20:23]
  s_add_u32 m0, s49, 0x380
  ds_read_b64_tr_b16 a[58:59], v225 offset:20480
  v_mfma_f32_16x16x32_bf16 v[24:27], a[112:115], a[28:31], v[24:27]
  s_add_u32 s68, s51, s63
  s_nop 0
  ds_read_b64_tr_b16 a[60:61], v225 offset:16392
  v_mfma_f32_16x16x32_bf16 v[28:31], a[116:119], a[28:31], v[28:31]
  s_add_u32 s69, s52, s63
  s_nop 0
  ds_read_b64_tr_b16 a[62:63], v225 offset:20488
  v_mfma_f32_16x16x32_bf16 v[32:35], a[88:91], a[32:35], v[32:35]
  buffer_load_dwordx4 v229, s[32:35], s54 offen offset:128 lds
  v_mfma_f32_16x16x32_bf16 v[36:39], a[92:95], a[32:35], v[36:39]
  ds_read_b64_tr_b16 a[64:65], v225 offset:16896
  v_mfma_f32_16x16x32_bf16 v[40:43], a[96:99], a[32:35], v[40:43]
  ds_read_b64_tr_b16 a[66:67], v225 offset:20992
  v_mfma_f32_16x16x32_bf16 v[44:47], a[100:103], a[32:35], v[44:47]
  s_add_u32 m0, s49, 0x800
  ds_read_b64_tr_b16 a[68:69], v225 offset:16904
  v_mfma_f32_16x16x32_bf16 v[48:51], a[104:107], a[32:35], v[48:51]
  s_add_u32 s54, s54, 0x20000
  ds_read_b64_tr_b16 a[70:71], v225 offset:21000
  v_mfma_f32_16x16x32_bf16 v[52:55], a[108:111], a[32:35], v[52:55]
  buffer_load_dwordx4 v229, s[32:35], s54 offen offset:0 lds
  v_mfma_f32_16x16x32_bf16 v[56:59], a[112:115], a[32:35], v[56:59]
  ds_read_b64_tr_b16 a[72:73], v225 offset:17408
  v_mfma_f32_16x16x32_bf16 v[60:63], a[116:119], a[32:35], v[60:63]
  ds_read_b64_tr_b16 a[74:75], v225 offset:21504
  v_mfma_f32_16x16x32_bf16 v[64:67], a[88:91], a[36:39], v[64:67]
  ds_read_b64_tr_b16 a[76:77], v225 offset:17416
  v_mfma_f32_16x16x32_bf16 v[68:71], a[92:95], a[36:39], v[68:71]
  s_add_u32 m0, s49, 0xb80
  ds_read_b64_tr_b16 a[78:79], v225 offset:21512
  v_mfma_f32_16x16x32_bf16 v[72:75], a[96:99], a[36:39], v[72:75]
  buffer_load_dwordx4 v229, s[32:35], s54 offen offset:128 lds
  v_mfma_f32_16x16x32_bf16 v[76:79], a[100:103], a[36:39], v[76:79]
  ds_read_b64_tr_b16 a[80:81], v225 offset:17920
  v_mfma_f32_16x16x32_bf16 v[80:83], a[104:107], a[36:39], v[80:83]
  ds_read_b64_tr_b16 a[82:83], v225 offset:22016
  v_mfma_f32_16x16x32_bf16 v[84:87], a[108:111], a[36:39], v[84:87]
  s_add_u32 m0, s49, 0x2000
  ds_read_b64_tr_b16 a[84:85], v225 offset:17928
  v_mfma_f32_16x16x32_bf16 v[88:91], a[112:115], a[36:39], v[88:91]
  s_add_u32 s55, s68, 0
  s_nop 0
  ds_read_b64_tr_b16 a[86:87], v225 offset:22024
  v_mfma_f32_16x16x32_bf16 v[92:95], a[116:119], a[36:39], v[92:95]
  buffer_load_dwordx4 v227, s[20:23], s55 offen offset:0 lds
  v_mfma_f32_16x16x32_bf16 v[96:99], a[88:91], a[40:43], v[96:99]
  ds_read_b128 a[4:7], v232 offset:17408
  v_mfma_f32_16x16x32_bf16 v[100:103], a[92:95], a[40:43], v[100:103]
  ds_read_b128 a[8:11], v232 offset:18432
  v_mfma_f32_16x16x32_bf16 v[104:107], a[96:99], a[40:43], v[104:107]
  ds_read_b128 a[12:15], v232 offset:19456
  v_mfma_f32_16x16x32_bf16 v[108:111], a[100:103], a[40:43], v[108:111]
  s_add_u32 s55, s68, 0x3c00
  ds_read_b128 a[16:19], v232 offset:20480
  v_mfma_f32_16x16x32_bf16 v[112:115], a[104:107], a[40:43], v[112:115]
  buffer_load_dwordx4 v227, s[20:23], s55 offen offset:1024 lds
  v_mfma_f32_16x16x32_bf16 v[116:119], a[108:111], a[40:43], v[116:119]
  ds_read_b128 a[20:23], v232 offset:21504
  v_mfma_f32_16x16x32_bf16 v[120:123], a[112:115], a[40:43], v[120:123]
  ds_read_b128 a[24:27], v232 offset:22528
  v_mfma_f32_16x16x32_bf16 v[124:127], a[116:119], a[40:43], v[124:127]
  v_mfma_f32_16x16x32_bf16 v[128:131], a[88:91], a[44:47], v[128:131]
  s_add_u32 s55, s68, 0x7800
  v_mfma_f32_16x16x32_bf16 v[132:135], a[92:95], a[44:47], v[132:135]
  buffer_load_dwordx4 v227, s[20:23], s55 offen offset:2048 lds
  v_mfma_f32_16x16x32_bf16 v[136:139], a[96:99], a[44:47], v[136:139]
  v_mfma_f32_16x16x32_bf16 v[140:143], a[100:103], a[44:47], v[140:143]
  v_mfma_f32_16x16x32_bf16 v[144:147], a[104:107], a[44:47], v[144:147]
  v_mfma_f32_16x16x32_bf16 v[148:151], a[108:111], a[44:47], v[148:151]
  s_add_u32 s55, s69, 0xb400
  v_mfma_f32_16x16x32_bf16 v[152:155], a[112:115], a[44:47], v[152:155]
  buffer_load_dwordx4 v227, s[20:23], s55 offen offset:3072 lds
  v_mfma_f32_16x16x32_bf16 v[156:159], a[116:119], a[44:47], v[156:159]
  v_mfma_f32_16x16x32_bf16 v[160:163], a[88:91], a[48:51], v[160:163]
  v_mfma_f32_16x16x32_bf16 v[164:167], a[92:95], a[48:51], v[164:167]
  v_mfma_f32_16x16x32_bf16 v[168:171], a[96:99], a[48:51], v[168:171]
  v_mfma_f32_16x16x32_bf16 v[172:175], a[100:103], a[48:51], v[172:175]
  v_mfma_f32_16x16x32_bf16 v[176:179], a[104:107], a[48:51], v[176:179]
  v_mfma_f32_16x16x32_bf16 v[180:183], a[108:111], a[48:51], v[180:183]
  v_mfma_f32_16x16x32_bf16 v[184:187], a[112:115], a[48:51], v[184:187]
  v_mfma_f32_16x16x32_bf16 v[188:191], a[116:119], a[48:51], v[188:191]
  v_mfma_f32_16x16x32_bf16 v[192:195], a[88:91], a[52:55], v[192:195]
  v_mfma_f32_16x16x32_bf16 v[196:199], a[92:95], a[52:55], v[196:199]
  v_mfma_f32_16x16x32_bf16 v[200:203], a[96:99], a[52:55], v[200:203]
  v_mfma_f32_16x16x32_bf16 v[204:207], a[100:103], a[52:55], v[204:207]
  v_mfma_f32_16x16x32_bf16 v[208:211], a[104:107], a[52:55], v[208:211]
  v_mfma_f32_16x16x32_bf16 v[212:215], a[108:111], a[52:55], v[212:215]
  v_mfma_f32_16x16x32_bf16 v[216:219], a[112:115], a[52:55], v[216:219]
  v_mfma_f32_16x16x32_bf16 v[220:223], a[116:119], a[52:55], v[220:223]
  s_waitcnt lgkmcnt(0)
  s_nop 0
  v_mfma_f32_16x16x32_bf16 v[0:3], a[56:59], a[0:3], v[0:3]
  s_waitcnt vmcnt(8)
  s_nop 0
  v_mfma_f32_16x16x32_bf16 v[4:7], a[60:63], a[0:3], v[4:7]
  s_barrier
  s_nop 0
  v_mfma_f32_16x16x32_bf16 v[8:11], a[64:67], a[0:3], v[8:11]
  s_add_u32 m0, s49, 0x4000
  s_add_u32 s63, s63, 64
  s_nop 0
  s_and_b32 s63, s63, 0x3ff
  s_lshl_b32 s54, s63, 12
  s_add_u32 s54, s54, s50
  ds_read_b128 a[28:31], v232 offset:32768
  v_mfma_f32_16x16x32_bf16 v[12:15], a[68:71], a[0:3], v[12:15]
  buffer_load_dwordx4 v229, s[32:35], s54 offen offset:0 lds
  v_mfma_f32_16x16x32_bf16 v[16:19], a[72:75], a[0:3], v[16:19]
  ds_read_b64_tr_b16 a[88:89], v225 offset:32768
  v_mfma_f32_16x16x32_bf16 v[20:23], a[76:79], a[0:3], v[20:23]
  s_add_u32 m0, s49, 0x4380
  ds_read_b64_tr_b16 a[90:91], v225 offset:36864
  v_mfma_f32_16x16x32_bf16 v[24:27], a[80:83], a[0:3], v[24:27]
  s_add_u32 s68, s51, s63
  s_nop 0
  ds_read_b64_tr_b16 a[92:93], v225 offset:32776
  v_mfma_f32_16x16x32_bf16 v[28:31], a[84:87], a[0:3], v[28:31]
  s_add_u32 s69, s52, s63
  s_nop 0
  ds_read_b64_tr_b16 a[94:95], v225 offset:36872
  v_mfma_f32_16x16x32_bf16 v[32:35], a[56:59], a[4:7], v[32:35]
  buffer_load_dwordx4 v229, s[32:35], s54 offen offset:128 lds
  v_mfma_f32_16x16x32_bf16 v[36:39], a[60:63], a[4:7], v[36:39]
  ds_read_b64_tr_b16 a[96:97], v225 offset:33280
  v_mfma_f32_16x16x32_bf16 v[40:43], a[64:67], a[4:7], v[40:43]
  ds_read_b64_tr_b16 a[98:99], v225 offset:37376
  v_mfma_f32_16x16x32_bf16 v[44:47], a[68:71], a[4:7], v[44:47]
  s_add_u32 m0, s49, 0x4800
  ds_read_b64_tr_b16 a[100:101], v225 offset:33288
  v_mfma_f32_16x16x32_bf16 v[48:51], a[72:75], a[4:7], v[48:51]
  s_add_u32 s54, s54, 0x20000
  ds_read_b64_tr_b16 a[102:103], v225 offset:37384
  v_mfma_f32_16x16x32_bf16 v[52:55], a[76:79], a[4:7], v[52:55]
  buffer_load_dwordx4 v229, s[32:35], s54 offen offset:0 lds
  v_mfma_f32_16x16x32_bf16 v[56:59], a[80:83], a[4:7], v[56:59]
  ds_read_b64_tr_b16 a[104:105], v225 offset:33792
  v_mfma_f32_16x16x32_bf16 v[60:63], a[84:87], a[4:7], v[60:63]
  ds_read_b64_tr_b16 a[106:107], v225 offset:37888
  v_mfma_f32_16x16x32_bf16 v[64:67], a[56:59], a[8:11], v[64:67]
  ds_read_b64_tr_b16 a[108:109], v225 offset:33800
  v_mfma_f32_16x16x32_bf16 v[68:71], a[60:63], a[8:11], v[68:71]
  s_add_u32 m0, s49, 0x4b80
  ds_read_b64_tr_b16 a[110:111], v225 offset:37896
  v_mfma_f32_16x16x32_bf16 v[72:75], a[64:67], a[8:11], v[72:75]
  buffer_load_dwordx4 v229, s[32:35], s54 offen offset:128 lds
  v_mfma_f32_16x16x32_bf16 v[76:79], a[68:71], a[8:11], v[76:79]
  ds_read_b64_tr_b16 a[112:113], v225 offset:34304
  v_mfma_f32_16x16x32_bf16 v[80:83], a[72:75], a[8:11], v[80:83]
  ds_read_b64_tr_b16 a[114:115], v225 offset:38400
  v_mfma_f32_16x16x32_bf16 v[84:87], a[76:79], a[8:11], v[84:87]
  s_add_u32 m0, s49, 0x6000
  ds_read_b64_tr_b16 a[116:117], v225 offset:34312
  v_mfma_f32_16x16x32_bf16 v[88:91], a[80:83], a[8:11], v[88:91]
  s_add_u32 s55, s68, 0
  s_nop 0
  ds_read_b64_tr_b16 a[118:119], v225 offset:38408
  v_mfma_f32_16x16x32_bf16 v[92:95], a[84:87], a[8:11], v[92:95]
  buffer_load_dwordx4 v227, s[20:23], s55 offen offset:0 lds
  v_mfma_f32_16x16x32_bf16 v[96:99], a[56:59], a[12:15], v[96:99]
  ds_read_b128 a[32:35], v232 offset:33792
  v_mfma_f32_16x16x32_bf16 v[100:103], a[60:63], a[12:15], v[100:103]
  ds_read_b128 a[36:39], v232 offset:34816
  v_mfma_f32_16x16x32_bf16 v[104:107], a[64:67], a[12:15], v[104:107]
  ds_read_b128 a[40:43], v232 offset:35840
  v_mfma_f32_16x16x32_bf16 v[108:111], a[68:71], a[12:15], v[108:111]
  s_add_u32 s55, s68, 0x3c00
  ds_read_b128 a[44:47], v232 offset:36864
  v_mfma_f32_16x16x32_bf16 v[112:115], a[72:75], a[12:15], v[112:115]
  buffer_load_dwordx4 v227, s[20:23], s55 offen offset:1024 lds
  v_mfma_f32_16x16x32_bf16 v[116:119], a[76:79], a[12:15], v[116:119]
  ds_read_b128 a[48:51], v232 offset:37888
  v_mfma_f32_16x16x32_bf16 v[120:123], a[80:83], a[12:15], v[120:123]
  ds_read_b128 a[52:55], v232 offset:38912
  v_mfma_f32_16x16x32_bf16 v[124:127], a[84:87], a[12:15], v[124:127]
  v_mfma_f32_16x16x32_bf16 v[128:131], a[56:59], a[16:19], v[128:131]
  s_add_u32 s55, s68, 0x7800
  v_mfma_f32_16x16x32_bf16 v[132:135], a[60:63], a[16:19], v[132:135]
  buffer_load_dwordx4 v227, s[20:23], s55 offen offset:2048 lds
  v_mfma_f32_16x16x32_bf16 v[136:139], a[64:67], a[16:19], v[136:139]
  v_mfma_f32_16x16x32_bf16 v[140:143], a[68:71], a[16:19], v[140:143]
  v_mfma_f32_16x16x32_bf16 v[144:147], a[72:75], a[16:19], v[144:147]
  v_mfma_f32_16x16x32_bf16 v[148:151], a[76:79], a[16:19], v[148:151]
  s_add_u32 s55, s69, 0xb400
  v_mfma_f32_16x16x32_bf16 v[152:155], a[80:83], a[16:19], v[152:155]
  buffer_load_dwordx4 v227, s[20:23], s55 offen offset:3072 lds
  v_mfma_f32_16x16x32_bf16 v[156:159], a[84:87], a[16:19], v[156:159]
  v_mfma_f32_16x16x32_bf16 v[160:163], a[56:59], a[20:23], v[160:163]
  v_mfma_f32_16x16x32_bf16 v[164:167], a[60:63], a[20:23], v[164:167]
  v_mfma_f32_16x16x32_bf16 v[168:171], a[64:67], a[20:23], v[168:171]
  v_mfma_f32_16x16x32_bf16 v[172:175], a[68:71], a[20:23], v[172:175]
  v_mfma_f32_16x16x32_bf16 v[176:179], a[72:75], a[20:23], v[176:179]
  v_mfma_f32_16x16x32_bf16 v[180:183], a[76:79], a[20:23], v[180:183]
  v_mfma_f32_16x16x32_bf16 v[184:187], a[80:83], a[20:23], v[184:187]
  v_mfma_f32_16x16x32_bf16 v[188:191], a[84:87], a[20:23], v[188:191]
  v_mfma_f32_16x16x32_bf16 v[192:195], a[56:59], a[24:27], v[192:195]
  v_mfma_f32_16x16x32_bf16 v[196:199], a[60:63], a[24:27], v[196:199]
  v_mfma_f32_16x16x32_bf16 v[200:203], a[64:67], a[24:27], v[200:203]
  v_mfma_f32_16x16x32_bf16 v[204:207], a[68:71], a[24:27], v[204:207]
  v_mfma_f32_16x16x32_bf16 v[208:211], a[72:75], a[24:27], v[208:211]
  v_mfma_f32_16x16x32_bf16 v[212:215], a[76:79], a[24:27], v[212:215]
  v_mfma_f32_16x16x32_bf16 v[216:219], a[80:83], a[24:27], v[216:219]
  v_mfma_f32_16x16x32_bf16 v[220:223], a[84:87], a[24:27], v[220:223]
  s_waitcnt lgkmcnt(0)
  s_nop 0
  v_mfma_f32_16x16x32_bf16 v[0:3], a[88:91], a[28:31], v[0:3]
  s_waitcnt vmcnt(8)
  s_nop 0
  v_mfma_f32_16x16x32_bf16 v[4:7], a[92:95], a[28:31], v[4:7]
  s_barrier
  s_nop 0
  v_mfma_f32_16x16x32_bf16 v[8:11], a[96:99], a[28:31], v[8:11]
  s_add_u32 m0, s49, 0x8000
  s_add_u32 s63, s63, 64
  s_nop 0
  s_and_b32 s63, s63, 0x3ff
  s_lshl_b32 s54, s63, 12
  s_add_u32 s54, s54, s50
  ds_read_b128 a[0:3], v232 offset:0
  v_mfma_f32_16x16x32_bf16 v[12:15], a[100:103], a[28:31], v[12:15]
  buffer_load_dwordx4 v229, s[32:35], s54 offen offset:0 lds
  v_mfma_f32_16x16x32_bf16 v[16:19], a[104:107], a[28:31], v[16:19]
  s_add_u32 m0, s49, 0x8380
  s_add_u32 s68, s51, s63
  s_nop 0
  ds_read_b64_tr_b16 a[56:57], v225 offset:0
  v_mfma_f32_16x16x32_bf16 v[20:23], a[108:111], a[28:31], v[20:23]
  s_add_u32 s69, s52, s63
  s_nop 0
  ds_read_b64_tr_b16 a[58:59], v225 offset:4096
  v_mfma_f32_16x16x32_bf16 v[24:27], a[112:115], a[28:31], v[24:27]
  buffer_load_dwordx4 v229, s[32:35], s54 offen offset:128 lds
  v_mfma_f32_16x16x32_bf16 v[28:31], a[116:119], a[28:31], v[28:31]
  s_add_u32 m0, s49, 0x8800
  ds_read_b64_tr_b16 a[60:61], v225 offset:8
  v_mfma_f32_16x16x32_bf16 v[32:35], a[88:91], a[32:35], v[32:35]
  s_add_u32 s54, s54, 0x20000
  ds_read_b64_tr_b16 a[62:63], v225 offset:4104
  v_mfma_f32_16x16x32_bf16 v[36:39], a[92:95], a[32:35], v[36:39]
  buffer_load_dwordx4 v229, s[32:35], s54 offen offset:0 lds
  v_mfma_f32_16x16x32_bf16 v[40:43], a[96:99], a[32:35], v[40:43]
  ds_read_b64_tr_b16 a[64:65], v225 offset:512
  v_mfma_f32_16x16x32_bf16 v[44:47], a[100:103], a[32:35], v[44:47]
  s_add_u32 m0, s49, 0x8b80
  ds_read_b64_tr_b16 a[66:67], v225 offset:4608
  v_mfma_f32_16x16x32_bf16 v[48:51], a[104:107], a[32:35], v[48:51]
  buffer_load_dwordx4 v229, s[32:35], s54 offen offset:128 lds
  v_mfma_f32_16x16x32_bf16 v[52:55], a[108:111], a[32:35], v[52:55]
  s_add_u32 m0, s49, 0xa000
  ds_read_b64_tr_b16 a[68:69], v225 offset:520
  v_mfma_f32_16x16x32_bf16 v[56:59], a[112:115], a[32:35], v[56:59]
  s_add_u32 s55, s68, 0
  s_nop 0
  ds_read_b64_tr_b16 a[70:71], v225 offset:4616
  v_mfma_f32_16x16x32_bf16 v[60:63], a[116:119], a[32:35], v[60:63]
  buffer_load_dwordx4 v227, s[20:23], s55 offen offset:0 lds
  v_mfma_f32_16x16x32_bf16 v[64:67], a[88:91], a[36:39], v[64:67]
  ds_read_b64_tr_b16 a[72:73], v225 offset:1024
  v_mfma_f32_16x16x32_bf16 v[68:71], a[92:95], a[36:39], v[68:71]
  s_add_u32 s55, s68, 0x3c00
  ds_read_b64_tr_b16 a[74:75], v225 offset:5120
  v_mfma_f32_16x16x32_bf16 v[72:75], a[96:99], a[36:39], v[72:75]
  buffer_load_dwordx4 v227, s[20:23], s55 offen offset:1024 lds
  v_mfma_f32_16x16x32_bf16 v[76:79], a[100:103], a[36:39], v[76:79]
  ds_read_b64_tr_b16 a[76:77], v225 offset:1032
  v_mfma_f32_16x16x32_bf16 v[80:83], a[104:107], a[36:39], v[80:83]
  s_add_u32 s55, s68, 0x7800
  ds_read_b64_tr_b16 a[78:79], v225 offset:5128
  v_mfma_f32_16x16x32_bf16 v[84:87], a[108:111], a[36:39], v[84:87]
  buffer_load_dwordx4 v227, s[20:23], s55 offen offset:2048 lds
  v_mfma_f32_16x16x32_bf16 v[88:91], a[112:115], a[36:39], v[88:91]
  ds_read_b64_tr_b16 a[80:81], v225 offset:1536
  v_mfma_f32_16x16x32_bf16 v[92:95], a[116:119], a[36:39], v[92:95]
  s_add_u32 s55, s69, 0xb400
  ds_read_b64_tr_b16 a[82:83], v225 offset:5632
  v_mfma_f32_16x16x32_bf16 v[96:99], a[88:91], a[40:43], v[96:99]
  buffer_load_dwordx4 v227, s[20:23], s55 offen offset:3072 lds
  v_mfma_f32_16x16x32_bf16 v[100:103], a[92:95], a[40:43], v[100:103]
  s_add_u32 m0, s49, 0xc000
  s_add_u32 s66, s53, 0
  s_nop 0
  ds_read_b64_tr_b16 a[84:85], v225 offset:1544
  v_mfma_f32_16x16x32_bf16 v[104:107], a[96:99], a[40:43], v[104:107]
  s_and_b32 s66, s66, 0x1ffff
  ds_read_b64_tr_b16 a[86:87], v225 offset:5640
  v_mfma_f32_16x16x32_bf16 v[108:111], a[100:103], a[40:43], v[108:111]
  buffer_load_dwordx4 v226, s[24:27], s66 offen offset:0 nt lds
  v_mfma_f32_16x16x32_bf16 v[112:115], a[104:107], a[40:43], v[112:115]
  ds_read_b128 a[4:7], v232 offset:1024
  v_mfma_f32_16x16x32_bf16 v[116:119], a[108:111], a[40:43], v[116:119]
  s_add_u32 m0, s49, 0xc380
  ds_read_b128 a[8:11], v232 offset:2048
  v_mfma_f32_16x16x32_bf16 v[120:123], a[112:115], a[40:43], v[120:123]
  buffer_load_dwordx4 v226, s[24:27], s66 offen offset:128 nt lds
  v_mfma_f32_16x16x32_bf16 v[124:127], a[116:119], a[40:43], v[124:127]
  ds_read_b128 a[12:15], v232 offset:3072
  v_mfma_f32_16x16x32_bf16 v[128:131], a[88:91], a[44:47], v[128:131]
  s_add_u32 m0, s49, 0xc000
  ds_read_b128 a[16:19], v232 offset:4096
  v_mfma_f32_16x16x32_bf16 v[132:135], a[92:95], a[44:47], v[132:135]
  buffer_load_dwordx4 v226, s[24:27], s66 offen offset:2048 nt lds
  v_mfma_f32_16x16x32_bf16 v[136:139], a[96:99], a[44:47], v[136:139]
  ds_read_b128 a[20:23], v232 offset:5120
  v_mfma_f32_16x16x32_bf16 v[140:143], a[100:103], a[44:47], v[140:143]
  s_add_u32 m0, s49, 0xc380
  ds_read_b128 a[24:27], v232 offset:6144
  v_mfma_f32_16x16x32_bf16 v[144:147], a[104:107], a[44:47], v[144:147]
  buffer_load_dwordx4 v226, s[24:27], s66 offen offset:2176 nt lds
  v_mfma_f32_16x16x32_bf16 v[148:151], a[108:111], a[44:47], v[148:151]
  v_mfma_f32_16x16x32_bf16 v[152:155], a[112:115], a[44:47], v[152:155]
  s_add_u32 m0, s49, 0xe000
  v_mfma_f32_16x16x32_bf16 v[156:159], a[116:119], a[44:47], v[156:159]
  buffer_load_dwordx4 v228, s[28:31], s66 offen offset:0 nt lds
  v_mfma_f32_16x16x32_bf16 v[160:163], a[88:91], a[48:51], v[160:163]
  v_mfma_f32_16x16x32_bf16 v[164:167], a[92:95], a[48:51], v[164:167]
  s_add_u32 m0, s49, 0xe380
  v_mfma_f32_16x16x32_bf16 v[168:171], a[96:99], a[48:51], v[168:171]
  buffer_load_dwordx4 v228, s[28:31], s66 offen offset:128 nt lds
  v_mfma_f32_16x16x32_bf16 v[172:175], a[100:103], a[48:51], v[172:175]
  v_mfma_f32_16x16x32_bf16 v[176:179], a[104:107], a[48:51], v[176:179]
  s_add_u32 m0, s49, 0xe000
  v_mfma_f32_16x16x32_bf16 v[180:183], a[108:111], a[48:51], v[180:183]
  buffer_load_dwordx4 v228, s[28:31], s66 offen offset:2048 nt lds
  v_mfma_f32_16x16x32_bf16 v[184:187], a[112:115], a[48:51], v[184:187]
  v_mfma_f32_16x16x32_bf16 v[188:191], a[116:119], a[48:51], v[188:191]
  s_add_u32 m0, s49, 0xe380
  v_mfma_f32_16x16x32_bf16 v[192:195], a[88:91], a[52:55], v[192:195]
  buffer_load_dwordx4 v228, s[28:31], s66 offen offset:2176 nt lds
  v_mfma_f32_16x16x32_bf16 v[196:199], a[92:95], a[52:55], v[196:199]
  v_mfma_f32_16x16x32_bf16 v[200:203], a[96:99], a[52:55], v[200:203]
  v_mfma_f32_16x16x32_bf16 v[204:207], a[100:103], a[52:55], v[204:207]
  v_mfma_f32_16x16x32_bf16 v[208:211], a[104:107], a[52:55], v[208:211]
  v_mfma_f32_16x16x32_bf16 v[212:215], a[108:111], a[52:55], v[212:215]
  v_mfma_f32_16x16x32_bf16 v[216:219], a[112:115], a[52:55], v[216:219]
  v_mfma_f32_16x16x32_bf16 v[220:223], a[116:119], a[52:55], v[220:223]
  s_waitcnt lgkmcnt(0)
  s_nop 0
  v_mfma_f32_16x16x32_bf16 v[0:3], a[56:59], a[0:3], v[0:3]
  s_waitcnt vmcnt(16)
  s_nop 0
  v_mfma_f32_16x16x32_bf16 v[4:7], a[60:63], a[0:3], v[4:7]
  s_barrier
  s_nop 0
  v_mfma_f32_16x16x32_bf16 v[8:11], a[64:67], a[0:3], v[8:11]
  s_add_u32 m0, s49, 0
  s_add_u32 s63, s63, 64
  s_and_b32 s63, s63, 0x3ff
  s_lshl_b32 s54, s63, 12
  s_add_u32 s54, s54, s50
  ds_read_b128 a[28:31], v232 offset:16384
  v_mfma_f32_16x16x32_bf16 v[12:15], a[68:71], a[0:3], v[12:15]
  buffer_load_dwordx4 v229, s[32:35], s54 offen offset:0 lds
  v_mfma_f32_16x16x32_bf16 v[16:19], a[72:75], a[0:3], v[16:19]
  ds_read_b64_tr_b16 a[88:89], v225 offset:16384
  v_mfma_f32_16x16x32_bf16 v[20:23], a[76:79], a[0:3], v[20:23]
  s_add_u32 m0, s49, 0x380
  ds_read_b64_tr_b16 a[90:91], v225 offset:20480
  v_mfma_f32_16x16x32_bf16 v[24:27], a[80:83], a[0:3], v[24:27]
  s_add_u32 s68, s51, s63
  s_nop 0
  ds_read_b64_tr_b16 a[92:93], v225 offset:16392
  v_mfma_f32_16x16x32_bf16 v[28:31], a[84:87], a[0:3], v[28:31]
  s_add_u32 s69, s52, s63
  s_nop 0
  ds_read_b64_tr_b16 a[94:95], v225 offset:20488
  v_mfma_f32_16x16x32_bf16 v[32:35], a[56:59], a[4:7], v[32:35]
  buffer_load_dwordx4 v229, s[32:35], s54 offen offset:128 lds
  v_mfma_f32_16x16x32_bf16 v[36:39], a[60:63], a[4:7], v[36:39]
  ds_read_b64_tr_b16 a[96:97], v225 offset:16896
  v_mfma_f32_16x16x32_bf16 v[40:43], a[64:67], a[4:7], v[40:43]
  ds_read_b64_tr_b16 a[98:99], v225 offset:20992
  v_mfma_f32_16x16x32_bf16 v[44:47], a[68:71], a[4:7], v[44:47]
  s_add_u32 m0, s49, 0x800
  ds_read_b64_tr_b16 a[100:101], v225 offset:16904
  v_mfma_f32_16x16x32_bf16 v[48:51], a[72:75], a[4:7], v[48:51]
  s_add_u32 s54, s54, 0x20000
  ds_read_b64_tr_b16 a[102:103], v225 offset:21000
  v_mfma_f32_16x16x32_bf16 v[52:55], a[76:79], a[4:7], v[52:55]
  buffer_load_dwordx4 v229, s[32:35], s54 offen offset:0 lds
  v_mfma_f32_16x16x32_bf16 v[56:59], a[80:83], a[4:7], v[56:59]
  ds_read_b64_tr_b16 a[104:105], v225 offset:17408
  v_mfma_f32_16x16x32_bf16 v[60:63], a[84:87], a[4:7], v[60:63]
  ds_read_b64_tr_b16 a[106:107], v225 offset:21504
  v_mfma_f32_16x16x32_bf16 v[64:67], a[56:59], a[8:11], v[64:67]
  ds_read_b64_tr_b16 a[108:109], v225 offset:17416
  v_mfma_f32_16x16x32_bf16 v[68:71], a[60:63], a[8:11], v[68:71]
  s_add_u32 m0, s49, 0xb80
  ds_read_b64_tr_b16 a[110:111], v225 offset:21512
  v_mfma_f32_16x16x32_bf16 v[72:75], a[64:67], a[8:11], v[72:75]
  buffer_load_dwordx4 v229, s[32:35], s54 offen offset:128 lds
  v_mfma_f32_16x16x32_bf16 v[76:79], a[68:71], a[8:11], v[76:79]
  ds_read_b64_tr_b16 a[112:113], v225 offset:17920
  v_mfma_f32_16x16x32_bf16 v[80:83], a[72:75], a[8:11], v[80:83]
  ds_read_b64_tr_b16 a[114:115], v225 offset:22016
  v_mfma_f32_16x16x32_bf16 v[84:87], a[76:79], a[8:11], v[84:87]
  s_add_u32 m0, s49, 0x2000
  ds_read_b64_tr_b16 a[116:117], v225 offset:17928
  v_mfma_f32_16x16x32_bf16 v[88:91], a[80:83], a[8:11], v[88:91]
  s_add_u32 s55, s68, 0
  s_nop 0
  ds_read_b64_tr_b16 a[118:119], v225 offset:22024
  v_mfma_f32_16x16x32_bf16 v[92:95], a[84:87], a[8:11], v[92:95]
  buffer_load_dwordx4 v227, s[20:23], s55 offen offset:0 lds
  v_mfma_f32_16x16x32_bf16 v[96:99], a[56:59], a[12:15], v[96:99]
  ds_read_b128 a[32:35], v232 offset:17408
  v_mfma_f32_16x16x32_bf16 v[100:103], a[60:63], a[12:15], v[100:103]
  ds_read_b128 a[36:39], v232 offset:18432
  v_mfma_f32_16x16x32_bf16 v[104:107], a[64:67], a[12:15], v[104:107]
  ds_read_b128 a[40:43], v232 offset:19456
  v_mfma_f32_16x16x32_bf16 v[108:111], a[68:71], a[12:15], v[108:111]
  s_add_u32 s55, s68, 0x3c00
  ds_read_b128 a[44:47], v232 offset:20480
  v_mfma_f32_16x16x32_bf16 v[112:115], a[72:75], a[12:15], v[112:115]
  buffer_load_dwordx4 v227, s[20:23], s55 offen offset:1024 lds
  v_mfma_f32_16x16x32_bf16 v[116:119], a[76:79], a[12:15], v[116:119]
  ds_read_b128 a[48:51], v232 offset:21504
  v_mfma_f32_16x16x32_bf16 v[120:123], a[80:83], a[12:15], v[120:123]
  ds_read_b128 a[52:55], v232 offset:22528
  v_mfma_f32_16x16x32_bf16 v[124:127], a[84:87], a[12:15], v[124:127]
  v_mfma_f32_16x16x32_bf16 v[128:131], a[56:59], a[16:19], v[128:131]
  s_add_u32 s55, s68, 0x7800
  v_mfma_f32_16x16x32_bf16 v[132:135], a[60:63], a[16:19], v[132:135]
  buffer_load_dwordx4 v227, s[20:23], s55 offen offset:2048 lds
  v_mfma_f32_16x16x32_bf16 v[136:139], a[64:67], a[16:19], v[136:139]
  v_mfma_f32_16x16x32_bf16 v[140:143], a[68:71], a[16:19], v[140:143]
  v_mfma_f32_16x16x32_bf16 v[144:147], a[72:75], a[16:19], v[144:147]
  v_mfma_f32_16x16x32_bf16 v[148:151], a[76:79], a[16:19], v[148:151]
  s_add_u32 s55, s69, 0xb400
  v_mfma_f32_16x16x32_bf16 v[152:155], a[80:83], a[16:19], v[152:155]
  buffer_load_dwordx4 v227, s[20:23], s55 offen offset:3072 lds
  v_mfma_f32_16x16x32_bf16 v[156:159], a[84:87], a[16:19], v[156:159]
  v_mfma_f32_16x16x32_bf16 v[160:163], a[56:59], a[20:23], v[160:163]
  v_mfma_f32_16x16x32_bf16 v[164:167], a[60:63], a[20:23], v[164:167]
  v_mfma_f32_16x16x32_bf16 v[168:171], a[64:67], a[20:23], v[168:171]
  v_mfma_f32_16x16x32_bf16 v[172:175], a[68:71], a[20:23], v[172:175]
  v_mfma_f32_16x16x32_bf16 v[176:179], a[72:75], a[20:23], v[176:179]
  v_mfma_f32_16x16x32_bf16 v[180:183], a[76:79], a[20:23], v[180:183]
  v_mfma_f32_16x16x32_bf16 v[184:187], a[80:83], a[20:23], v[184:187]
  v_mfma_f32_16x16x32_bf16 v[188:191], a[84:87], a[20:23], v[188:191]
  v_mfma_f32_16x16x32_bf16 v[192:195], a[56:59], a[24:27], v[192:195]
  v_mfma_f32_16x16x32_bf16 v[196:199], a[60:63], a[24:27], v[196:199]
  v_mfma_f32_16x16x32_bf16 v[200:203], a[64:67], a[24:27], v[200:203]
  v_mfma_f32_16x16x32_bf16 v[204:207], a[68:71], a[24:27], v[204:207]
  v_mfma_f32_16x16x32_bf16 v[208:211], a[72:75], a[24:27], v[208:211]
  v_mfma_f32_16x16x32_bf16 v[212:215], a[76:79], a[24:27], v[212:215]
  v_mfma_f32_16x16x32_bf16 v[216:219], a[80:83], a[24:27], v[216:219]
  v_mfma_f32_16x16x32_bf16 v[220:223], a[84:87], a[24:27], v[220:223]
  s_waitcnt lgkmcnt(0)
  s_nop 0
  v_mfma_f32_16x16x32_bf16 v[0:3], a[88:91], a[28:31], v[0:3]
  s_waitcnt vmcnt(16)
  s_nop 0
  v_mfma_f32_16x16x32_bf16 v[4:7], a[92:95], a[28:31], v[4:7]
  s_barrier
  s_nop 0
  v_mfma_f32_16x16x32_bf16 v[8:11], a[96:99], a[28:31], v[8:11]
  s_add_u32 m0, s49, 0x4000
  s_add_u32 s63, s63, 64
  s_nop 0
  s_and_b32 s63, s63, 0x3ff
  s_lshl_b32 s54, s63, 12
  s_add_u32 s54, s54, s50
  ds_read_b128 a[0:3], v232 offset:32768
  v_mfma_f32_16x16x32_bf16 v[12:15], a[100:103], a[28:31], v[12:15]
  buffer_load_dwordx4 v229, s[32:35], s54 offen offset:0 lds
  v_mfma_f32_16x16x32_bf16 v[16:19], a[104:107], a[28:31], v[16:19]
  ds_read_b64_tr_b16 a[56:57], v225 offset:32768
  v_mfma_f32_16x16x32_bf16 v[20:23], a[108:111], a[28:31], v[20:23]
  s_add_u32 m0, s49, 0x4380
  ds_read_b64_tr_b16 a[58:59], v225 offset:36864
  v_mfma_f32_16x16x32_bf16 v[24:27], a[112:115], a[28:31], v[24:27]
  s_add_u32 s68, s51, s63
  s_nop 0
  ds_read_b64_tr_b16 a[60:61], v225 offset:32776
  v_mfma_f32_16x16x32_bf16 v[28:31], a[116:119], a[28:31], v[28:31]
  s_add_u32 s69, s52, s63
  s_nop 0
  ds_read_b64_tr_b16 a[62:63], v225 offset:36872
  v_mfma_f32_16x16x32_bf16 v[32:35], a[88:91], a[32:35], v[32:35]
  buffer_load_dwordx4 v229, s[32:35], s54 offen offset:128 lds
  v_mfma_f32_16x16x32_bf16 v[36:39], a[92:95], a[32:35], v[36:39]
  ds_read_b64_tr_b16 a[64:65], v225 offset:33280
  v_mfma_f32_16x16x32_bf16 v[40:43], a[96:99], a[32:35], v[40:43]
  ds_read_b64_tr_b16 a[66:67], v225 offset:37376
  v_mfma_f32_16x16x32_bf16 v[44:47], a[100:103], a[32:35], v[44:47]
  s_add_u32 m0, s49, 0x4800
  ds_read_b64_tr_b16 a[68:69], v225 offset:33288
  v_mfma_f32_16x16x32_bf16 v[48:51], a[104:107], a[32:35], v[48:51]
  s_add_u32 s54, s54, 0x20000
  ds_read_b64_tr_b16 a[70:71], v225 offset:37384
  v_mfma_f32_16x16x32_bf16 v[52:55], a[108:111], a[32:35], v[52:55]
  buffer_load_dwordx4 v229, s[32:35], s54 offen offset:0 lds
  v_mfma_f32_16x16x32_bf16 v[56:59], a[112:115], a[32:35], v[56:59]
  ds_read_b64_tr_b16 a[72:73], v225 offset:33792
  v_mfma_f32_16x16x32_bf16 v[60:63], a[116:119], a[32:35], v[60:63]
  ds_read_b64_tr_b16 a[74:75], v225 offset:37888
  v_mfma_f32_16x16x32_bf16 v[64:67], a[88:91], a[36:39], v[64:67]
  ds_read_b64_tr_b16 a[76:77], v225 offset:33800
  v_mfma_f32_16x16x32_bf16 v[68:71], a[92:95], a[36:39], v[68:71]
  s_add_u32 m0, s49, 0x4b80
  ds_read_b64_tr_b16 a[78:79], v225 offset:37896
  v_mfma_f32_16x16x32_bf16 v[72:75], a[96:99], a[36:39], v[72:75]
  buffer_load_dwordx4 v229, s[32:35], s54 offen offset:128 lds
  v_mfma_f32_16x16x32_bf16 v[76:79], a[100:103], a[36:39], v[76:79]
  ds_read_b64_tr_b16 a[80:81], v225 offset:34304
  v_mfma_f32_16x16x32_bf16 v[80:83], a[104:107], a[36:39], v[80:83]
  ds_read_b64_tr_b16 a[82:83], v225 offset:38400
  v_mfma_f32_16x16x32_bf16 v[84:87], a[108:111], a[36:39], v[84:87]
  s_add_u32 m0, s49, 0x6000
  ds_read_b64_tr_b16 a[84:85], v225 offset:34312
  v_mfma_f32_16x16x32_bf16 v[88:91], a[112:115], a[36:39], v[88:91]
  s_add_u32 s55, s68, 0
  s_nop 0
  ds_read_b64_tr_b16 a[86:87], v225 offset:38408
  v_mfma_f32_16x16x32_bf16 v[92:95], a[116:119], a[36:39], v[92:95]
  buffer_load_dwordx4 v227, s[20:23], s55 offen offset:0 lds
  v_mfma_f32_16x16x32_bf16 v[96:99], a[88:91], a[40:43], v[96:99]
  ds_read_b128 a[4:7], v232 offset:33792
  v_mfma_f32_16x16x32_bf16 v[100:103], a[92:95], a[40:43], v[100:103]
  ds_read_b128 a[8:11], v232 offset:34816
  v_mfma_f32_16x16x32_bf16 v[104:107], a[96:99], a[40:43], v[104:107]
  ds_read_b128 a[12:15], v232 offset:35840
  v_mfma_f32_16x16x32_bf16 v[108:111], a[100:103], a[40:43], v[108:111]
  s_add_u32 s55, s68, 0x3c00
  ds_read_b128 a[16:19], v232 offset:36864
  v_mfma_f32_16x16x32_bf16 v[112:115], a[104:107], a[40:43], v[112:115]
  buffer_load_dwordx4 v227, s[20:23], s55 offen offset:1024 lds
  v_mfma_f32_16x16x32_bf16 v[116:119], a[108:111], a[40:43], v[116:119]
  ds_read_b128 a[20:23], v232 offset:37888
  v_mfma_f32_16x16x32_bf16 v[120:123], a[112:115], a[40:43], v[120:123]
  ds_read_b128 a[24:27], v232 offset:38912
  v_mfma_f32_16x16x32_bf16 v[124:127], a[116:119], a[40:43], v[124:127]
  v_mfma_f32_16x16x32_bf16 v[128:131], a[88:91], a[44:47], v[128:131]
  s_add_u32 s55, s68, 0x7800
  v_mfma_f32_16x16x32_bf16 v[132:135], a[92:95], a[44:47], v[132:135]
  buffer_load_dwordx4 v227, s[20:23], s55 offen offset:2048 lds
  v_mfma_f32_16x16x32_bf16 v[136:139], a[96:99], a[44:47], v[136:139]
  v_mfma_f32_16x16x32_bf16 v[140:143], a[100:103], a[44:47], v[140:143]
  v_mfma_f32_16x16x32_bf16 v[144:147], a[104:107], a[44:47], v[144:147]
  v_mfma_f32_16x16x32_bf16 v[148:151], a[108:111], a[44:47], v[148:151]
  s_add_u32 s55, s69, 0xb400
  v_mfma_f32_16x16x32_bf16 v[152:155], a[112:115], a[44:47], v[152:155]
  buffer_load_dwordx4 v227, s[20:23], s55 offen offset:3072 lds
  v_mfma_f32_16x16x32_bf16 v[156:159], a[116:119], a[44:47], v[156:159]
  v_mfma_f32_16x16x32_bf16 v[160:163], a[88:91], a[48:51], v[160:163]
  v_mfma_f32_16x16x32_bf16 v[164:167], a[92:95], a[48:51], v[164:167]
  v_mfma_f32_16x16x32_bf16 v[168:171], a[96:99], a[48:51], v[168:171]
  v_mfma_f32_16x16x32_bf16 v[172:175], a[100:103], a[48:51], v[172:175]
  v_mfma_f32_16x16x32_bf16 v[176:179], a[104:107], a[48:51], v[176:179]
  v_mfma_f32_16x16x32_bf16 v[180:183], a[108:111], a[48:51], v[180:183]
  v_mfma_f32_16x16x32_bf16 v[184:187], a[112:115], a[48:51], v[184:187]
  v_mfma_f32_16x16x32_bf16 v[188:191], a[116:119], a[48:51], v[188:191]
  v_mfma_f32_16x16x32_bf16 v[192:195], a[88:91], a[52:55], v[192:195]
  v_mfma_f32_16x16x32_bf16 v[196:199], a[92:95], a[52:55], v[196:199]
  v_mfma_f32_16x16x32_bf16 v[200:203], a[96:99], a[52:55], v[200:203]
  v_mfma_f32_16x16x32_bf16 v[204:207], a[100:103], a[52:55], v[204:207]
  v_mfma_f32_16x16x32_bf16 v[208:211], a[104:107], a[52:55], v[208:211]
  v_mfma_f32_16x16x32_bf16 v[212:215], a[108:111], a[52:55], v[212:215]
  v_mfma_f32_16x16x32_bf16 v[216:219], a[112:115], a[52:55], v[216:219]
  v_mfma_f32_16x16x32_bf16 v[220:223], a[116:119], a[52:55], v[220:223]
  s_waitcnt lgkmcnt(0)
  s_nop 0
  v_mfma_f32_16x16x32_bf16 v[0:3], a[56:59], a[0:3], v[0:3]
  s_waitcnt vmcnt(8)
  s_nop 0
  v_mfma_f32_16x16x32_bf16 v[4:7], a[60:63], a[0:3], v[4:7]
  s_barrier
  s_nop 0
  v_mfma_f32_16x16x32_bf16 v[8:11], a[64:67], a[0:3], v[8:11]
  s_add_u32 m0, s49, 0x8000
  s_add_u32 s63, s63, 64
  s_nop 0
  s_and_b32 s63, s63, 0x3ff
  s_lshl_b32 s54, s63, 12
  s_add_u32 s54, s54, s50
  ds_read_b128 a[28:31], v232 offset:0
  v_mfma_f32_16x16x32_bf16 v[12:15], a[68:71], a[0:3], v[12:15]
  buffer_load_dwordx4 v229, s[32:35], s54 offen offset:0 lds
  v_mfma_f32_16x16x32_bf16 v[16:19], a[72:75], a[0:3], v[16:19]
  s_add_u32 m0, s49, 0x8380
  s_add_u32 s68, s51, s63
  s_nop 0
  ds_read_b64_tr_b16 a[88:89], v225 offset:0
  v_mfma_f32_16x16x32_bf16 v[20:23], a[76:79], a[0:3], v[20:23]
  s_add_u32 s69, s52, s63
  s_nop 0
  ds_read_b64_tr_b16 a[90:91], v225 offset:4096
  v_mfma_f32_16x16x32_bf16 v[24:27], a[80:83], a[0:3], v[24:27]
  buffer_load_dwordx4 v229, s[32:35], s54 offen offset:128 lds
  v_mfma_f32_16x16x32_bf16 v[28:31], a[84:87], a[0:3], v[28:31]
  s_add_u32 m0, s49, 0x8800
  ds_read_b64_tr_b16 a[92:93], v225 offset:8
  v_mfma_f32_16x16x32_bf16 v[32:35], a[56:59], a[4:7], v[32:35]
  s_add_u32 s54, s54, 0x20000
  ds_read_b64_tr_b16 a[94:95], v225 offset:4104
  v_mfma_f32_16x16x32_bf16 v[36:39], a[60:63], a[4:7], v[36:39]
  buffer_load_dwordx4 v229, s[32:35], s54 offen offset:0 lds
  v_mfma_f32_16x16x32_bf16 v[40:43], a[64:67], a[4:7], v[40:43]
  ds_read_b64_tr_b16 a[96:97], v225 offset:512
  v_mfma_f32_16x16x32_bf16 v[44:47], a[68:71], a[4:7], v[44:47]
  s_add_u32 m0, s49, 0x8b80
  ds_read_b64_tr_b16 a[98:99], v225 offset:4608
  v_mfma_f32_16x16x32_bf16 v[48:51], a[72:75], a[4:7], v[48:51]
  buffer_load_dwordx4 v229, s[32:35], s54 offen offset:128 lds
  v_mfma_f32_16x16x32_bf16 v[52:55], a[76:79], a[4:7], v[52:55]
  s_add_u32 m0, s49, 0xa000
  ds_read_b64_tr_b16 a[100:101], v225 offset:520
  v_mfma_f32_16x16x32_bf16 v[56:59], a[80:83], a[4:7], v[56:59]
  s_add_u32 s55, s68, 0
  s_nop 0
  ds_read_b64_tr_b16 a[102:103], v225 offset:4616
  v_mfma_f32_16x16x32_bf16 v[60:63], a[84:87], a[4:7], v[60:63]
  buffer_load_dwordx4 v227, s[20:23], s55 offen offset:0 lds
  v_mfma_f32_16x16x32_bf16 v[64:67], a[56:59], a[8:11], v[64:67]
  ds_read_b64_tr_b16 a[104:105], v225 offset:1024
  v_mfma_f32_16x16x32_bf16 v[68:71], a[60:63], a[8:11], v[68:71]
  s_add_u32 s55, s68, 0x3c00
  ds_read_b64_tr_b16 a[106:107], v225 offset:5120
  v_mfma_f32_16x16x32_bf16 v[72:75], a[64:67], a[8:11], v[72:75]
  buffer_load_dwordx4 v227, s[20:23], s55 offen offset:1024 lds
  v_mfma_f32_16x16x32_bf16 v[76:79], a[68:71], a[8:11], v[76:79]
  ds_read_b64_tr_b16 a[108:109], v225 offset:1032
  v_mfma_f32_16x16x32_bf16 v[80:83], a[72:75], a[8:11], v[80:83]
  s_add_u32 s55, s68, 0x7800
  ds_read_b64_tr_b16 a[110:111], v225 offset:5128
  v_mfma_f32_16x16x32_bf16 v[84:87], a[76:79], a[8:11], v[84:87]
  buffer_load_dwordx4 v227, s[20:23], s55 offen offset:2048 lds
  v_mfma_f32_16x16x32_bf16 v[88:91], a[80:83], a[8:11], v[88:91]
  ds_read_b64_tr_b16 a[112:113], v225 offset:1536
  v_mfma_f32_16x16x32_bf16 v[92:95], a[84:87], a[8:11], v[92:95]
  s_add_u32 s55, s69, 0xb400
  ds_read_b64_tr_b16 a[114:115], v225 offset:5632
  v_mfma_f32_16x16x32_bf16 v[96:99], a[56:59], a[12:15], v[96:99]
  buffer_load_dwordx4 v227, s[20:23], s55 offen offset:3072 lds
  v_mfma_f32_16x16x32_bf16 v[100:103], a[60:63], a[12:15], v[100:103]
  s_add_u32 m0, s49, 0x10000
  s_add_u32 s66, s53, 0x2000
  ds_read_b64_tr_b16 a[116:117], v225 offset:1544
  v_mfma_f32_16x16x32_bf16 v[104:107], a[64:67], a[12:15], v[104:107]
  s_and_b32 s66, s66, 0x1ffff
  ds_read_b64_tr_b16 a[118:119], v225 offset:5640
  v_mfma_f32_16x16x32_bf16 v[108:111], a[68:71], a[12:15], v[108:111]
  buffer_load_dwordx4 v226, s[24:27], s66 offen offset:0 nt lds
  v_mfma_f32_16x16x32_bf16 v[112:115], a[72:75], a[12:15], v[112:115]
  ds_read_b128 a[32:35], v232 offset:1024
  v_mfma_f32_16x16x32_bf16 v[116:119], a[76:79], a[12:15], v[116:119]
  s_add_u32 m0, s49, 0x10380
  ds_read_b128 a[36:39], v232 offset:2048
  v_mfma_f32_16x16x32_bf16 v[120:123], a[80:83], a[12:15], v[120:123]
  buffer_load_dwordx4 v226, s[24:27], s66 offen offset:128 nt lds
  v_mfma_f32_16x16x32_bf16 v[124:127], a[84:87], a[12:15], v[124:127]
  ds_read_b128 a[40:43], v232 offset:3072
  v_mfma_f32_16x16x32_bf16 v[128:131], a[56:59], a[16:19], v[128:131]
  s_add_u32 m0, s49, 0x10000
  ds_read_b128 a[44:47], v232 offset:4096
  v_mfma_f32_16x16x32_bf16 v[132:135], a[60:63], a[16:19], v[132:135]
  buffer_load_dwordx4 v226, s[24:27], s66 offen offset:2048 nt lds
  v_mfma_f32_16x16x32_bf16 v[136:139], a[64:67], a[16:19], v[136:139]
  ds_read_b128 a[48:51], v232 offset:5120
  v_mfma_f32_16x16x32_bf16 v[140:143], a[68:71], a[16:19], v[140:143]
  s_add_u32 m0, s49, 0x10380
  ds_read_b128 a[52:55], v232 offset:6144
  v_mfma_f32_16x16x32_bf16 v[144:147], a[72:75], a[16:19], v[144:147]
  buffer_load_dwordx4 v226, s[24:27], s66 offen offset:2176 nt lds
  v_mfma_f32_16x16x32_bf16 v[148:151], a[76:79], a[16:19], v[148:151]
  v_mfma_f32_16x16x32_bf16 v[152:155], a[80:83], a[16:19], v[152:155]
  s_add_u32 m0, s49, 0x12000
  v_mfma_f32_16x16x32_bf16 v[156:159], a[84:87], a[16:19], v[156:159]
  buffer_load_dwordx4 v228, s[28:31], s66 offen offset:0 nt lds
  v_mfma_f32_16x16x32_bf16 v[160:163], a[56:59], a[20:23], v[160:163]
  v_mfma_f32_16x16x32_bf16 v[164:167], a[60:63], a[20:23], v[164:167]
  s_add_u32 m0, s49, 0x12380
  v_mfma_f32_16x16x32_bf16 v[168:171], a[64:67], a[20:23], v[168:171]
  buffer_load_dwordx4 v228, s[28:31], s66 offen offset:128 nt lds
  v_mfma_f32_16x16x32_bf16 v[172:175], a[68:71], a[20:23], v[172:175]
  v_mfma_f32_16x16x32_bf16 v[176:179], a[72:75], a[20:23], v[176:179]
  s_add_u32 m0, s49, 0x12000
  v_mfma_f32_16x16x32_bf16 v[180:183], a[76:79], a[20:23], v[180:183]
  buffer_load_dwordx4 v228, s[28:31], s66 offen offset:2048 nt lds
  v_mfma_f32_16x16x32_bf16 v[184:187], a[80:83], a[20:23], v[184:187]
  v_mfma_f32_16x16x32_bf16 v[188:191], a[84:87], a[20:23], v[188:191]
  s_add_u32 m0, s49, 0x12380
  v_mfma_f32_16x16x32_bf16 v[192:195], a[56:59], a[24:27], v[192:195]
  buffer_load_dwordx4 v228, s[28:31], s66 offen offset:2176 nt lds
  v_mfma_f32_16x16x32_bf16 v[196:199], a[60:63], a[24:27], v[196:199]
  v_mfma_f32_16x16x32_bf16 v[200:203], a[64:67], a[24:27], v[200:203]
  v_mfma_f32_16x16x32_bf16 v[204:207], a[68:71], a[24:27], v[204:207]
  v_mfma_f32_16x16x32_bf16 v[208:211], a[72:75], a[24:27], v[208:211]
  v_mfma_f32_16x16x32_bf16 v[212:215], a[76:79], a[24:27], v[212:215]
  v_mfma_f32_16x16x32_bf16 v[216:219], a[80:83], a[24:27], v[216:219]
  v_mfma_f32_16x16x32_bf16 v[220:223], a[84:87], a[24:27], v[220:223]
  s_waitcnt lgkmcnt(0)
  s_nop 0
  v_mfma_f32_16x16x32_bf16 v[0:3], a[88:91], a[28:31], v[0:3]
  s_waitcnt vmcnt(16)
  s_nop 0
  v_mfma_f32_16x16x32_bf16 v[4:7], a[92:95], a[28:31], v[4:7]
  s_barrier
  s_nop 0
  v_mfma_f32_16x16x32_bf16 v[8:11], a[96:99], a[28:31], v[8:11]
  s_add_u32 m0, s49, 0
  s_add_u32 s63, s63, 64
  s_and_b32 s63, s63, 0x3ff
  s_lshl_b32 s54, s63, 12
  s_add_u32 s54, s54, s50
  ds_read_b128 a[0:3], v232 offset:16384
  v_mfma_f32_16x16x32_bf16 v[12:15], a[100:103], a[28:31], v[12:15]
  buffer_load_dwordx4 v229, s[32:35], s54 offen offset:0 lds
  v_mfma_f32_16x16x32_bf16 v[16:19], a[104:107], a[28:31], v[16:19]
  ds_read_b64_tr_b16 a[56:57], v225 offset:16384
  v_mfma_f32_16x16x32_bf16 v[20:23], a[108:111], a[28:31], v[20:23]
  s_add_u32 m0, s49, 0x380
  ds_read_b64_tr_b16 a[58:59], v225 offset:20480
  v_mfma_f32_16x16x32_bf16 v[24:27], a[112:115], a[28:31], v[24:27]
  s_add_u32 s68, s51, s63
  s_nop 0
  ds_read_b64_tr_b16 a[60:61], v225 offset:16392
  v_mfma_f32_16x16x32_bf16 v[28:31], a[116:119], a[28:31], v[28:31]
  s_add_u32 s69, s52, s63
  s_nop 0
  ds_read_b64_tr_b16 a[62:63], v225 offset:20488
  v_mfma_f32_16x16x32_bf16 v[32:35], a[88:91], a[32:35], v[32:35]
  buffer_load_dwordx4 v229, s[32:35], s54 offen offset:128 lds
  v_mfma_f32_16x16x32_bf16 v[36:39], a[92:95], a[32:35], v[36:39]
  ds_read_b64_tr_b16 a[64:65], v225 offset:16896
  v_mfma_f32_16x16x32_bf16 v[40:43], a[96:99], a[32:35], v[40:43]
  ds_read_b64_tr_b16 a[66:67], v225 offset:20992
  v_mfma_f32_16x16x32_bf16 v[44:47], a[100:103], a[32:35], v[44:47]
  s_add_u32 m0, s49, 0x800
  ds_read_b64_tr_b16 a[68:69], v225 offset:16904
  v_mfma_f32_16x16x32_bf16 v[48:51], a[104:107], a[32:35], v[48:51]
  s_add_u32 s54, s54, 0x20000
  ds_read_b64_tr_b16 a[70:71], v225 offset:21000
  v_mfma_f32_16x16x32_bf16 v[52:55], a[108:111], a[32:35], v[52:55]
  buffer_load_dwordx4 v229, s[32:35], s54 offen offset:0 lds
  v_mfma_f32_16x16x32_bf16 v[56:59], a[112:115], a[32:35], v[56:59]
  ds_read_b64_tr_b16 a[72:73], v225 offset:17408
  v_mfma_f32_16x16x32_bf16 v[60:63], a[116:119], a[32:35], v[60:63]
  ds_read_b64_tr_b16 a[74:75], v225 offset:21504
  v_mfma_f32_16x16x32_bf16 v[64:67], a[88:91], a[36:39], v[64:67]
  ds_read_b64_tr_b16 a[76:77], v225 offset:17416
  v_mfma_f32_16x16x32_bf16 v[68:71], a[92:95], a[36:39], v[68:71]
  s_add_u32 m0, s49, 0xb80
  ds_read_b64_tr_b16 a[78:79], v225 offset:21512
  v_mfma_f32_16x16x32_bf16 v[72:75], a[96:99], a[36:39], v[72:75]
  buffer_load_dwordx4 v229, s[32:35], s54 offen offset:128 lds
  v_mfma_f32_16x16x32_bf16 v[76:79], a[100:103], a[36:39], v[76:79]
  ds_read_b64_tr_b16 a[80:81], v225 offset:17920
  v_mfma_f32_16x16x32_bf16 v[80:83], a[104:107], a[36:39], v[80:83]
  ds_read_b64_tr_b16 a[82:83], v225 offset:22016
  v_mfma_f32_16x16x32_bf16 v[84:87], a[108:111], a[36:39], v[84:87]
  s_add_u32 m0, s49, 0x2000
  ds_read_b64_tr_b16 a[84:85], v225 offset:17928
  v_mfma_f32_16x16x32_bf16 v[88:91], a[112:115], a[36:39], v[88:91]
  s_add_u32 s55, s68, 0
  s_nop 0
  ds_read_b64_tr_b16 a[86:87], v225 offset:22024
  v_mfma_f32_16x16x32_bf16 v[92:95], a[116:119], a[36:39], v[92:95]
  buffer_load_dwordx4 v227, s[20:23], s55 offen offset:0 lds
  v_mfma_f32_16x16x32_bf16 v[96:99], a[88:91], a[40:43], v[96:99]
  ds_read_b128 a[4:7], v232 offset:17408
  v_mfma_f32_16x16x32_bf16 v[100:103], a[92:95], a[40:43], v[100:103]
  ds_read_b128 a[8:11], v232 offset:18432
  v_mfma_f32_16x16x32_bf16 v[104:107], a[96:99], a[40:43], v[104:107]
  ds_read_b128 a[12:15], v232 offset:19456
  v_mfma_f32_16x16x32_bf16 v[108:111], a[100:103], a[40:43], v[108:111]
  s_add_u32 s55, s68, 0x3c00
  ds_read_b128 a[16:19], v232 offset:20480
  v_mfma_f32_16x16x32_bf16 v[112:115], a[104:107], a[40:43], v[112:115]
  buffer_load_dwordx4 v227, s[20:23], s55 offen offset:1024 lds
  v_mfma_f32_16x16x32_bf16 v[116:119], a[108:111], a[40:43], v[116:119]
  ds_read_b128 a[20:23], v232 offset:21504
  v_mfma_f32_16x16x32_bf16 v[120:123], a[112:115], a[40:43], v[120:123]
  ds_read_b128 a[24:27], v232 offset:22528
  v_mfma_f32_16x16x32_bf16 v[124:127], a[116:119], a[40:43], v[124:127]
  v_mfma_f32_16x16x32_bf16 v[128:131], a[88:91], a[44:47], v[128:131]
  s_add_u32 s55, s68, 0x7800
  v_mfma_f32_16x16x32_bf16 v[132:135], a[92:95], a[44:47], v[132:135]
  buffer_load_dwordx4 v227, s[20:23], s55 offen offset:2048 lds
  v_mfma_f32_16x16x32_bf16 v[136:139], a[96:99], a[44:47], v[136:139]
  v_mfma_f32_16x16x32_bf16 v[140:143], a[100:103], a[44:47], v[140:143]
  v_mfma_f32_16x16x32_bf16 v[144:147], a[104:107], a[44:47], v[144:147]
  v_mfma_f32_16x16x32_bf16 v[148:151], a[108:111], a[44:47], v[148:151]
  s_add_u32 s55, s69, 0xb400
  v_mfma_f32_16x16x32_bf16 v[152:155], a[112:115], a[44:47], v[152:155]
  buffer_load_dwordx4 v227, s[20:23], s55 offen offset:3072 lds
  v_mfma_f32_16x16x32_bf16 v[156:159], a[116:119], a[44:47], v[156:159]
  v_mfma_f32_16x16x32_bf16 v[160:163], a[88:91], a[48:51], v[160:163]
  v_mfma_f32_16x16x32_bf16 v[164:167], a[92:95], a[48:51], v[164:167]
  v_mfma_f32_16x16x32_bf16 v[168:171], a[96:99], a[48:51], v[168:171]
  v_mfma_f32_16x16x32_bf16 v[172:175], a[100:103], a[48:51], v[172:175]
  v_mfma_f32_16x16x32_bf16 v[176:179], a[104:107], a[48:51], v[176:179]
  v_mfma_f32_16x16x32_bf16 v[180:183], a[108:111], a[48:51], v[180:183]
  v_mfma_f32_16x16x32_bf16 v[184:187], a[112:115], a[48:51], v[184:187]
  v_mfma_f32_16x16x32_bf16 v[188:191], a[116:119], a[48:51], v[188:191]
  v_mfma_f32_16x16x32_bf16 v[192:195], a[88:91], a[52:55], v[192:195]
  v_mfma_f32_16x16x32_bf16 v[196:199], a[92:95], a[52:55], v[196:199]
  v_mfma_f32_16x16x32_bf16 v[200:203], a[96:99], a[52:55], v[200:203]
  v_mfma_f32_16x16x32_bf16 v[204:207], a[100:103], a[52:55], v[204:207]
  v_mfma_f32_16x16x32_bf16 v[208:211], a[104:107], a[52:55], v[208:211]
  v_mfma_f32_16x16x32_bf16 v[212:215], a[108:111], a[52:55], v[212:215]
  v_mfma_f32_16x16x32_bf16 v[216:219], a[112:115], a[52:55], v[216:219]
  v_mfma_f32_16x16x32_bf16 v[220:223], a[116:119], a[52:55], v[220:223]
  s_waitcnt lgkmcnt(0)
  s_nop 0
  v_mfma_f32_16x16x32_bf16 v[0:3], a[56:59], a[0:3], v[0:3]
  s_waitcnt vmcnt(16)
  s_nop 0
  v_mfma_f32_16x16x32_bf16 v[4:7], a[60:63], a[0:3], v[4:7]
  s_barrier
  s_nop 0
  v_mfma_f32_16x16x32_bf16 v[8:11], a[64:67], a[0:3], v[8:11]
  s_add_u32 m0, s49, 0x4000
  s_add_u32 s63, s63, 64
  s_nop 0
  s_and_b32 s63, s63, 0x3ff
  s_lshl_b32 s54, s63, 12
  s_add_u32 s54, s54, s50
  ds_read_b128 a[28:31], v232 offset:32768
  v_mfma_f32_16x16x32_bf16 v[12:15], a[68:71], a[0:3], v[12:15]
  buffer_load_dwordx4 v229, s[32:35], s54 offen offset:0 lds
  v_mfma_f32_16x16x32_bf16 v[16:19], a[72:75], a[0:3], v[16:19]
  ds_read_b64_tr_b16 a[88:89], v225 offset:32768
  v_mfma_f32_16x16x32_bf16 v[20:23], a[76:79], a[0:3], v[20:23]
  s_add_u32 m0, s49, 0x4380
  ds_read_b64_tr_b16 a[90:91], v225 offset:36864
  v_mfma_f32_16x16x32_bf16 v[24:27], a[80:83], a[0:3], v[24:27]
  s_add_u32 s68, s51, s63
  s_nop 0
  ds_read_b64_tr_b16 a[92:93], v225 offset:32776
  v_mfma_f32_16x16x32_bf16 v[28:31], a[84:87], a[0:3], v[28:31]
  s_add_u32 s69, s52, s63
  s_nop 0
  ds_read_b64_tr_b16 a[94:95], v225 offset:36872
  v_mfma_f32_16x16x32_bf16 v[32:35], a[56:59], a[4:7], v[32:35]
  buffer_load_dwordx4 v229, s[32:35], s54 offen offset:128 lds
  v_mfma_f32_16x16x32_bf16 v[36:39], a[60:63], a[4:7], v[36:39]
  ds_read_b64_tr_b16 a[96:97], v225 offset:33280
  v_mfma_f32_16x16x32_bf16 v[40:43], a[64:67], a[4:7], v[40:43]
  ds_read_b64_tr_b16 a[98:99], v225 offset:37376
  v_mfma_f32_16x16x32_bf16 v[44:47], a[68:71], a[4:7], v[44:47]
  s_add_u32 m0, s49, 0x4800
  ds_read_b64_tr_b16 a[100:101], v225 offset:33288
  v_mfma_f32_16x16x32_bf16 v[48:51], a[72:75], a[4:7], v[48:51]
  s_add_u32 s54, s54, 0x20000
  ds_read_b64_tr_b16 a[102:103], v225 offset:37384
  v_mfma_f32_16x16x32_bf16 v[52:55], a[76:79], a[4:7], v[52:55]
  buffer_load_dwordx4 v229, s[32:35], s54 offen offset:0 lds
  v_mfma_f32_16x16x32_bf16 v[56:59], a[80:83], a[4:7], v[56:59]
  ds_read_b64_tr_b16 a[104:105], v225 offset:33792
  v_mfma_f32_16x16x32_bf16 v[60:63], a[84:87], a[4:7], v[60:63]
  ds_read_b64_tr_b16 a[106:107], v225 offset:37888
  v_mfma_f32_16x16x32_bf16 v[64:67], a[56:59], a[8:11], v[64:67]
  ds_read_b64_tr_b16 a[108:109], v225 offset:33800
  v_mfma_f32_16x16x32_bf16 v[68:71], a[60:63], a[8:11], v[68:71]
  s_add_u32 m0, s49, 0x4b80
  ds_read_b64_tr_b16 a[110:111], v225 offset:37896
  v_mfma_f32_16x16x32_bf16 v[72:75], a[64:67], a[8:11], v[72:75]
  buffer_load_dwordx4 v229, s[32:35], s54 offen offset:128 lds
  v_mfma_f32_16x16x32_bf16 v[76:79], a[68:71], a[8:11], v[76:79]
  ds_read_b64_tr_b16 a[112:113], v225 offset:34304
  v_mfma_f32_16x16x32_bf16 v[80:83], a[72:75], a[8:11], v[80:83]
  ds_read_b64_tr_b16 a[114:115], v225 offset:38400
  v_mfma_f32_16x16x32_bf16 v[84:87], a[76:79], a[8:11], v[84:87]
  s_add_u32 m0, s49, 0x6000
  ds_read_b64_tr_b16 a[116:117], v225 offset:34312
  v_mfma_f32_16x16x32_bf16 v[88:91], a[80:83], a[8:11], v[88:91]
  s_add_u32 s55, s68, 0
  s_nop 0
  ds_read_b64_tr_b16 a[118:119], v225 offset:38408
  v_mfma_f32_16x16x32_bf16 v[92:95], a[84:87], a[8:11], v[92:95]
  buffer_load_dwordx4 v227, s[20:23], s55 offen offset:0 lds
  v_mfma_f32_16x16x32_bf16 v[96:99], a[56:59], a[12:15], v[96:99]
  ds_read_b128 a[32:35], v232 offset:33792
  v_mfma_f32_16x16x32_bf16 v[100:103], a[60:63], a[12:15], v[100:103]
  ds_read_b128 a[36:39], v232 offset:34816
  v_mfma_f32_16x16x32_bf16 v[104:107], a[64:67], a[12:15], v[104:107]
  ds_read_b128 a[40:43], v232 offset:35840
  v_mfma_f32_16x16x32_bf16 v[108:111], a[68:71], a[12:15], v[108:111]
  s_add_u32 s55, s68, 0x3c00
  ds_read_b128 a[44:47], v232 offset:36864
  v_mfma_f32_16x16x32_bf16 v[112:115], a[72:75], a[12:15], v[112:115]
  buffer_load_dwordx4 v227, s[20:23], s55 offen offset:1024 lds
  v_mfma_f32_16x16x32_bf16 v[116:119], a[76:79], a[12:15], v[116:119]
  ds_read_b128 a[48:51], v232 offset:37888
  v_mfma_f32_16x16x32_bf16 v[120:123], a[80:83], a[12:15], v[120:123]
  ds_read_b128 a[52:55], v232 offset:38912
  v_mfma_f32_16x16x32_bf16 v[124:127], a[84:87], a[12:15], v[124:127]
  v_mfma_f32_16x16x32_bf16 v[128:131], a[56:59], a[16:19], v[128:131]
  s_add_u32 s55, s68, 0x7800
  v_mfma_f32_16x16x32_bf16 v[132:135], a[60:63], a[16:19], v[132:135]
  buffer_load_dwordx4 v227, s[20:23], s55 offen offset:2048 lds
  v_mfma_f32_16x16x32_bf16 v[136:139], a[64:67], a[16:19], v[136:139]
  v_mfma_f32_16x16x32_bf16 v[140:143], a[68:71], a[16:19], v[140:143]
  v_mfma_f32_16x16x32_bf16 v[144:147], a[72:75], a[16:19], v[144:147]
  v_mfma_f32_16x16x32_bf16 v[148:151], a[76:79], a[16:19], v[148:151]
  s_add_u32 s55, s69, 0xb400
  v_mfma_f32_16x16x32_bf16 v[152:155], a[80:83], a[16:19], v[152:155]
  buffer_load_dwordx4 v227, s[20:23], s55 offen offset:3072 lds
  v_mfma_f32_16x16x32_bf16 v[156:159], a[84:87], a[16:19], v[156:159]
  v_mfma_f32_16x16x32_bf16 v[160:163], a[56:59], a[20:23], v[160:163]
  v_mfma_f32_16x16x32_bf16 v[164:167], a[60:63], a[20:23], v[164:167]
  v_mfma_f32_16x16x32_bf16 v[168:171], a[64:67], a[20:23], v[168:171]
  v_mfma_f32_16x16x32_bf16 v[172:175], a[68:71], a[20:23], v[172:175]
  v_mfma_f32_16x16x32_bf16 v[176:179], a[72:75], a[20:23], v[176:179]
  v_mfma_f32_16x16x32_bf16 v[180:183], a[76:79], a[20:23], v[180:183]
  v_mfma_f32_16x16x32_bf16 v[184:187], a[80:83], a[20:23], v[184:187]
  v_mfma_f32_16x16x32_bf16 v[188:191], a[84:87], a[20:23], v[188:191]
  v_mfma_f32_16x16x32_bf16 v[192:195], a[56:59], a[24:27], v[192:195]
  v_mfma_f32_16x16x32_bf16 v[196:199], a[60:63], a[24:27], v[196:199]
  v_mfma_f32_16x16x32_bf16 v[200:203], a[64:67], a[24:27], v[200:203]
  v_mfma_f32_16x16x32_bf16 v[204:207], a[68:71], a[24:27], v[204:207]
  v_mfma_f32_16x16x32_bf16 v[208:211], a[72:75], a[24:27], v[208:211]
  v_mfma_f32_16x16x32_bf16 v[212:215], a[76:79], a[24:27], v[212:215]
  v_mfma_f32_16x16x32_bf16 v[216:219], a[80:83], a[24:27], v[216:219]
  v_mfma_f32_16x16x32_bf16 v[220:223], a[84:87], a[24:27], v[220:223]
  s_waitcnt lgkmcnt(0)
  s_nop 0
  v_mfma_f32_16x16x32_bf16 v[0:3], a[88:91], a[28:31], v[0:3]
  s_waitcnt vmcnt(8)
  s_nop 0
  v_mfma_f32_16x16x32_bf16 v[4:7], a[92:95], a[28:31], v[4:7]
  s_barrier
  s_nop 0
  v_mfma_f32_16x16x32_bf16 v[8:11], a[96:99], a[28:31], v[8:11]
  s_add_u32 m0, s49, 0x8000
  s_add_u32 s63, s63, 64
  s_nop 0
  s_and_b32 s63, s63, 0x3ff
  s_lshl_b32 s54, s63, 12
  s_add_u32 s54, s54, s50
  ds_read_b128 a[0:3], v232 offset:0
  v_mfma_f32_16x16x32_bf16 v[12:15], a[100:103], a[28:31], v[12:15]
  buffer_load_dwordx4 v229, s[32:35], s54 offen offset:0 lds
  v_mfma_f32_16x16x32_bf16 v[16:19], a[104:107], a[28:31], v[16:19]
  s_add_u32 m0, s49, 0x8380
  s_add_u32 s68, s51, s63
  s_nop 0
  ds_read_b64_tr_b16 a[56:57], v225 offset:0
  v_mfma_f32_16x16x32_bf16 v[20:23], a[108:111], a[28:31], v[20:23]
  s_add_u32 s69, s52, s63
  s_nop 0
  ds_read_b64_tr_b16 a[58:59], v225 offset:4096
  v_mfma_f32_16x16x32_bf16 v[24:27], a[112:115], a[28:31], v[24:27]
  buffer_load_dwordx4 v229, s[32:35], s54 offen offset:128 lds
  v_mfma_f32_16x16x32_bf16 v[28:31], a[116:119], a[28:31], v[28:31]
  s_add_u32 m0, s49, 0x8800
  ds_read_b64_tr_b16 a[60:61], v225 offset:8
  v_mfma_f32_16x16x32_bf16 v[32:35], a[88:91], a[32:35], v[32:35]
  s_add_u32 s54, s54, 0x20000
  ds_read_b64_tr_b16 a[62:63], v225 offset:4104
  v_mfma_f32_16x16x32_bf16 v[36:39], a[92:95], a[32:35], v[36:39]
  buffer_load_dwordx4 v229, s[32:35], s54 offen offset:0 lds
  v_mfma_f32_16x16x32_bf16 v[40:43], a[96:99], a[32:35], v[40:43]
  ds_read_b64_tr_b16 a[64:65], v225 offset:512
  v_mfma_f32_16x16x32_bf16 v[44:47], a[100:103], a[32:35], v[44:47]
  s_add_u32 m0, s49, 0x8b80
  ds_read_b64_tr_b16 a[66:67], v225 offset:4608
  v_mfma_f32_16x16x32_bf16 v[48:51], a[104:107], a[32:35], v[48:51]
  buffer_load_dwordx4 v229, s[32:35], s54 offen offset:128 lds
  v_mfma_f32_16x16x32_bf16 v[52:55], a[108:111], a[32:35], v[52:55]
  s_add_u32 m0, s49, 0xa000
  ds_read_b64_tr_b16 a[68:69], v225 offset:520
  v_mfma_f32_16x16x32_bf16 v[56:59], a[112:115], a[32:35], v[56:59]
  s_add_u32 s55, s68, 0
  s_nop 0
  ds_read_b64_tr_b16 a[70:71], v225 offset:4616
  v_mfma_f32_16x16x32_bf16 v[60:63], a[116:119], a[32:35], v[60:63]
  buffer_load_dwordx4 v227, s[20:23], s55 offen offset:0 lds
  v_mfma_f32_16x16x32_bf16 v[64:67], a[88:91], a[36:39], v[64:67]
  ds_read_b64_tr_b16 a[72:73], v225 offset:1024
  v_mfma_f32_16x16x32_bf16 v[68:71], a[92:95], a[36:39], v[68:71]
  s_add_u32 s55, s68, 0x3c00
  ds_read_b64_tr_b16 a[74:75], v225 offset:5120
  v_mfma_f32_16x16x32_bf16 v[72:75], a[96:99], a[36:39], v[72:75]
  buffer_load_dwordx4 v227, s[20:23], s55 offen offset:1024 lds
  v_mfma_f32_16x16x32_bf16 v[76:79], a[100:103], a[36:39], v[76:79]
  ds_read_b64_tr_b16 a[76:77], v225 offset:1032
  v_mfma_f32_16x16x32_bf16 v[80:83], a[104:107], a[36:39], v[80:83]
  s_add_u32 s55, s68, 0x7800
  ds_read_b64_tr_b16 a[78:79], v225 offset:5128
  v_mfma_f32_16x16x32_bf16 v[84:87], a[108:111], a[36:39], v[84:87]
  buffer_load_dwordx4 v227, s[20:23], s55 offen offset:2048 lds
  v_mfma_f32_16x16x32_bf16 v[88:91], a[112:115], a[36:39], v[88:91]
  ds_read_b64_tr_b16 a[80:81], v225 offset:1536
  v_mfma_f32_16x16x32_bf16 v[92:95], a[116:119], a[36:39], v[92:95]
  s_add_u32 s55, s69, 0xb400
  ds_read_b64_tr_b16 a[82:83], v225 offset:5632
  v_mfma_f32_16x16x32_bf16 v[96:99], a[88:91], a[40:43], v[96:99]
  buffer_load_dwordx4 v227, s[20:23], s55 offen offset:3072 lds
  v_mfma_f32_16x16x32_bf16 v[100:103], a[92:95], a[40:43], v[100:103]
  s_add_u32 s66, s53, 0x4000
  ds_read_b64_tr_b16 a[84:85], v225 offset:1544
  v_mfma_f32_16x16x32_bf16 v[104:107], a[96:99], a[40:43], v[104:107]
  s_and_b32 s66, s66, 0x1ffff
  ds_read_b64_tr_b16 a[86:87], v225 offset:5640
  v_mfma_f32_16x16x32_bf16 v[108:111], a[100:103], a[40:43], v[108:111]
  buffer_load_dwordx4 a[120:123], v226, s[24:27], s66 offen offset:0 nt
  v_mfma_f32_16x16x32_bf16 v[112:115], a[104:107], a[40:43], v[112:115]
  ds_read_b128 a[4:7], v232 offset:1024
  v_mfma_f32_16x16x32_bf16 v[116:119], a[108:111], a[40:43], v[116:119]
  ds_read_b128 a[8:11], v232 offset:2048
  v_mfma_f32_16x16x32_bf16 v[120:123], a[112:115], a[40:43], v[120:123]
  buffer_load_dwordx4 a[124:127], v226, s[24:27], s66 offen offset:128 nt
  v_mfma_f32_16x16x32_bf16 v[124:127], a[116:119], a[40:43], v[124:127]
  ds_read_b128 a[12:15], v232 offset:3072
  v_mfma_f32_16x16x32_bf16 v[128:131], a[88:91], a[44:47], v[128:131]
  ds_read_b128 a[16:19], v232 offset:4096
  v_mfma_f32_16x16x32_bf16 v[132:135], a[92:95], a[44:47], v[132:135]
  buffer_load_dwordx4 a[128:131], v226, s[24:27], s66 offen offset:2048 nt
  v_mfma_f32_16x16x32_bf16 v[136:139], a[96:99], a[44:47], v[136:139]
  ds_read_b128 a[20:23], v232 offset:5120
  v_mfma_f32_16x16x32_bf16 v[140:143], a[100:103], a[44:47], v[140:143]
  ds_read_b128 a[24:27], v232 offset:6144
  v_mfma_f32_16x16x32_bf16 v[144:147], a[104:107], a[44:47], v[144:147]
  buffer_load_dwordx4 a[132:135], v226, s[24:27], s66 offen offset:2176 nt
  v_mfma_f32_16x16x32_bf16 v[148:151], a[108:111], a[44:47], v[148:151]
  v_mfma_f32_16x16x32_bf16 v[152:155], a[112:115], a[44:47], v[152:155]
  v_mfma_f32_16x16x32_bf16 v[156:159], a[116:119], a[44:47], v[156:159]
  buffer_load_dwordx4 a[136:139], v228, s[28:31], s66 offen offset:0 nt
  v_mfma_f32_16x16x32_bf16 v[160:163], a[88:91], a[48:51], v[160:163]
  v_mfma_f32_16x16x32_bf16 v[164:167], a[92:95], a[48:51], v[164:167]
  v_mfma_f32_16x16x32_bf16 v[168:171], a[96:99], a[48:51], v[168:171]
  buffer_load_dwordx4 a[140:143], v228, s[28:31], s66 offen offset:128 nt
  v_mfma_f32_16x16x32_bf16 v[172:175], a[100:103], a[48:51], v[172:175]
  v_mfma_f32_16x16x32_bf16 v[176:179], a[104:107], a[48:51], v[176:179]
  v_mfma_f32_16x16x32_bf16 v[180:183], a[108:111], a[48:51], v[180:183]
  buffer_load_dwordx4 a[144:147], v228, s[28:31], s66 offen offset:2048 nt
  v_mfma_f32_16x16x32_bf16 v[184:187], a[112:115], a[48:51], v[184:187]
  v_mfma_f32_16x16x32_bf16 v[188:191], a[116:119], a[48:51], v[188:191]
  v_mfma_f32_16x16x32_bf16 v[192:195], a[88:91], a[52:55], v[192:195]
  buffer_load_dwordx4 a[148:151], v228, s[28:31], s66 offen offset:2176 nt
  v_mfma_f32_16x16x32_bf16 v[196:199], a[92:95], a[52:55], v[196:199]
  v_mfma_f32_16x16x32_bf16 v[200:203], a[96:99], a[52:55], v[200:203]
  v_mfma_f32_16x16x32_bf16 v[204:207], a[100:103], a[52:55], v[204:207]
  v_mfma_f32_16x16x32_bf16 v[208:211], a[104:107], a[52:55], v[208:211]
  v_mfma_f32_16x16x32_bf16 v[212:215], a[108:111], a[52:55], v[212:215]
  v_mfma_f32_16x16x32_bf16 v[216:219], a[112:115], a[52:55], v[216:219]
  v_mfma_f32_16x16x32_bf16 v[220:223], a[116:119], a[52:55], v[220:223]
  s_waitcnt lgkmcnt(0)
  s_nop 0
  v_mfma_f32_16x16x32_bf16 v[0:3], a[56:59], a[0:3], v[0:3]
  s_waitcnt vmcnt(16)
  s_nop 0
  v_mfma_f32_16x16x32_bf16 v[4:7], a[60:63], a[0:3], v[4:7]
  s_barrier
  s_nop 0
  v_mfma_f32_16x16x32_bf16 v[8:11], a[64:67], a[0:3], v[8:11]
  s_add_u32 m0, s49, 0
  s_add_u32 s63, s63, 64
  s_and_b32 s63, s63, 0x3ff
  s_lshl_b32 s54, s63, 12
  s_add_u32 s54, s54, s50
  ds_read_b128 a[28:31], v232 offset:16384
  v_mfma_f32_16x16x32_bf16 v[12:15], a[68:71], a[0:3], v[12:15]
  buffer_load_dwordx4 v229, s[32:35], s54 offen offset:0 lds
  v_mfma_f32_16x16x32_bf16 v[16:19], a[72:75], a[0:3], v[16:19]
  ds_read_b64_tr_b16 a[88:89], v225 offset:16384
  v_mfma_f32_16x16x32_bf16 v[20:23], a[76:79], a[0:3], v[20:23]
  s_add_u32 m0, s49, 0x380
  ds_read_b64_tr_b16 a[90:91], v225 offset:20480
  v_mfma_f32_16x16x32_bf16 v[24:27], a[80:83], a[0:3], v[24:27]
  s_add_u32 s68, s51, s63
  s_nop 0
  ds_read_b64_tr_b16 a[92:93], v225 offset:16392
  v_mfma_f32_16x16x32_bf16 v[28:31], a[84:87], a[0:3], v[28:31]
  s_add_u32 s69, s52, s63
  s_nop 0
  ds_read_b64_tr_b16 a[94:95], v225 offset:20488
  v_mfma_f32_16x16x32_bf16 v[32:35], a[56:59], a[4:7], v[32:35]
  buffer_load_dwordx4 v229, s[32:35], s54 offen offset:128 lds
  v_mfma_f32_16x16x32_bf16 v[36:39], a[60:63], a[4:7], v[36:39]
  ds_read_b64_tr_b16 a[96:97], v225 offset:16896
  v_mfma_f32_16x16x32_bf16 v[40:43], a[64:67], a[4:7], v[40:43]
  ds_read_b64_tr_b16 a[98:99], v225 offset:20992
  v_mfma_f32_16x16x32_bf16 v[44:47], a[68:71], a[4:7], v[44:47]
  s_add_u32 m0, s49, 0x800
  ds_read_b64_tr_b16 a[100:101], v225 offset:16904
  v_mfma_f32_16x16x32_bf16 v[48:51], a[72:75], a[4:7], v[48:51]
  s_add_u32 s54, s54, 0x20000
  ds_read_b64_tr_b16 a[102:103], v225 offset:21000
  v_mfma_f32_16x16x32_bf16 v[52:55], a[76:79], a[4:7], v[52:55]
  buffer_load_dwordx4 v229, s[32:35], s54 offen offset:0 lds
  v_mfma_f32_16x16x32_bf16 v[56:59], a[80:83], a[4:7], v[56:59]
  ds_read_b64_tr_b16 a[104:105], v225 offset:17408
  v_mfma_f32_16x16x32_bf16 v[60:63], a[84:87], a[4:7], v[60:63]
  ds_read_b64_tr_b16 a[106:107], v225 offset:21504
  v_mfma_f32_16x16x32_bf16 v[64:67], a[56:59], a[8:11], v[64:67]
  ds_read_b64_tr_b16 a[108:109], v225 offset:17416
  v_mfma_f32_16x16x32_bf16 v[68:71], a[60:63], a[8:11], v[68:71]
  s_add_u32 m0, s49, 0xb80
  ds_read_b64_tr_b16 a[110:111], v225 offset:21512
  v_mfma_f32_16x16x32_bf16 v[72:75], a[64:67], a[8:11], v[72:75]
  buffer_load_dwordx4 v229, s[32:35], s54 offen offset:128 lds
  v_mfma_f32_16x16x32_bf16 v[76:79], a[68:71], a[8:11], v[76:79]
  ds_read_b64_tr_b16 a[112:113], v225 offset:17920
  v_mfma_f32_16x16x32_bf16 v[80:83], a[72:75], a[8:11], v[80:83]
  ds_read_b64_tr_b16 a[114:115], v225 offset:22016
  v_mfma_f32_16x16x32_bf16 v[84:87], a[76:79], a[8:11], v[84:87]
  s_add_u32 m0, s49, 0x2000
  ds_read_b64_tr_b16 a[116:117], v225 offset:17928
  v_mfma_f32_16x16x32_bf16 v[88:91], a[80:83], a[8:11], v[88:91]
  s_add_u32 s55, s68, 0
  s_nop 0
  ds_read_b64_tr_b16 a[118:119], v225 offset:22024
  v_mfma_f32_16x16x32_bf16 v[92:95], a[84:87], a[8:11], v[92:95]
  buffer_load_dwordx4 v227, s[20:23], s55 offen offset:0 lds
  v_mfma_f32_16x16x32_bf16 v[96:99], a[56:59], a[12:15], v[96:99]
  ds_read_b128 a[32:35], v232 offset:17408
  v_mfma_f32_16x16x32_bf16 v[100:103], a[60:63], a[12:15], v[100:103]
  ds_read_b128 a[36:39], v232 offset:18432
  v_mfma_f32_16x16x32_bf16 v[104:107], a[64:67], a[12:15], v[104:107]
  ds_read_b128 a[40:43], v232 offset:19456
  v_mfma_f32_16x16x32_bf16 v[108:111], a[68:71], a[12:15], v[108:111]
  s_add_u32 s55, s68, 0x3c00
  ds_read_b128 a[44:47], v232 offset:20480
  v_mfma_f32_16x16x32_bf16 v[112:115], a[72:75], a[12:15], v[112:115]
  buffer_load_dwordx4 v227, s[20:23], s55 offen offset:1024 lds
  v_mfma_f32_16x16x32_bf16 v[116:119], a[76:79], a[12:15], v[116:119]
  ds_read_b128 a[48:51], v232 offset:21504
  v_mfma_f32_16x16x32_bf16 v[120:123], a[80:83], a[12:15], v[120:123]
  ds_read_b128 a[52:55], v232 offset:22528
  v_mfma_f32_16x16x32_bf16 v[124:127], a[84:87], a[12:15], v[124:127]
  v_mfma_f32_16x16x32_bf16 v[128:131], a[56:59], a[16:19], v[128:131]
  s_add_u32 s55, s68, 0x7800
  v_mfma_f32_16x16x32_bf16 v[132:135], a[60:63], a[16:19], v[132:135]
  buffer_load_dwordx4 v227, s[20:23], s55 offen offset:2048 lds
  v_mfma_f32_16x16x32_bf16 v[136:139], a[64:67], a[16:19], v[136:139]
  v_mfma_f32_16x16x32_bf16 v[140:143], a[68:71], a[16:19], v[140:143]
  v_mfma_f32_16x16x32_bf16 v[144:147], a[72:75], a[16:19], v[144:147]
  v_mfma_f32_16x16x32_bf16 v[148:151], a[76:79], a[16:19], v[148:151]
  s_add_u32 s55, s69, 0xb400
  v_mfma_f32_16x16x32_bf16 v[152:155], a[80:83], a[16:19], v[152:155]
  buffer_load_dwordx4 v227, s[20:23], s55 offen offset:3072 lds
  v_mfma_f32_16x16x32_bf16 v[156:159], a[84:87], a[16:19], v[156:159]
  v_mfma_f32_16x16x32_bf16 v[160:163], a[56:59], a[20:23], v[160:163]
  v_mfma_f32_16x16x32_bf16 v[164:167], a[60:63], a[20:23], v[164:167]
  v_mfma_f32_16x16x32_bf16 v[168:171], a[64:67], a[20:23], v[168:171]
  v_mfma_f32_16x16x32_bf16 v[172:175], a[68:71], a[20:23], v[172:175]
  v_mfma_f32_16x16x32_bf16 v[176:179], a[72:75], a[20:23], v[176:179]
  v_mfma_f32_16x16x32_bf16 v[180:183], a[76:79], a[20:23], v[180:183]
  v_mfma_f32_16x16x32_bf16 v[184:187], a[80:83], a[20:23], v[184:187]
  v_mfma_f32_16x16x32_bf16 v[188:191], a[84:87], a[20:23], v[188:191]
  v_mfma_f32_16x16x32_bf16 v[192:195], a[56:59], a[24:27], v[192:195]
  v_mfma_f32_16x16x32_bf16 v[196:199], a[60:63], a[24:27], v[196:199]
  v_mfma_f32_16x16x32_bf16 v[200:203], a[64:67], a[24:27], v[200:203]
  v_mfma_f32_16x16x32_bf16 v[204:207], a[68:71], a[24:27], v[204:207]
  v_mfma_f32_16x16x32_bf16 v[208:211], a[72:75], a[24:27], v[208:211]
  v_mfma_f32_16x16x32_bf16 v[212:215], a[76:79], a[24:27], v[212:215]
  v_mfma_f32_16x16x32_bf16 v[216:219], a[80:83], a[24:27], v[216:219]
  v_mfma_f32_16x16x32_bf16 v[220:223], a[84:87], a[24:27], v[220:223]
  s_waitcnt lgkmcnt(0)
  s_nop 0
  v_mfma_f32_16x16x32_bf16 v[0:3], a[88:91], a[28:31], v[0:3]
  s_waitcnt vmcnt(16)
  s_nop 0
  v_mfma_f32_16x16x32_bf16 v[4:7], a[92:95], a[28:31], v[4:7]
  s_barrier
  s_nop 0
  v_mfma_f32_16x16x32_bf16 v[8:11], a[96:99], a[28:31], v[8:11]
  s_add_u32 m0, s49, 0x4000
  s_add_u32 s63, s63, 64
  s_nop 0
  s_and_b32 s63, s63, 0x3ff
  s_lshl_b32 s54, s63, 12
  s_add_u32 s54, s54, s50
  ds_read_b128 a[0:3], v232 offset:32768
  v_mfma_f32_16x16x32_bf16 v[12:15], a[100:103], a[28:31], v[12:15]
  buffer_load_dwordx4 v229, s[32:35], s54 offen offset:0 lds
  v_mfma_f32_16x16x32_bf16 v[16:19], a[104:107], a[28:31], v[16:19]
  ds_read_b64_tr_b16 a[56:57], v225 offset:32768
  v_mfma_f32_16x16x32_bf16 v[20:23], a[108:111], a[28:31], v[20:23]
  s_add_u32 m0, s49, 0x4380
  ds_read_b64_tr_b16 a[58:59], v225 offset:36864
  v_mfma_f32_16x16x32_bf16 v[24:27], a[112:115], a[28:31], v[24:27]
  s_add_u32 s68, s51, s63
  s_nop 0
  ds_read_b64_tr_b16 a[60:61], v225 offset:32776
  v_mfma_f32_16x16x32_bf16 v[28:31], a[116:119], a[28:31], v[28:31]
  s_add_u32 s69, s52, s63
  s_nop 0
  ds_read_b64_tr_b16 a[62:63], v225 offset:36872
  v_mfma_f32_16x16x32_bf16 v[32:35], a[88:91], a[32:35], v[32:35]
  buffer_load_dwordx4 v229, s[32:35], s54 offen offset:128 lds
  v_mfma_f32_16x16x32_bf16 v[36:39], a[92:95], a[32:35], v[36:39]
  ds_read_b64_tr_b16 a[64:65], v225 offset:33280
  v_mfma_f32_16x16x32_bf16 v[40:43], a[96:99], a[32:35], v[40:43]
  ds_read_b64_tr_b16 a[66:67], v225 offset:37376
  v_mfma_f32_16x16x32_bf16 v[44:47], a[100:103], a[32:35], v[44:47]
  s_add_u32 m0, s49, 0x4800
  ds_read_b64_tr_b16 a[68:69], v225 offset:33288
  v_mfma_f32_16x16x32_bf16 v[48:51], a[104:107], a[32:35], v[48:51]
  s_add_u32 s54, s54, 0x20000
  ds_read_b64_tr_b16 a[70:71], v225 offset:37384
  v_mfma_f32_16x16x32_bf16 v[52:55], a[108:111], a[32:35], v[52:55]
  buffer_load_dwordx4 v229, s[32:35], s54 offen offset:0 lds
  v_mfma_f32_16x16x32_bf16 v[56:59], a[112:115], a[32:35], v[56:59]
  ds_read_b64_tr_b16 a[72:73], v225 offset:33792
  v_mfma_f32_16x16x32_bf16 v[60:63], a[116:119], a[32:35], v[60:63]
  ds_read_b64_tr_b16 a[74:75], v225 offset:37888
  v_mfma_f32_16x16x32_bf16 v[64:67], a[88:91], a[36:39], v[64:67]
  ds_read_b64_tr_b16 a[76:77], v225 offset:33800
  v_mfma_f32_16x16x32_bf16 v[68:71], a[92:95], a[36:39], v[68:71]
  s_add_u32 m0, s49, 0x4b80
  ds_read_b64_tr_b16 a[78:79], v225 offset:37896
  v_mfma_f32_16x16x32_bf16 v[72:75], a[96:99], a[36:39], v[72:75]
  buffer_load_dwordx4 v229, s[32:35], s54 offen offset:128 lds
  v_mfma_f32_16x16x32_bf16 v[76:79], a[100:103], a[36:39], v[76:79]
  ds_read_b64_tr_b16 a[80:81], v225 offset:34304
  v_mfma_f32_16x16x32_bf16 v[80:83], a[104:107], a[36:39], v[80:83]
  ds_read_b64_tr_b16 a[82:83], v225 offset:38400
  v_mfma_f32_16x16x32_bf16 v[84:87], a[108:111], a[36:39], v[84:87]
  s_add_u32 m0, s49, 0x6000
  ds_read_b64_tr_b16 a[84:85], v225 offset:34312
  v_mfma_f32_16x16x32_bf16 v[88:91], a[112:115], a[36:39], v[88:91]
  s_add_u32 s55, s68, 0
  s_nop 0
  ds_read_b64_tr_b16 a[86:87], v225 offset:38408
  v_mfma_f32_16x16x32_bf16 v[92:95], a[116:119], a[36:39], v[92:95]
  buffer_load_dwordx4 v227, s[20:23], s55 offen offset:0 lds
  v_mfma_f32_16x16x32_bf16 v[96:99], a[88:91], a[40:43], v[96:99]
  ds_read_b128 a[4:7], v232 offset:33792
  v_mfma_f32_16x16x32_bf16 v[100:103], a[92:95], a[40:43], v[100:103]
  ds_read_b128 a[8:11], v232 offset:34816
  v_mfma_f32_16x16x32_bf16 v[104:107], a[96:99], a[40:43], v[104:107]
  ds_read_b128 a[12:15], v232 offset:35840
  v_mfma_f32_16x16x32_bf16 v[108:111], a[100:103], a[40:43], v[108:111]
  s_add_u32 s55, s68, 0x3c00
  ds_read_b128 a[16:19], v232 offset:36864
  v_mfma_f32_16x16x32_bf16 v[112:115], a[104:107], a[40:43], v[112:115]
  buffer_load_dwordx4 v227, s[20:23], s55 offen offset:1024 lds
  v_mfma_f32_16x16x32_bf16 v[116:119], a[108:111], a[40:43], v[116:119]
  ds_read_b128 a[20:23], v232 offset:37888
  v_mfma_f32_16x16x32_bf16 v[120:123], a[112:115], a[40:43], v[120:123]
  ds_read_b128 a[24:27], v232 offset:38912
  v_mfma_f32_16x16x32_bf16 v[124:127], a[116:119], a[40:43], v[124:127]
  v_mfma_f32_16x16x32_bf16 v[128:131], a[88:91], a[44:47], v[128:131]
  s_add_u32 s55, s68, 0x7800
  v_mfma_f32_16x16x32_bf16 v[132:135], a[92:95], a[44:47], v[132:135]
  buffer_load_dwordx4 v227, s[20:23], s55 offen offset:2048 lds
  v_mfma_f32_16x16x32_bf16 v[136:139], a[96:99], a[44:47], v[136:139]
  v_mfma_f32_16x16x32_bf16 v[140:143], a[100:103], a[44:47], v[140:143]
  v_mfma_f32_16x16x32_bf16 v[144:147], a[104:107], a[44:47], v[144:147]
  v_mfma_f32_16x16x32_bf16 v[148:151], a[108:111], a[44:47], v[148:151]
  s_add_u32 s55, s69, 0xb400
  v_mfma_f32_16x16x32_bf16 v[152:155], a[112:115], a[44:47], v[152:155]
  buffer_load_dwordx4 v227, s[20:23], s55 offen offset:3072 lds
  v_mfma_f32_16x16x32_bf16 v[156:159], a[116:119], a[44:47], v[156:159]
  v_mfma_f32_16x16x32_bf16 v[160:163], a[88:91], a[48:51], v[160:163]
  v_mfma_f32_16x16x32_bf16 v[164:167], a[92:95], a[48:51], v[164:167]
  v_mfma_f32_16x16x32_bf16 v[168:171], a[96:99], a[48:51], v[168:171]
  v_mfma_f32_16x16x32_bf16 v[172:175], a[100:103], a[48:51], v[172:175]
  v_mfma_f32_16x16x32_bf16 v[176:179], a[104:107], a[48:51], v[176:179]
  v_mfma_f32_16x16x32_bf16 v[180:183], a[108:111], a[48:51], v[180:183]
  v_mfma_f32_16x16x32_bf16 v[184:187], a[112:115], a[48:51], v[184:187]
  v_mfma_f32_16x16x32_bf16 v[188:191], a[116:119], a[48:51], v[188:191]
  v_mfma_f32_16x16x32_bf16 v[192:195], a[88:91], a[52:55], v[192:195]
  v_mfma_f32_16x16x32_bf16 v[196:199], a[92:95], a[52:55], v[196:199]
  v_mfma_f32_16x16x32_bf16 v[200:203], a[96:99], a[52:55], v[200:203]
  v_mfma_f32_16x16x32_bf16 v[204:207], a[100:103], a[52:55], v[204:207]
  v_mfma_f32_16x16x32_bf16 v[208:211], a[104:107], a[52:55], v[208:211]
  v_mfma_f32_16x16x32_bf16 v[212:215], a[108:111], a[52:55], v[212:215]
  v_mfma_f32_16x16x32_bf16 v[216:219], a[112:115], a[52:55], v[216:219]
  v_mfma_f32_16x16x32_bf16 v[220:223], a[116:119], a[52:55], v[220:223]
  s_waitcnt lgkmcnt(0)
  s_nop 0
  v_mfma_f32_16x16x32_bf16 v[0:3], a[56:59], a[0:3], v[0:3]
  s_waitcnt vmcnt(8)
  s_nop 0
  v_mfma_f32_16x16x32_bf16 v[4:7], a[60:63], a[0:3], v[4:7]
  s_barrier
  s_nop 0
  v_mfma_f32_16x16x32_bf16 v[8:11], a[64:67], a[0:3], v[8:11]
  s_add_u32 m0, s49, 0x8000
  s_add_u32 s63, s63, 64
  s_nop 0
  s_and_b32 s63, s63, 0x3ff
  s_lshl_b32 s54, s63, 12
  s_add_u32 s54, s54, s50
  ds_read_b128 a[28:31], v232 offset:0
  v_mfma_f32_16x16x32_bf16 v[12:15], a[68:71], a[0:3], v[12:15]
  buffer_load_dwordx4 v229, s[32:35], s54 offen offset:0 lds
  v_mfma_f32_16x16x32_bf16 v[16:19], a[72:75], a[0:3], v[16:19]
  s_add_u32 m0, s49, 0x8380
  s_add_u32 s68, s51, s63
  s_nop 0
  ds_read_b64_tr_b16 a[88:89], v225 offset:0
  v_mfma_f32_16x16x32_bf16 v[20:23], a[76:79], a[0:3], v[20:23]
  s_add_u32 s69, s52, s63
  s_nop 0
  ds_read_b64_tr_b16 a[90:91], v225 offset:4096
  v_mfma_f32_16x16x32_bf16 v[24:27], a[80:83], a[0:3], v[24:27]
  buffer_load_dwordx4 v229, s[32:35], s54 offen offset:128 lds
  v_mfma_f32_16x16x32_bf16 v[28:31], a[84:87], a[0:3], v[28:31]
  s_add_u32 m0, s49, 0x8800
  ds_read_b64_tr_b16 a[92:93], v225 offset:8
  v_mfma_f32_16x16x32_bf16 v[32:35], a[56:59], a[4:7], v[32:35]
  s_add_u32 s54, s54, 0x20000
  ds_read_b64_tr_b16 a[94:95], v225 offset:4104
  v_mfma_f32_16x16x32_bf16 v[36:39], a[60:63], a[4:7], v[36:39]
  buffer_load_dwordx4 v229, s[32:35], s54 offen offset:0 lds
  v_mfma_f32_16x16x32_bf16 v[40:43], a[64:67], a[4:7], v[40:43]
  ds_read_b64_tr_b16 a[96:97], v225 offset:512
  v_mfma_f32_16x16x32_bf16 v[44:47], a[68:71], a[4:7], v[44:47]
  s_add_u32 m0, s49, 0x8b80
  ds_read_b64_tr_b16 a[98:99], v225 offset:4608
  v_mfma_f32_16x16x32_bf16 v[48:51], a[72:75], a[4:7], v[48:51]
  buffer_load_dwordx4 v229, s[32:35], s54 offen offset:128 lds
  v_mfma_f32_16x16x32_bf16 v[52:55], a[76:79], a[4:7], v[52:55]
  s_add_u32 m0, s49, 0xa000
  ds_read_b64_tr_b16 a[100:101], v225 offset:520
  v_mfma_f32_16x16x32_bf16 v[56:59], a[80:83], a[4:7], v[56:59]
  s_add_u32 s55, s68, 0
  s_nop 0
  ds_read_b64_tr_b16 a[102:103], v225 offset:4616
  v_mfma_f32_16x16x32_bf16 v[60:63], a[84:87], a[4:7], v[60:63]
  buffer_load_dwordx4 v227, s[20:23], s55 offen offset:0 lds
  v_mfma_f32_16x16x32_bf16 v[64:67], a[56:59], a[8:11], v[64:67]
  ds_read_b64_tr_b16 a[104:105], v225 offset:1024
  v_mfma_f32_16x16x32_bf16 v[68:71], a[60:63], a[8:11], v[68:71]
  s_add_u32 s55, s68, 0x3c00
  ds_read_b64_tr_b16 a[106:107], v225 offset:5120
  v_mfma_f32_16x16x32_bf16 v[72:75], a[64:67], a[8:11], v[72:75]
  buffer_load_dwordx4 v227, s[20:23], s55 offen offset:1024 lds
  v_mfma_f32_16x16x32_bf16 v[76:79], a[68:71], a[8:11], v[76:79]
  ds_read_b64_tr_b16 a[108:109], v225 offset:1032
  v_mfma_f32_16x16x32_bf16 v[80:83], a[72:75], a[8:11], v[80:83]
  s_add_u32 s55, s68, 0x7800
  ds_read_b64_tr_b16 a[110:111], v225 offset:5128
  v_mfma_f32_16x16x32_bf16 v[84:87], a[76:79], a[8:11], v[84:87]
  buffer_load_dwordx4 v227, s[20:23], s55 offen offset:2048 lds
  v_mfma_f32_16x16x32_bf16 v[88:91], a[80:83], a[8:11], v[88:91]
  ds_read_b64_tr_b16 a[112:113], v225 offset:1536
  v_mfma_f32_16x16x32_bf16 v[92:95], a[84:87], a[8:11], v[92:95]
  s_add_u32 s55, s69, 0xb400
  ds_read_b64_tr_b16 a[114:115], v225 offset:5632
  v_mfma_f32_16x16x32_bf16 v[96:99], a[56:59], a[12:15], v[96:99]
  buffer_load_dwordx4 v227, s[20:23], s55 offen offset:3072 lds
  v_mfma_f32_16x16x32_bf16 v[100:103], a[60:63], a[12:15], v[100:103]
  s_add_u32 s66, s53, 0x6000
  ds_read_b64_tr_b16 a[116:117], v225 offset:1544
  v_mfma_f32_16x16x32_bf16 v[104:107], a[64:67], a[12:15], v[104:107]
  s_and_b32 s66, s66, 0x1ffff
  ds_read_b64_tr_b16 a[118:119], v225 offset:5640
  v_mfma_f32_16x16x32_bf16 v[108:111], a[68:71], a[12:15], v[108:111]
  buffer_load_dwordx4 a[152:155], v226, s[24:27], s66 offen offset:0 nt
  v_mfma_f32_16x16x32_bf16 v[112:115], a[72:75], a[12:15], v[112:115]
  ds_read_b128 a[32:35], v232 offset:1024
  v_mfma_f32_16x16x32_bf16 v[116:119], a[76:79], a[12:15], v[116:119]
  ds_read_b128 a[36:39], v232 offset:2048
  v_mfma_f32_16x16x32_bf16 v[120:123], a[80:83], a[12:15], v[120:123]
  buffer_load_dwordx4 a[156:159], v226, s[24:27], s66 offen offset:128 nt
  v_mfma_f32_16x16x32_bf16 v[124:127], a[84:87], a[12:15], v[124:127]
  ds_read_b128 a[40:43], v232 offset:3072
  v_mfma_f32_16x16x32_bf16 v[128:131], a[56:59], a[16:19], v[128:131]
  ds_read_b128 a[44:47], v232 offset:4096
  v_mfma_f32_16x16x32_bf16 v[132:135], a[60:63], a[16:19], v[132:135]
  buffer_load_dwordx4 a[160:163], v226, s[24:27], s66 offen offset:2048 nt
  v_mfma_f32_16x16x32_bf16 v[136:139], a[64:67], a[16:19], v[136:139]
  ds_read_b128 a[48:51], v232 offset:5120
  v_mfma_f32_16x16x32_bf16 v[140:143], a[68:71], a[16:19], v[140:143]
  ds_read_b128 a[52:55], v232 offset:6144
  v_mfma_f32_16x16x32_bf16 v[144:147], a[72:75], a[16:19], v[144:147]
  buffer_load_dwordx4 a[164:167], v226, s[24:27], s66 offen offset:2176 nt
  v_mfma_f32_16x16x32_bf16 v[148:151], a[76:79], a[16:19], v[148:151]
  v_mfma_f32_16x16x32_bf16 v[152:155], a[80:83], a[16:19], v[152:155]
  v_mfma_f32_16x16x32_bf16 v[156:159], a[84:87], a[16:19], v[156:159]
  buffer_load_dwordx4 a[168:171], v228, s[28:31], s66 offen offset:0 nt
  v_mfma_f32_16x16x32_bf16 v[160:163], a[56:59], a[20:23], v[160:163]
  v_mfma_f32_16x16x32_bf16 v[164:167], a[60:63], a[20:23], v[164:167]
  v_mfma_f32_16x16x32_bf16 v[168:171], a[64:67], a[20:23], v[168:171]
  buffer_load_dwordx4 a[172:175], v228, s[28:31], s66 offen offset:128 nt
  v_mfma_f32_16x16x32_bf16 v[172:175], a[68:71], a[20:23], v[172:175]
  v_mfma_f32_16x16x32_bf16 v[176:179], a[72:75], a[20:23], v[176:179]
  v_mfma_f32_16x16x32_bf16 v[180:183], a[76:79], a[20:23], v[180:183]
  buffer_load_dwordx4 a[176:179], v228, s[28:31], s66 offen offset:2048 nt
  v_mfma_f32_16x16x32_bf16 v[184:187], a[80:83], a[20:23], v[184:187]
  v_mfma_f32_16x16x32_bf16 v[188:191], a[84:87], a[20:23], v[188:191]
  v_mfma_f32_16x16x32_bf16 v[192:195], a[56:59], a[24:27], v[192:195]
  buffer_load_dwordx4 a[180:183], v228, s[28:31], s66 offen offset:2176 nt
  v_mfma_f32_16x16x32_bf16 v[196:199], a[60:63], a[24:27], v[196:199]
  v_mfma_f32_16x16x32_bf16 v[200:203], a[64:67], a[24:27], v[200:203]
  v_mfma_f32_16x16x32_bf16 v[204:207], a[68:71], a[24:27], v[204:207]
  v_mfma_f32_16x16x32_bf16 v[208:211], a[72:75], a[24:27], v[208:211]
  v_mfma_f32_16x16x32_bf16 v[212:215], a[76:79], a[24:27], v[212:215]
  v_mfma_f32_16x16x32_bf16 v[216:219], a[80:83], a[24:27], v[216:219]
  v_mfma_f32_16x16x32_bf16 v[220:223], a[84:87], a[24:27], v[220:223]
  s_waitcnt lgkmcnt(0)
  s_nop 0
  v_mfma_f32_16x16x32_bf16 v[0:3], a[88:91], a[28:31], v[0:3]
  s_waitcnt vmcnt(16)
  s_nop 0
  v_mfma_f32_16x16x32_bf16 v[4:7], a[92:95], a[28:31], v[4:7]
  s_barrier
  s_nop 0
  v_mfma_f32_16x16x32_bf16 v[8:11], a[96:99], a[28:31], v[8:11]
  ds_read_b128 a[0:3], v232 offset:16384
  v_mfma_f32_16x16x32_bf16 v[12:15], a[100:103], a[28:31], v[12:15]
  ds_read_b64_tr_b16 a[56:57], v225 offset:16384
  v_mfma_f32_16x16x32_bf16 v[16:19], a[104:107], a[28:31], v[16:19]
  ds_read_b64_tr_b16 a[58:59], v225 offset:20480
  v_mfma_f32_16x16x32_bf16 v[20:23], a[108:111], a[28:31], v[20:23]
  ds_read_b64_tr_b16 a[60:61], v225 offset:16392
  v_mfma_f32_16x16x32_bf16 v[24:27], a[112:115], a[28:31], v[24:27]
  ds_read_b64_tr_b16 a[62:63], v225 offset:20488
  v_mfma_f32_16x16x32_bf16 v[28:31], a[116:119], a[28:31], v[28:31]
  ds_read_b64_tr_b16 a[64:65], v225 offset:16896
  v_mfma_f32_16x16x32_bf16 v[32:35], a[88:91], a[32:35], v[32:35]
  ds_read_b64_tr_b16 a[66:67], v225 offset:20992
  v_mfma_f32_16x16x32_bf16 v[36:39], a[92:95], a[32:35], v[36:39]
  ds_read_b64_tr_b16 a[68:69], v225 offset:16904
  v_mfma_f32_16x16x32_bf16 v[40:43], a[96:99], a[32:35], v[40:43]
  ds_read_b64_tr_b16 a[70:71], v225 offset:21000
  v_mfma_f32_16x16x32_bf16 v[44:47], a[100:103], a[32:35], v[44:47]
  ds_read_b64_tr_b16 a[72:73], v225 offset:17408
  v_mfma_f32_16x16x32_bf16 v[48:51], a[104:107], a[32:35], v[48:51]
  ds_read_b64_tr_b16 a[74:75], v225 offset:21504
  v_mfma_f32_16x16x32_bf16 v[52:55], a[108:111], a[32:35], v[52:55]
  ds_read_b64_tr_b16 a[76:77], v225 offset:17416
  v_mfma_f32_16x16x32_bf16 v[56:59], a[112:115], a[32:35], v[56:59]
  ds_read_b64_tr_b16 a[78:79], v225 offset:21512
  v_mfma_f32_16x16x32_bf16 v[60:63], a[116:119], a[32:35], v[60:63]
  ds_read_b64_tr_b16 a[80:81], v225 offset:17920
  v_mfma_f32_16x16x32_bf16 v[64:67], a[88:91], a[36:39], v[64:67]
  ds_read_b64_tr_b16 a[82:83], v225 offset:22016
  v_mfma_f32_16x16x32_bf16 v[68:71], a[92:95], a[36:39], v[68:71]
  ds_read_b64_tr_b16 a[84:85], v225 offset:17928
  v_mfma_f32_16x16x32_bf16 v[72:75], a[96:99], a[36:39], v[72:75]
  ds_read_b64_tr_b16 a[86:87], v225 offset:22024
  v_mfma_f32_16x16x32_bf16 v[76:79], a[100:103], a[36:39], v[76:79]
  ds_read_b128 a[4:7], v232 offset:17408
  v_mfma_f32_16x16x32_bf16 v[80:83], a[104:107], a[36:39], v[80:83]
  ds_read_b128 a[8:11], v232 offset:18432
  v_mfma_f32_16x16x32_bf16 v[84:87], a[108:111], a[36:39], v[84:87]
  ds_read_b128 a[12:15], v232 offset:19456
  v_mfma_f32_16x16x32_bf16 v[88:91], a[112:115], a[36:39], v[88:91]
  ds_read_b128 a[16:19], v232 offset:20480
  v_mfma_f32_16x16x32_bf16 v[92:95], a[116:119], a[36:39], v[92:95]
  ds_read_b128 a[20:23], v232 offset:21504
  v_mfma_f32_16x16x32_bf16 v[96:99], a[88:91], a[40:43], v[96:99]
  ds_read_b128 a[24:27], v232 offset:22528
  v_mfma_f32_16x16x32_bf16 v[100:103], a[92:95], a[40:43], v[100:103]
  v_mfma_f32_16x16x32_bf16 v[104:107], a[96:99], a[40:43], v[104:107]
  v_mfma_f32_16x16x32_bf16 v[108:111], a[100:103], a[40:43], v[108:111]
  v_mfma_f32_16x16x32_bf16 v[112:115], a[104:107], a[40:43], v[112:115]
  v_mfma_f32_16x16x32_bf16 v[116:119], a[108:111], a[40:43], v[116:119]
  v_mfma_f32_16x16x32_bf16 v[120:123], a[112:115], a[40:43], v[120:123]
  v_mfma_f32_16x16x32_bf16 v[124:127], a[116:119], a[40:43], v[124:127]
  v_mfma_f32_16x16x32_bf16 v[128:131], a[88:91], a[44:47], v[128:131]
  v_mfma_f32_16x16x32_bf16 v[132:135], a[92:95], a[44:47], v[132:135]
  v_mfma_f32_16x16x32_bf16 v[136:139], a[96:99], a[44:47], v[136:139]
  v_mfma_f32_16x16x32_bf16 v[140:143], a[100:103], a[44:47], v[140:143]
  v_mfma_f32_16x16x32_bf16 v[144:147], a[104:107], a[44:47], v[144:147]
  v_mfma_f32_16x16x32_bf16 v[148:151], a[108:111], a[44:47], v[148:151]
  v_mfma_f32_16x16x32_bf16 v[152:155], a[112:115], a[44:47], v[152:155]
  v_mfma_f32_16x16x32_bf16 v[156:159], a[116:119], a[44:47], v[156:159]
  v_mfma_f32_16x16x32_bf16 v[160:163], a[88:91], a[48:51], v[160:163]
  v_mfma_f32_16x16x32_bf16 v[164:167], a[92:95], a[48:51], v[164:167]
  v_mfma_f32_16x16x32_bf16 v[168:171], a[96:99], a[48:51], v[168:171]
  v_mfma_f32_16x16x32_bf16 v[172:175], a[100:103], a[48:51], v[172:175]
  v_mfma_f32_16x16x32_bf16 v[176:179], a[104:107], a[48:51], v[176:179]
  v_mfma_f32_16x16x32_bf16 v[180:183], a[108:111], a[48:51], v[180:183]
  v_mfma_f32_16x16x32_bf16 v[184:187], a[112:115], a[48:51], v[184:187]
  v_mfma_f32_16x16x32_bf16 v[188:191], a[116:119], a[48:51], v[188:191]
  v_mfma_f32_16x16x32_bf16 v[192:195], a[88:91], a[52:55], v[192:195]
  v_mfma_f32_16x16x32_bf16 v[196:199], a[92:95], a[52:55], v[196:199]
  v_mfma_f32_16x16x32_bf16 v[200:203], a[96:99], a[52:55], v[200:203]
  v_mfma_f32_16x16x32_bf16 v[204:207], a[100:103], a[52:55], v[204:207]
  v_mfma_f32_16x16x32_bf16 v[208:211], a[104:107], a[52:55], v[208:211]
  v_mfma_f32_16x16x32_bf16 v[212:215], a[108:111], a[52:55], v[212:215]
  v_mfma_f32_16x16x32_bf16 v[216:219], a[112:115], a[52:55], v[216:219]
  v_mfma_f32_16x16x32_bf16 v[220:223], a[116:119], a[52:55], v[220:223]
  s_waitcnt lgkmcnt(0)
  s_nop 0
  v_mfma_f32_16x16x32_bf16 v[0:3], a[56:59], a[0:3], v[0:3]
  s_waitcnt vmcnt(8)
  s_nop 0
  v_mfma_f32_16x16x32_bf16 v[4:7], a[60:63], a[0:3], v[4:7]
  s_barrier
  s_waitcnt vmcnt(32)
  v_mfma_f32_16x16x32_bf16 v[8:11], a[64:67], a[0:3], v[8:11]
  s_add_u32 s66, s53, 0x8000
  s_and_b32 s66, s66, 0x1ffff
  ds_read_b128 a[28:31], v232 offset:32768
  v_mfma_f32_16x16x32_bf16 v[12:15], a[68:71], a[0:3], v[12:15]
  buffer_load_dwordx4 a[184:187], v226, s[24:27], s66 offen offset:0 nt
  v_mfma_f32_16x16x32_bf16 v[16:19], a[72:75], a[0:3], v[16:19]
  ds_read_b64_tr_b16 a[88:89], v225 offset:32768
  v_mfma_f32_16x16x32_bf16 v[20:23], a[76:79], a[0:3], v[20:23]
  ds_read_b64_tr_b16 a[90:91], v225 offset:36864
  v_mfma_f32_16x16x32_bf16 v[24:27], a[80:83], a[0:3], v[24:27]
  ds_read_b64_tr_b16 a[92:93], v225 offset:32776
  v_mfma_f32_16x16x32_bf16 v[28:31], a[84:87], a[0:3], v[28:31]
  ds_read_b64_tr_b16 a[94:95], v225 offset:36872
  v_mfma_f32_16x16x32_bf16 v[32:35], a[56:59], a[4:7], v[32:35]
  buffer_load_dwordx4 a[188:191], v226, s[24:27], s66 offen offset:128 nt
  v_mfma_f32_16x16x32_bf16 v[36:39], a[60:63], a[4:7], v[36:39]
  ds_read_b64_tr_b16 a[96:97], v225 offset:33280
  v_mfma_f32_16x16x32_bf16 v[40:43], a[64:67], a[4:7], v[40:43]
  ds_read_b64_tr_b16 a[98:99], v225 offset:37376
  v_mfma_f32_16x16x32_bf16 v[44:47], a[68:71], a[4:7], v[44:47]
  ds_read_b64_tr_b16 a[100:101], v225 offset:33288
  v_mfma_f32_16x16x32_bf16 v[48:51], a[72:75], a[4:7], v[48:51]
  ds_read_b64_tr_b16 a[102:103], v225 offset:37384
  v_mfma_f32_16x16x32_bf16 v[52:55], a[76:79], a[4:7], v[52:55]
  buffer_load_dwordx4 a[192:195], v226, s[24:27], s66 offen offset:2048 nt
  v_mfma_f32_16x16x32_bf16 v[56:59], a[80:83], a[4:7], v[56:59]
  ds_read_b64_tr_b16 a[104:105], v225 offset:33792
  v_mfma_f32_16x16x32_bf16 v[60:63], a[84:87], a[4:7], v[60:63]
  ds_read_b64_tr_b16 a[106:107], v225 offset:37888
  v_mfma_f32_16x16x32_bf16 v[64:67], a[56:59], a[8:11], v[64:67]
  ds_read_b64_tr_b16 a[108:109], v225 offset:33800
  v_mfma_f32_16x16x32_bf16 v[68:71], a[60:63], a[8:11], v[68:71]
  ds_read_b64_tr_b16 a[110:111], v225 offset:37896
  v_mfma_f32_16x16x32_bf16 v[72:75], a[64:67], a[8:11], v[72:75]
  buffer_load_dwordx4 a[196:199], v226, s[24:27], s66 offen offset:2176 nt
  v_mfma_f32_16x16x32_bf16 v[76:79], a[68:71], a[8:11], v[76:79]
  ds_read_b64_tr_b16 a[112:113], v225 offset:34304
  v_mfma_f32_16x16x32_bf16 v[80:83], a[72:75], a[8:11], v[80:83]
  ds_read_b64_tr_b16 a[114:115], v225 offset:38400
  v_mfma_f32_16x16x32_bf16 v[84:87], a[76:79], a[8:11], v[84:87]
  ds_read_b64_tr_b16 a[116:117], v225 offset:34312
  v_mfma_f32_16x16x32_bf16 v[88:91], a[80:83], a[8:11], v[88:91]
  ds_read_b64_tr_b16 a[118:119], v225 offset:38408
  v_mfma_f32_16x16x32_bf16 v[92:95], a[84:87], a[8:11], v[92:95]
  buffer_load_dwordx4 a[200:203], v228, s[28:31], s66 offen offset:0 nt
  v_mfma_f32_16x16x32_bf16 v[96:99], a[56:59], a[12:15], v[96:99]
  ds_read_b128 a[32:35], v232 offset:33792
  v_mfma_f32_16x16x32_bf16 v[100:103], a[60:63], a[12:15], v[100:103]
  ds_read_b128 a[36:39], v232 offset:34816
  v_mfma_f32_16x16x32_bf16 v[104:107], a[64:67], a[12:15], v[104:107]
  ds_read_b128 a[40:43], v232 offset:35840
  v_mfma_f32_16x16x32_bf16 v[108:111], a[68:71], a[12:15], v[108:111]
  ds_read_b128 a[44:47], v232 offset:36864
  v_mfma_f32_16x16x32_bf16 v[112:115], a[72:75], a[12:15], v[112:115]
  buffer_load_dwordx4 a[204:207], v228, s[28:31], s66 offen offset:128 nt
  v_mfma_f32_16x16x32_bf16 v[116:119], a[76:79], a[12:15], v[116:119]
  ds_read_b128 a[48:51], v232 offset:37888
  v_mfma_f32_16x16x32_bf16 v[120:123], a[80:83], a[12:15], v[120:123]
  ds_read_b128 a[52:55], v232 offset:38912
  v_mfma_f32_16x16x32_bf16 v[124:127], a[84:87], a[12:15], v[124:127]
  v_mfma_f32_16x16x32_bf16 v[128:131], a[56:59], a[16:19], v[128:131]
  ds_write_b128 v224, a[120:123] offset:0
  v_mfma_f32_16x16x32_bf16 v[132:135], a[60:63], a[16:19], v[132:135]
  buffer_load_dwordx4 a[208:211], v228, s[28:31], s66 offen offset:2048 nt
  v_mfma_f32_16x16x32_bf16 v[136:139], a[64:67], a[16:19], v[136:139]
  v_mfma_f32_16x16x32_bf16 v[140:143], a[68:71], a[16:19], v[140:143]
  ds_write_b128 v224, a[124:127] offset:1024
  v_mfma_f32_16x16x32_bf16 v[144:147], a[72:75], a[16:19], v[144:147]
  v_mfma_f32_16x16x32_bf16 v[148:151], a[76:79], a[16:19], v[148:151]
  v_mfma_f32_16x16x32_bf16 v[152:155], a[80:83], a[16:19], v[152:155]
  buffer_load_dwordx4 a[212:215], v228, s[28:31], s66 offen offset:2176 nt
  v_mfma_f32_16x16x32_bf16 v[156:159], a[84:87], a[16:19], v[156:159]
  ds_write_b128 v224, a[128:131] offset:2048
  v_mfma_f32_16x16x32_bf16 v[160:163], a[56:59], a[20:23], v[160:163]
  v_mfma_f32_16x16x32_bf16 v[164:167], a[60:63], a[20:23], v[164:167]
  v_mfma_f32_16x16x32_bf16 v[168:171], a[64:67], a[20:23], v[168:171]
  ds_write_b128 v224, a[132:135] offset:3072
  v_mfma_f32_16x16x32_bf16 v[172:175], a[68:71], a[20:23], v[172:175]
  v_mfma_f32_16x16x32_bf16 v[176:179], a[72:75], a[20:23], v[176:179]
  v_mfma_f32_16x16x32_bf16 v[180:183], a[76:79], a[20:23], v[180:183]
  ds_write_b128 v224, a[136:139] offset:8192
  v_mfma_f32_16x16x32_bf16 v[184:187], a[80:83], a[20:23], v[184:187]
  v_mfma_f32_16x16x32_bf16 v[188:191], a[84:87], a[20:23], v[188:191]
  v_mfma_f32_16x16x32_bf16 v[192:195], a[56:59], a[24:27], v[192:195]
  ds_write_b128 v224, a[140:143] offset:9216
  v_mfma_f32_16x16x32_bf16 v[196:199], a[60:63], a[24:27], v[196:199]
  v_mfma_f32_16x16x32_bf16 v[200:203], a[64:67], a[24:27], v[200:203]
  v_mfma_f32_16x16x32_bf16 v[204:207], a[68:71], a[24:27], v[204:207]
  ds_write_b128 v224, a[144:147] offset:10240
  v_mfma_f32_16x16x32_bf16 v[208:211], a[72:75], a[24:27], v[208:211]
  v_mfma_f32_16x16x32_bf16 v[212:215], a[76:79], a[24:27], v[212:215]
  v_mfma_f32_16x16x32_bf16 v[216:219], a[80:83], a[24:27], v[216:219]
  ds_write_b128 v224, a[148:151] offset:11264
  v_mfma_f32_16x16x32_bf16 v[220:223], a[84:87], a[24:27], v[220:223]
  s_waitcnt lgkmcnt(0)
  s_nop 0
  v_mfma_f32_16x16x32_bf16 v[0:3], a[88:91], a[28:31], v[0:3]
  v_mfma_f32_16x16x32_bf16 v[4:7], a[92:95], a[28:31], v[4:7]
  s_barrier
  s_nop 0
  v_mfma_f32_16x16x32_bf16 v[8:11], a[96:99], a[28:31], v[8:11]
  ds_read_b128 a[224:227], v233 offset:0
  v_mfma_f32_16x16x32_bf16 v[12:15], a[100:103], a[28:31], v[12:15]
  ds_read_b128 a[240:243], v233 offset:4096
  v_mfma_f32_16x16x32_bf16 v[16:19], a[104:107], a[28:31], v[16:19]
  ds_read_b128 a[228:231], v235 offset:0
  v_mfma_f32_16x16x32_bf16 v[20:23], a[108:111], a[28:31], v[20:23]
  ds_read_b128 a[244:247], v235 offset:4096
  v_mfma_f32_16x16x32_bf16 v[24:27], a[112:115], a[28:31], v[24:27]
  ds_read_b128 a[232:235], v233 offset:1024
  v_mfma_f32_16x16x32_bf16 v[28:31], a[116:119], a[28:31], v[28:31]
  ds_read_b128 a[248:251], v233 offset:5120
  v_mfma_f32_16x16x32_bf16 v[32:35], a[88:91], a[32:35], v[32:35]
  ds_read_b128 a[236:239], v235 offset:1024
  v_mfma_f32_16x16x32_bf16 v[36:39], a[92:95], a[32:35], v[36:39]
  ds_read_b128 a[252:255], v235 offset:5120
  v_mfma_f32_16x16x32_bf16 v[40:43], a[96:99], a[32:35], v[40:43]
  v_mfma_f32_16x16x32_bf16 v[44:47], a[100:103], a[32:35], v[44:47]
  v_mfma_f32_16x16x32_bf16 v[48:51], a[104:107], a[32:35], v[48:51]
  v_mfma_f32_16x16x32_bf16 v[52:55], a[108:111], a[32:35], v[52:55]
  v_pk_mul_f32 v[0:1], v[0:1], s[64:65]
  v_pk_mul_f32 v[2:3], v[2:3], s[64:65]
  v_mfma_f32_16x16x32_bf16 v[56:59], a[112:115], a[32:35], v[56:59]
  v_pk_mul_f32 v[4:5], v[4:5], s[64:65]
  v_pk_mul_f32 v[6:7], v[6:7], s[64:65]
  v_mfma_f32_16x16x32_bf16 v[60:63], a[116:119], a[32:35], v[60:63]
  v_cvt_pk_bf16_f32 v0, v0, v1
  v_cvt_pk_bf16_f32 v1, v2, v3
  v_mfma_f32_16x16x32_bf16 v[64:67], a[88:91], a[36:39], v[64:67]
  v_cvt_pk_bf16_f32 v2, v4, v5
  v_cvt_pk_bf16_f32 v3, v6, v7
  v_mfma_f32_16x16x32_bf16 v[68:71], a[92:95], a[36:39], v[68:71]
  v_pk_mul_f32 v[8:9], v[8:9], s[64:65]
  v_pk_mul_f32 v[10:11], v[10:11], s[64:65]
  v_mfma_f32_16x16x32_bf16 v[72:75], a[96:99], a[36:39], v[72:75]
  v_pk_mul_f32 v[12:13], v[12:13], s[64:65]
  v_pk_mul_f32 v[14:15], v[14:15], s[64:65]
  v_mfma_f32_16x16x32_bf16 v[76:79], a[100:103], a[36:39], v[76:79]
  v_cvt_pk_bf16_f32 v4, v8, v9
  v_cvt_pk_bf16_f32 v5, v10, v11
  v_mfma_f32_16x16x32_bf16 v[80:83], a[104:107], a[36:39], v[80:83]
  v_cvt_pk_bf16_f32 v6, v12, v13
  v_cvt_pk_bf16_f32 v7, v14, v15
  v_mfma_f32_16x16x32_bf16 v[84:87], a[108:111], a[36:39], v[84:87]
  v_pk_mul_f32 v[16:17], v[16:17], s[64:65]
  v_pk_mul_f32 v[18:19], v[18:19], s[64:65]
  v_mfma_f32_16x16x32_bf16 v[88:91], a[112:115], a[36:39], v[88:91]
  v_pk_mul_f32 v[20:21], v[20:21], s[64:65]
  v_pk_mul_f32 v[22:23], v[22:23], s[64:65]
  v_mfma_f32_16x16x32_bf16 v[92:95], a[116:119], a[36:39], v[92:95]
  v_cvt_pk_bf16_f32 v8, v16, v17
  v_cvt_pk_bf16_f32 v9, v18, v19
  v_mfma_f32_16x16x32_bf16 v[96:99], a[88:91], a[40:43], v[96:99]
  v_cvt_pk_bf16_f32 v10, v20, v21
  v_cvt_pk_bf16_f32 v11, v22, v23
  v_mfma_f32_16x16x32_bf16 v[100:103], a[92:95], a[40:43], v[100:103]
  v_pk_mul_f32 v[24:25], v[24:25], s[64:65]
  v_pk_mul_f32 v[26:27], v[26:27], s[64:65]
  v_mfma_f32_16x16x32_bf16 v[104:107], a[96:99], a[40:43], v[104:107]
  v_pk_mul_f32 v[28:29], v[28:29], s[64:65]
  v_pk_mul_f32 v[30:31], v[30:31], s[64:65]
  v_mfma_f32_16x16x32_bf16 v[108:111], a[100:103], a[40:43], v[108:111]
  v_cvt_pk_bf16_f32 v12, v24, v25
  v_cvt_pk_bf16_f32 v13, v26, v27
  v_mfma_f32_16x16x32_bf16 v[112:115], a[104:107], a[40:43], v[112:115]
  v_cvt_pk_bf16_f32 v14, v28, v29
  v_cvt_pk_bf16_f32 v15, v30, v31
  v_mfma_f32_16x16x32_bf16 v[116:119], a[108:111], a[40:43], v[116:119]
  v_pk_mul_f32 v[32:33], v[32:33], s[64:65]
  v_pk_mul_f32 v[34:35], v[34:35], s[64:65]
  v_mfma_f32_16x16x32_bf16 v[120:123], a[112:115], a[40:43], v[120:123]
  v_pk_mul_f32 v[36:37], v[36:37], s[64:65]
  v_pk_mul_f32 v[38:39], v[38:39], s[64:65]
  v_mfma_f32_16x16x32_bf16 v[124:127], a[116:119], a[40:43], v[124:127]
  v_cvt_pk_bf16_f32 v16, v32, v33
  v_cvt_pk_bf16_f32 v17, v34, v35
  v_mfma_f32_16x16x32_bf16 v[128:131], a[88:91], a[44:47], v[128:131]
  v_cvt_pk_bf16_f32 v18, v36, v37
  v_cvt_pk_bf16_f32 v19, v38, v39
  v_mfma_f32_16x16x32_bf16 v[132:135], a[92:95], a[44:47], v[132:135]
  v_pk_mul_f32 v[40:41], v[40:41], s[64:65]
  v_pk_mul_f32 v[42:43], v[42:43], s[64:65]
  v_mfma_f32_16x16x32_bf16 v[136:139], a[96:99], a[44:47], v[136:139]
  v_pk_mul_f32 v[44:45], v[44:45], s[64:65]
  v_pk_mul_f32 v[46:47], v[46:47], s[64:65]
  v_mfma_f32_16x16x32_bf16 v[140:143], a[100:103], a[44:47], v[140:143]
  v_cvt_pk_bf16_f32 v20, v40, v41
  v_cvt_pk_bf16_f32 v21, v42, v43
  v_mfma_f32_16x16x32_bf16 v[144:147], a[104:107], a[44:47], v[144:147]
  v_cvt_pk_bf16_f32 v22, v44, v45
  v_cvt_pk_bf16_f32 v23, v46, v47
  v_mfma_f32_16x16x32_bf16 v[148:151], a[108:111], a[44:47], v[148:151]
  v_pk_mul_f32 v[48:49], v[48:49], s[64:65]
  v_pk_mul_f32 v[50:51], v[50:51], s[64:65]
  v_mfma_f32_16x16x32_bf16 v[152:155], a[112:115], a[44:47], v[152:155]
  v_pk_mul_f32 v[52:53], v[52:53], s[64:65]
  v_pk_mul_f32 v[54:55], v[54:55], s[64:65]
  v_mfma_f32_16x16x32_bf16 v[156:159], a[116:119], a[44:47], v[156:159]
  v_cvt_pk_bf16_f32 v24, v48, v49
  v_cvt_pk_bf16_f32 v25, v50, v51
  v_mfma_f32_16x16x32_bf16 v[160:163], a[88:91], a[48:51], v[160:163]
  v_cvt_pk_bf16_f32 v26, v52, v53
  v_cvt_pk_bf16_f32 v27, v54, v55
  v_mfma_f32_16x16x32_bf16 v[164:167], a[92:95], a[48:51], v[164:167]
  v_pk_mul_f32 v[56:57], v[56:57], s[64:65]
  v_pk_mul_f32 v[58:59], v[58:59], s[64:65]
  v_mfma_f32_16x16x32_bf16 v[168:171], a[96:99], a[48:51], v[168:171]
  v_pk_mul_f32 v[60:61], v[60:61], s[64:65]
  v_pk_mul_f32 v[62:63], v[62:63], s[64:65]
  v_mfma_f32_16x16x32_bf16 v[172:175], a[100:103], a[48:51], v[172:175]
  v_cvt_pk_bf16_f32 v28, v56, v57
  v_cvt_pk_bf16_f32 v29, v58, v59
  v_mfma_f32_16x16x32_bf16 v[176:179], a[104:107], a[48:51], v[176:179]
  v_cvt_pk_bf16_f32 v30, v60, v61
  v_cvt_pk_bf16_f32 v31, v62, v63
  v_mfma_f32_16x16x32_bf16 v[180:183], a[108:111], a[48:51], v[180:183]
  v_pk_mul_f32 v[64:65], v[64:65], s[64:65]
  v_pk_mul_f32 v[66:67], v[66:67], s[64:65]
  v_mfma_f32_16x16x32_bf16 v[184:187], a[112:115], a[48:51], v[184:187]
  v_pk_mul_f32 v[68:69], v[68:69], s[64:65]
  v_pk_mul_f32 v[70:71], v[70:71], s[64:65]
  v_mfma_f32_16x16x32_bf16 v[188:191], a[116:119], a[48:51], v[188:191]
  v_cvt_pk_bf16_f32 v32, v64, v65
  v_cvt_pk_bf16_f32 v33, v66, v67
  v_mfma_f32_16x16x32_bf16 v[192:195], a[88:91], a[52:55], v[192:195]
  v_cvt_pk_bf16_f32 v34, v68, v69
  v_cvt_pk_bf16_f32 v35, v70, v71
  v_mfma_f32_16x16x32_bf16 v[196:199], a[92:95], a[52:55], v[196:199]
  v_pk_mul_f32 v[72:73], v[72:73], s[64:65]
  v_pk_mul_f32 v[74:75], v[74:75], s[64:65]
  v_mfma_f32_16x16x32_bf16 v[200:203], a[96:99], a[52:55], v[200:203]
  v_pk_mul_f32 v[76:77], v[76:77], s[64:65]
  v_pk_mul_f32 v[78:79], v[78:79], s[64:65]
  v_mfma_f32_16x16x32_bf16 v[204:207], a[100:103], a[52:55], v[204:207]
  v_cvt_pk_bf16_f32 v36, v72, v73
  v_cvt_pk_bf16_f32 v37, v74, v75
  v_mfma_f32_16x16x32_bf16 v[208:211], a[104:107], a[52:55], v[208:211]
  v_cvt_pk_bf16_f32 v38, v76, v77
  v_cvt_pk_bf16_f32 v39, v78, v79
  v_mfma_f32_16x16x32_bf16 v[212:215], a[108:111], a[52:55], v[212:215]
  v_pk_mul_f32 v[80:81], v[80:81], s[64:65]
  v_pk_mul_f32 v[82:83], v[82:83], s[64:65]
  v_mfma_f32_16x16x32_bf16 v[216:219], a[112:115], a[52:55], v[216:219]
  v_pk_mul_f32 v[84:85], v[84:85], s[64:65]
  v_pk_mul_f32 v[86:87], v[86:87], s[64:65]
  v_mfma_f32_16x16x32_bf16 v[220:223], a[116:119], a[52:55], v[220:223]
  v_cvt_pk_bf16_f32 v40, v80, v81
  v_cvt_pk_bf16_f32 v41, v82, v83
  s_nop 7
  s_nop 0
  v_cvt_pk_bf16_f32 v42, v84, v85
  v_cvt_pk_bf16_f32 v43, v86, v87
  v_pk_mul_f32 v[88:89], v[88:89], s[64:65]
  v_pk_mul_f32 v[90:91], v[90:91], s[64:65]
  v_pk_mul_f32 v[92:93], v[92:93], s[64:65]
  v_pk_mul_f32 v[94:95], v[94:95], s[64:65]
  v_cvt_pk_bf16_f32 v44, v88, v89
  v_cvt_pk_bf16_f32 v45, v90, v91
  v_cvt_pk_bf16_f32 v46, v92, v93
  v_cvt_pk_bf16_f32 v47, v94, v95
  v_pk_mul_f32 v[96:97], v[96:97], s[64:65]
  v_pk_mul_f32 v[98:99], v[98:99], s[64:65]
  v_pk_mul_f32 v[100:101], v[100:101], s[64:65]
  v_pk_mul_f32 v[102:103], v[102:103], s[64:65]
  v_cvt_pk_bf16_f32 v48, v96, v97
  v_cvt_pk_bf16_f32 v49, v98, v99
  v_cvt_pk_bf16_f32 v50, v100, v101
  v_cvt_pk_bf16_f32 v51, v102, v103
  v_pk_mul_f32 v[104:105], v[104:105], s[64:65]
  v_pk_mul_f32 v[106:107], v[106:107], s[64:65]
  v_pk_mul_f32 v[108:109], v[108:109], s[64:65]
  v_pk_mul_f32 v[110:111], v[110:111], s[64:65]
  v_cvt_pk_bf16_f32 v52, v104, v105
  v_cvt_pk_bf16_f32 v53, v106, v107
  v_cvt_pk_bf16_f32 v54, v108, v109
  v_cvt_pk_bf16_f32 v55, v110, v111
  v_pk_mul_f32 v[112:113], v[112:113], s[64:65]
  v_pk_mul_f32 v[114:115], v[114:115], s[64:65]
  v_pk_mul_f32 v[116:117], v[116:117], s[64:65]
  v_pk_mul_f32 v[118:119], v[118:119], s[64:65]
  v_cvt_pk_bf16_f32 v56, v112, v113
  v_cvt_pk_bf16_f32 v57, v114, v115
  v_cvt_pk_bf16_f32 v58, v116, v117
  v_cvt_pk_bf16_f32 v59, v118, v119
  v_pk_mul_f32 v[120:121], v[120:121], s[64:65]
  v_pk_mul_f32 v[122:123], v[122:123], s[64:65]
  v_pk_mul_f32 v[124:125], v[124:125], s[64:65]
  v_pk_mul_f32 v[126:127], v[126:127], s[64:65]
  v_cvt_pk_bf16_f32 v60, v120, v121
  v_cvt_pk_bf16_f32 v61, v122, v123
  v_cvt_pk_bf16_f32 v62, v124, v125
  v_cvt_pk_bf16_f32 v63, v126, v127
  v_pk_mul_f32 v[128:129], v[128:129], s[64:65]
  v_pk_mul_f32 v[130:131], v[130:131], s[64:65]
  v_pk_mul_f32 v[132:133], v[132:133], s[64:65]
  v_pk_mul_f32 v[134:135], v[134:135], s[64:65]
  v_cvt_pk_bf16_f32 v64, v128, v129
  v_cvt_pk_bf16_f32 v65, v130, v131
  v_cvt_pk_bf16_f32 v66, v132, v133
  v_cvt_pk_bf16_f32 v67, v134, v135
  v_pk_mul_f32 v[136:137], v[136:137], s[64:65]
  v_pk_mul_f32 v[138:139], v[138:139], s[64:65]
  v_pk_mul_f32 v[140:141], v[140:141], s[64:65]
  v_pk_mul_f32 v[142:143], v[142:143], s[64:65]
  v_cvt_pk_bf16_f32 v68, v136, v137
  v_cvt_pk_bf16_f32 v69, v138, v139
  v_cvt_pk_bf16_f32 v70, v140, v141
  v_cvt_pk_bf16_f32 v71, v142, v143
  v_pk_mul_f32 v[144:145], v[144:145], s[64:65]
  v_pk_mul_f32 v[146:147], v[146:147], s[64:65]
  v_pk_mul_f32 v[148:149], v[148:149], s[64:65]
  v_pk_mul_f32 v[150:151], v[150:151], s[64:65]
  v_cvt_pk_bf16_f32 v72, v144, v145
  v_cvt_pk_bf16_f32 v73, v146, v147
  v_cvt_pk_bf16_f32 v74, v148, v149
  v_cvt_pk_bf16_f32 v75, v150, v151
  v_pk_mul_f32 v[152:153], v[152:153], s[64:65]
  v_pk_mul_f32 v[154:155], v[154:155], s[64:65]
  v_pk_mul_f32 v[156:157], v[156:157], s[64:65]
  v_pk_mul_f32 v[158:159], v[158:159], s[64:65]
  v_cvt_pk_bf16_f32 v76, v152, v153
  v_cvt_pk_bf16_f32 v77, v154, v155
  v_cvt_pk_bf16_f32 v78, v156, v157
  v_cvt_pk_bf16_f32 v79, v158, v159
  v_pk_mul_f32 v[160:161], v[160:161], s[64:65]
  v_pk_mul_f32 v[162:163], v[162:163], s[64:65]
  v_pk_mul_f32 v[164:165], v[164:165], s[64:65]
  v_pk_mul_f32 v[166:167], v[166:167], s[64:65]
  v_cvt_pk_bf16_f32 v80, v160, v161
  v_cvt_pk_bf16_f32 v81, v162, v163
  v_cvt_pk_bf16_f32 v82, v164, v165
  v_cvt_pk_bf16_f32 v83, v166, v167
  v_pk_mul_f32 v[168:169], v[168:169], s[64:65]
  v_pk_mul_f32 v[170:171], v[170:171], s[64:65]
  v_pk_mul_f32 v[172:173], v[172:173], s[64:65]
  v_pk_mul_f32 v[174:175], v[174:175], s[64:65]
  v_cvt_pk_bf16_f32 v84, v168, v169
  v_cvt_pk_bf16_f32 v85, v170, v171
  v_cvt_pk_bf16_f32 v86, v172, v173
  v_cvt_pk_bf16_f32 v87, v174, v175
  v_pk_mul_f32 v[176:177], v[176:177], s[64:65]
  v_pk_mul_f32 v[178:179], v[178:179], s[64:65]
  v_pk_mul_f32 v[180:181], v[180:181], s[64:65]
  v_pk_mul_f32 v[182:183], v[182:183], s[64:65]
  v_cvt_pk_bf16_f32 v88, v176, v177
  v_cvt_pk_bf16_f32 v89, v178, v179
  v_cvt_pk_bf16_f32 v90, v180, v181
  v_cvt_pk_bf16_f32 v91, v182, v183
  v_pk_mul_f32 v[184:185], v[184:185], s[64:65]
  v_pk_mul_f32 v[186:187], v[186:187], s[64:65]
  v_pk_mul_f32 v[188:189], v[188:189], s[64:65]
  v_pk_mul_f32 v[190:191], v[190:191], s[64:65]
  v_cvt_pk_bf16_f32 v92, v184, v185
  v_cvt_pk_bf16_f32 v93, v186, v187
  v_cvt_pk_bf16_f32 v94, v188, v189
  v_cvt_pk_bf16_f32 v95, v190, v191
  ds_read_b64_tr_b16 v[112:113], v230 offset:0
  ds_read_b64_tr_b16 v[114:115], v230 offset:4096
  ds_read_b64_tr_b16 v[116:117], v231 offset:0
  ds_read_b64_tr_b16 v[118:119], v231 offset:4096
  ds_read_b64_tr_b16 v[120:121], v230 offset:512
  ds_read_b64_tr_b16 v[122:123], v230 offset:4608
  ds_read_b64_tr_b16 v[124:125], v231 offset:512
  ds_read_b64_tr_b16 v[126:127], v231 offset:4608
  ds_read_b64_tr_b16 v[128:129], v230 offset:1024
  ds_read_b64_tr_b16 v[130:131], v230 offset:5120
  ds_read_b64_tr_b16 v[132:133], v231 offset:1024
  ds_read_b64_tr_b16 v[134:135], v231 offset:5120
  ds_read_b64_tr_b16 v[136:137], v230 offset:1536
  ds_read_b64_tr_b16 v[138:139], v230 offset:5632
  ds_read_b64_tr_b16 v[140:141], v231 offset:1536
  ds_read_b64_tr_b16 v[142:143], v231 offset:5632
  s_waitcnt lgkmcnt(15)
  s_nop 0
  v_mfma_f32_16x16x32_bf16 v[172:175], a[224:227], v[0:3], 0
  v_pk_mul_f32 v[192:193], v[192:193], s[64:65]
  v_pk_mul_f32 v[194:195], v[194:195], s[64:65]
  v_mfma_f32_16x16x32_bf16 v[176:179], a[240:243], v[0:3], 0
  v_pk_mul_f32 v[196:197], v[196:197], s[64:65]
  v_pk_mul_f32 v[198:199], v[198:199], s[64:65]
  v_mfma_f32_16x16x32_bf16 v[172:175], a[228:231], v[4:7], v[172:175]
  v_cvt_pk_bf16_f32 v96, v192, v193
  v_cvt_pk_bf16_f32 v97, v194, v195
  v_mfma_f32_16x16x32_bf16 v[176:179], a[244:247], v[4:7], v[176:179]
  v_cvt_pk_bf16_f32 v98, v196, v197
  v_cvt_pk_bf16_f32 v99, v198, v199
  v_mfma_f32_16x16x32_bf16 v[172:175], a[232:235], v[8:11], v[172:175]
  v_pk_mul_f32 v[200:201], v[200:201], s[64:65]
  v_pk_mul_f32 v[202:203], v[202:203], s[64:65]
  v_mfma_f32_16x16x32_bf16 v[176:179], a[248:251], v[8:11], v[176:179]
  v_pk_mul_f32 v[204:205], v[204:205], s[64:65]
  v_pk_mul_f32 v[206:207], v[206:207], s[64:65]
  v_mfma_f32_16x16x32_bf16 v[172:175], a[236:239], v[12:15], v[172:175]
  v_cvt_pk_bf16_f32 v100, v200, v201
  v_cvt_pk_bf16_f32 v101, v202, v203
  v_mfma_f32_16x16x32_bf16 v[176:179], a[252:255], v[12:15], v[176:179]
  v_cvt_pk_bf16_f32 v102, v204, v205
  v_cvt_pk_bf16_f32 v103, v206, v207
  v_pk_mul_f32 v[208:209], v[208:209], s[64:65]
  v_pk_mul_f32 v[210:211], v[210:211], s[64:65]
  v_pk_mul_f32 v[212:213], v[212:213], s[64:65]
  v_pk_mul_f32 v[214:215], v[214:215], s[64:65]
  v_cvt_pk_bf16_f32 v104, v208, v209
  v_cvt_pk_bf16_f32 v105, v210, v211
  v_cvt_pk_bf16_f32 v106, v212, v213
  v_cvt_pk_bf16_f32 v107, v214, v215
  v_pk_mul_f32 v[216:217], v[216:217], s[64:65]
  v_pk_mul_f32 v[218:219], v[218:219], s[64:65]
  v_pk_mul_f32 v[220:221], v[220:221], s[64:65]
  v_pk_mul_f32 v[222:223], v[222:223], s[64:65]
  v_cvt_pk_bf16_f32 v108, v216, v217
  v_cvt_pk_bf16_f32 v109, v218, v219
  v_cvt_pk_bf16_f32 v110, v220, v221
  v_cvt_pk_bf16_f32 v111, v222, v223
  v_mfma_f32_16x16x32_bf16 v[180:183], a[224:227], v[16:19], 0
  v_max3_f32 v248, v172, v173, v174
  v_max3_f32 v248, v248, v175, v176
  v_max3_f32 v248, v248, v177, v178
  v_max_f32_e64 v248, v248, v179
  v_mov_b32_e32 v249, v248
  s_nop 1
  v_mfma_f32_16x16x32_bf16 v[184:187], a[240:243], v[16:19], 0
  v_permlane16_swap_b32 v248, v249
  v_max_f32_e32 v248, v248, v249
  v_mov_b32_e32 v249, v248
  s_nop 1
  s_waitcnt vmcnt(8)
  s_nop 0
  v_mfma_f32_16x16x32_bf16 v[180:183], a[228:231], v[20:23], v[180:183]
  v_permlane32_swap_b32 v248, v249
  v_max_f32_e32 v248, v248, v249
  v_sub_f32_e64 v172, v172, v248
  v_sub_f32_e64 v173, v173, v248
  v_sub_f32_e64 v174, v174, v248
  ds_write_b128 v224, a[152:155] offset:16384
  v_mfma_f32_16x16x32_bf16 v[184:187], a[244:247], v[20:23], v[184:187]
  v_sub_f32_e64 v175, v175, v248
  v_sub_f32_e64 v176, v176, v248
  v_sub_f32_e64 v177, v177, v248
  v_sub_f32_e64 v178, v178, v248
  v_sub_f32_e64 v179, v179, v248
  ds_write_b128 v224, a[156:159] offset:17408
  v_mfma_f32_16x16x32_bf16 v[180:183], a[232:235], v[24:27], v[180:183]
  v_exp_f32_e64 v220, v172
  v_exp_f32_e64 v221, v173
  v_sub_f32_e64 v144, 0, v248
  ds_write_b128 v224, a[160:163] offset:18432
  v_mfma_f32_16x16x32_bf16 v[184:187], a[248:251], v[24:27], v[184:187]
  v_cvt_pk_bf16_f32 v204, v220, v221
  v_exp_f32_e64 v222, v174
  v_exp_f32_e64 v223, v175
  ds_write_b128 v224, a[164:167] offset:19456
  v_mfma_f32_16x16x32_bf16 v[180:183], a[236:239], v[28:31], v[180:183]
  v_sub_f32_e64 v145, 0, v248
  v_cvt_pk_bf16_f32 v205, v222, v223
  v_exp_f32_e64 v220, v176
  v_exp_f32_e64 v221, v177
  v_mfma_f32_16x16x32_bf16 v[184:187], a[252:255], v[28:31], v[184:187]
  v_sub_f32_e64 v146, 0, v248
  v_cvt_pk_bf16_f32 v206, v220, v221
  v_exp_f32_e64 v222, v178
  v_exp_f32_e64 v223, v179
  v_sub_f32_e64 v147, 0, v248
  v_cvt_pk_bf16_f32 v207, v222, v223
  s_nop 1
  s_nop 0
  v_mfma_f32_16x16x32_bf16 v[216:219], v[236:239], v[204:207], 0
  v_max3_f32 v248, v180, v181, v182
  v_max3_f32 v248, v248, v183, v184
  v_max3_f32 v248, v248, v185, v186
  v_max_f32_e64 v248, v248, v187
  v_mfma_f32_16x16x32_bf16 v[188:191], a[224:227], v[32:35], 0
  v_mov_b32_e64 v249, v248
  ds_write_b128 v224, a[168:171] offset:24576
  v_mfma_f32_16x16x32_bf16 v[192:195], a[240:243], v[32:35], 0
  s_nop 1
  s_nop 0
  ds_write_b128 v224, a[172:175] offset:25600
  v_mfma_f32_16x16x32_bf16 v[188:191], a[228:231], v[36:39], v[188:191]
  v_permlane16_swap_b32 v248, v249
  v_max_f32_e32 v248, v248, v249
  ds_write_b128 v224, a[176:179] offset:26624
  v_mfma_f32_16x16x32_bf16 v[192:195], a[244:247], v[36:39], v[192:195]
  v_mov_b32_e64 v249, v248
  ds_write_b128 v224, a[180:183] offset:27648
  v_mfma_f32_16x16x32_bf16 v[188:191], a[232:235], v[40:43], v[188:191]
  s_nop 1
  v_permlane32_swap_b32 v248, v249
  v_max_f32_e64 v248, v248, v249
  v_mfma_f32_16x16x32_bf16 v[192:195], a[248:251], v[40:43], v[192:195]
  v_sub_f32_e64 v180, v180, v248
  v_sub_f32_e64 v181, v181, v248
  v_sub_f32_e64 v182, v182, v248
  v_sub_f32_e64 v183, v183, v248
  v_mfma_f32_16x16x32_bf16 v[188:191], a[236:239], v[44:47], v[188:191]
  s_waitcnt lgkmcnt(0)
  v_sub_f32_e32 v184, v184, v248
  v_sub_f32_e64 v185, v185, v248
  v_sub_f32_e64 v186, v186, v248
  v_mfma_f32_16x16x32_bf16 v[192:195], a[252:255], v[44:47], v[192:195]
  v_sub_f32_e64 v187, v187, v248
  v_exp_f32_e64 v220, v180
  v_mfma_f32_16x16x32_bf16 a[0:3], v[112:115], v[204:207], 0
  v_add_f32_e64 v240, v240, v216
  v_exp_f32_e64 v221, v181
  v_sub_f32_e64 v148, 0, v248
  v_mfma_f32_16x16x32_bf16 a[4:7], v[116:119], v[204:207], 0
  v_cvt_pk_bf16_f32 v208, v220, v221
  v_exp_f32_e64 v222, v182
  v_exp_f32_e64 v223, v183
  v_mfma_f32_16x16x32_bf16 a[8:11], v[120:123], v[204:207], 0
  v_sub_f32_e64 v149, 0, v248
  v_cvt_pk_bf16_f32 v209, v222, v223
  v_mfma_f32_16x16x32_bf16 a[12:15], v[124:127], v[204:207], 0
  v_exp_f32_e64 v220, v184
  v_exp_f32_e64 v221, v185
  v_sub_f32_e64 v150, 0, v248
  v_mfma_f32_16x16x32_bf16 a[16:19], v[128:131], v[204:207], 0
  v_cvt_pk_bf16_f32 v210, v220, v221
  v_exp_f32_e64 v222, v186
  v_mfma_f32_16x16x32_bf16 a[20:23], v[132:135], v[204:207], 0
  v_exp_f32_e64 v223, v187
  v_sub_f32_e64 v151, 0, v248
  v_cvt_pk_bf16_f32 v211, v222, v223
  v_mfma_f32_16x16x32_bf16 a[24:27], v[136:139], v[204:207], 0
  v_mfma_f32_16x16x32_bf16 a[28:31], v[140:143], v[204:207], 0
  v_mfma_f32_16x16x32_bf16 v[216:219], v[236:239], v[208:211], 0
  s_barrier
  s_nop 0
  v_max3_f32 v248, v188, v189, v190
  v_max3_f32 v248, v248, v191, v192
  v_max3_f32 v248, v248, v193, v194
  v_mfma_f32_16x16x32_bf16 v[172:175], a[224:227], v[48:51], 0
  v_max_f32_e64 v248, v248, v195
  v_mov_b32_e32 v249, v248
  s_nop 1
  s_add_u32 s59, s11, s56
  s_nop 0
  v_mfma_f32_16x16x32_bf16 v[176:179], a[240:243], v[48:51], 0
  v_permlane16_swap_b32 v248, v249
  v_max_f32_e32 v248, v248, v249
  v_mov_b32_e64 v249, v248
  s_add_u32 s53, s53, 0xa000
  v_mfma_f32_16x16x32_bf16 v[172:175], a[228:231], v[52:55], v[172:175]
  s_nop 1
  v_permlane32_swap_b32 v248, v249
  v_max_f32_e64 v248, v248, v249
  s_and_b32 s53, s53, 0x1ffff
  v_mfma_f32_16x16x32_bf16 v[176:179], a[244:247], v[52:55], v[176:179]
  v_sub_f32_e64 v188, v188, v248
  v_sub_f32_e64 v189, v189, v248
  v_sub_f32_e32 v190, v190, v248
  s_waitcnt vmcnt(0)
  v_mfma_f32_16x16x32_bf16 v[172:175], a[232:235], v[56:59], v[172:175]
  v_sub_f32_e64 v191, v191, v248
  v_sub_f32_e64 v192, v192, v248
  v_sub_f32_e64 v193, v193, v248
  v_sub_f32_e64 v194, v194, v248
  s_add_u32 m0, s59, 0x100
  v_mfma_f32_16x16x32_bf16 v[176:179], a[248:251], v[56:59], v[176:179]
  v_sub_f32_e64 v195, v195, v248
  v_exp_f32_e32 v220, v188
  s_nop 0
  v_mfma_f32_16x16x32_bf16 v[172:175], a[236:239], v[60:63], v[172:175]
  v_exp_f32_e64 v221, v189
  v_sub_f32_e64 v152, 0, v248
  buffer_load_dwordx4 v226, s[24:27], s53 offen offset:0 nt lds
  v_mfma_f32_16x16x32_bf16 v[176:179], a[252:255], v[60:63], v[176:179]
  v_cvt_pk_bf16_f32 v204, v220, v221
  v_exp_f32_e64 v222, v190
  ds_write_b128 v224, a[184:187] offset:32768
  v_mfma_f32_16x16x32_bf16 a[32:35], v[112:115], v[208:211], 0
  v_add_f32_e64 v241, v241, v216
  ds_write_b128 v224, a[188:191] offset:33792
  v_mfma_f32_16x16x32_bf16 a[36:39], v[116:119], v[208:211], 0
  v_exp_f32_e64 v223, v191
  v_sub_f32_e64 v153, 0, v248
  ds_write_b128 v224, a[192:195] offset:34816
  v_mfma_f32_16x16x32_bf16 a[40:43], v[120:123], v[208:211], 0
  v_cvt_pk_bf16_f32 v205, v222, v223
  v_exp_f32_e64 v220, v192
  ds_write_b128 v224, a[196:199] offset:35840
  v_mfma_f32_16x16x32_bf16 a[44:47], v[124:127], v[208:211], 0
  v_exp_f32_e64 v221, v193
  v_sub_f32_e32 v154, 0, v248
  s_nop 0
  v_mfma_f32_16x16x32_bf16 a[48:51], v[128:131], v[208:211], 0
  v_cvt_pk_bf16_f32 v206, v220, v221
  v_exp_f32_e64 v222, v194
  buffer_load_dwordx4 v226, s[24:27], s53 offen offset:2048 nt lds
  v_mfma_f32_16x16x32_bf16 a[52:55], v[132:135], v[208:211], 0
  v_exp_f32_e64 v223, v195
  v_sub_f32_e64 v155, 0, v248
  v_cvt_pk_bf16_f32 v207, v222, v223
  v_mfma_f32_16x16x32_bf16 a[56:59], v[136:139], v[208:211], 0
  v_mfma_f32_16x16x32_bf16 a[60:63], v[140:143], v[208:211], 0
  v_mfma_f32_16x16x32_bf16 v[216:219], v[236:239], v[204:207], 0
  v_max3_f32 v248, v172, v173, v174
  v_max3_f32 v248, v248, v175, v176
  v_max3_f32 v248, v248, v177, v178
  v_max_f32_e64 v248, v248, v179
  v_mfma_f32_16x16x32_bf16 v[180:183], a[224:227], v[64:67], 0
  v_mov_b32_e32 v249, v248
  s_nop 1
  v_permlane16_swap_b32 v248, v249
  s_nop 0
  s_add_u32 m0, s59, 0x480
  v_mfma_f32_16x16x32_bf16 v[184:187], a[240:243], v[64:67], 0
  v_max_f32_e64 v248, v248, v249
  v_mov_b32_e32 v249, v248
  s_nop 1
  s_nop 0
  s_nop 0
  v_mfma_f32_16x16x32_bf16 v[180:183], a[228:231], v[68:71], v[180:183]
  v_permlane32_swap_b32 v248, v249
  v_max_f32_e32 v248, v248, v249
  buffer_load_dwordx4 v226, s[24:27], s53 offen offset:128 nt lds
  v_mfma_f32_16x16x32_bf16 v[184:187], a[244:247], v[68:71], v[184:187]
  v_sub_f32_e64 v172, v172, v248
  v_sub_f32_e64 v173, v173, v248
  ds_write_b128 v224, a[200:203] offset:40960
  v_mfma_f32_16x16x32_bf16 v[180:183], a[232:235], v[72:75], v[180:183]
  v_sub_f32_e64 v174, v174, v248
  v_sub_f32_e64 v175, v175, v248
  ds_write_b128 v224, a[204:207] offset:41984
  v_mfma_f32_16x16x32_bf16 v[184:187], a[248:251], v[72:75], v[184:187]
  v_sub_f32_e64 v176, v176, v248
  v_sub_f32_e64 v177, v177, v248
  v_sub_f32_e64 v178, v178, v248
  ds_write_b128 v224, a[208:211] offset:43008
  v_mfma_f32_16x16x32_bf16 v[180:183], a[236:239], v[76:79], v[180:183]
  v_sub_f32_e64 v179, v179, v248
  v_exp_f32_e64 v220, v172
  ds_write_b128 v224, a[212:215] offset:44032
  v_mfma_f32_16x16x32_bf16 v[184:187], a[252:255], v[76:79], v[184:187]
  v_exp_f32_e64 v221, v173
  v_sub_f32_e64 v156, 0, v248
  s_add_u32 s57, s56, 0x4000
  v_mfma_f32_16x16x32_bf16 a[64:67], v[112:115], v[204:207], 0
  v_add_f32_e64 v242, v242, v216
  v_cvt_pk_bf16_f32 v208, v220, v221
  v_exp_f32_e64 v222, v174
  s_cmp_eq_u32 s57, 0x14000
  v_mfma_f32_16x16x32_bf16 a[68:71], v[116:119], v[204:207], 0
  v_exp_f32_e32 v223, v175
  s_cselect_b32 s57, 0, s57
  v_mfma_f32_16x16x32_bf16 a[72:75], v[120:123], v[204:207], 0
  v_sub_f32_e64 v157, 0, v248
  v_cvt_pk_bf16_f32 v209, v222, v223
  v_exp_f32_e32 v220, v176
  s_sub_u32 s58, s57, s56
  v_mfma_f32_16x16x32_bf16 a[76:79], v[124:127], v[204:207], 0
  v_exp_f32_e64 v221, v177
  v_sub_f32_e32 v158, 0, v248
  s_nop 0
  v_mfma_f32_16x16x32_bf16 a[80:83], v[128:131], v[204:207], 0
  v_cvt_pk_bf16_f32 v210, v220, v221
  v_exp_f32_e64 v222, v178
  buffer_load_dwordx4 v226, s[24:27], s53 offen offset:2176 nt lds
  v_mfma_f32_16x16x32_bf16 a[84:87], v[132:135], v[204:207], 0
  v_exp_f32_e64 v223, v179
  v_sub_f32_e64 v159, 0, v248
  v_cvt_pk_bf16_f32 v211, v222, v223
  v_mfma_f32_16x16x32_bf16 a[88:91], v[136:139], v[204:207], 0
  v_mfma_f32_16x16x32_bf16 a[92:95], v[140:143], v[204:207], 0
  v_mfma_f32_16x16x32_bf16 v[216:219], v[236:239], v[208:211], 0
  v_max3_f32 v248, v180, v181, v182
  v_max3_f32 v248, v248, v183, v184
  v_max3_f32 v248, v248, v185, v186
  v_max_f32_e64 v248, v248, v187
  v_mov_b32_e32 v249, v248
  s_nop 1
  v_mfma_f32_16x16x32_bf16 v[188:191], a[224:227], v[80:83], 0
  v_permlane16_swap_b32 v248, v249
  v_max_f32_e32 v248, v248, v249
  v_add_u32_e64 v233, s58, v233
  v_add_u32_e64 v235, s58, v235
  v_add_u32_e64 v230, s58, v230
  v_mfma_f32_16x16x32_bf16 v[192:195], a[240:243], v[80:83], 0
  v_mov_b32_e32 v249, v248
  s_nop 1
  v_add_u32_e64 v231, s58, v231
  s_add_u32 m0, s59, 0x2100
  s_nop 0
  s_nop 0
  v_mfma_f32_16x16x32_bf16 v[188:191], a[228:231], v[84:87], v[188:191]
  v_permlane32_swap_b32 v248, v249
  s_nop 0
  buffer_load_dwordx4 v228, s[28:31], s53 offen offset:0 nt lds
  s_nop 0
  s_nop 0
  buffer_load_dwordx4 v228, s[28:31], s53 offen offset:2048 nt lds
  v_mfma_f32_16x16x32_bf16 v[192:195], a[244:247], v[84:87], v[192:195]
  v_max_f32_e64 v248, v248, v249
  v_sub_f32_e64 v180, v180, v248
  v_sub_f32_e64 v181, v181, v248
  v_accvgpr_write_b32 a192, 0
  v_accvgpr_write_b32 a193, 0
  v_accvgpr_write_b32 a194, 0
  v_mfma_f32_16x16x32_bf16 v[188:191], a[232:235], v[88:91], v[188:191]
  v_sub_f32_e64 v182, v182, v248
  v_sub_f32_e64 v183, v183, v248
  v_sub_f32_e64 v184, v184, v248
  v_accvgpr_write_b32 a195, 0
  v_accvgpr_write_b32 a196, 0
  v_accvgpr_write_b32 a197, 0
  v_mfma_f32_16x16x32_bf16 v[192:195], a[248:251], v[88:91], v[192:195]
  v_sub_f32_e64 v185, v185, v248
  v_sub_f32_e64 v186, v186, v248
  v_sub_f32_e64 v187, v187, v248
  v_accvgpr_write_b32 a198, 0
  v_accvgpr_write_b32 a199, 0
  v_accvgpr_write_b32 a200, 0
  v_mfma_f32_16x16x32_bf16 v[188:191], a[236:239], v[92:95], v[188:191]
  v_exp_f32_e64 v220, v180
  v_exp_f32_e64 v221, v181
  v_accvgpr_write_b32 a201, 0
  v_accvgpr_write_b32 a202, 0
  v_accvgpr_write_b32 a203, 0
  v_mfma_f32_16x16x32_bf16 v[192:195], a[252:255], v[92:95], v[192:195]
  v_sub_f32_e64 v160, 0, v248
  v_cvt_pk_bf16_f32 v204, v220, v221
  v_accvgpr_write_b32 a204, 0
  v_accvgpr_write_b32 a205, 0
  v_accvgpr_write_b32 a206, 0
  v_mfma_f32_16x16x32_bf16 a[96:99], v[112:115], v[208:211], 0
  v_add_f32_e64 v243, v243, v216
  v_exp_f32_e64 v222, v182
  v_accvgpr_write_b32 a207, 0
  v_accvgpr_write_b32 a208, 0
  v_accvgpr_write_b32 a209, 0
  v_mfma_f32_16x16x32_bf16 a[100:103], v[116:119], v[208:211], 0
  v_exp_f32_e64 v223, v183
  v_sub_f32_e64 v161, 0, v248
  v_accvgpr_write_b32 a210, 0
  v_accvgpr_write_b32 a211, 0
  v_accvgpr_write_b32 a212, 0
  v_mfma_f32_16x16x32_bf16 a[104:107], v[120:123], v[208:211], 0
  v_cvt_pk_bf16_f32 v205, v222, v223
  v_exp_f32_e64 v220, v184
  v_accvgpr_write_b32 a213, 0
  v_accvgpr_write_b32 a214, 0
  v_accvgpr_write_b32 a215, 0
  v_mfma_f32_16x16x32_bf16 a[108:111], v[124:127], v[208:211], 0
  v_exp_f32_e64 v221, v185
  v_sub_f32_e64 v162, 0, v248
  v_accvgpr_write_b32 a216, 0
  v_accvgpr_write_b32 a217, 0
  v_accvgpr_write_b32 a218, 0
  v_mfma_f32_16x16x32_bf16 a[112:115], v[128:131], v[208:211], 0
  v_cvt_pk_bf16_f32 v206, v220, v221
  v_exp_f32_e64 v222, v186
  v_accvgpr_write_b32 a219, 0
  v_accvgpr_write_b32 a220, 0
  v_accvgpr_write_b32 a221, 0
  v_mfma_f32_16x16x32_bf16 a[116:119], v[132:135], v[208:211], 0
  v_exp_f32_e64 v223, v187
  v_sub_f32_e64 v163, 0, v248
  v_cvt_pk_bf16_f32 v207, v222, v223
  v_accvgpr_write_b32 a222, 0
  v_accvgpr_write_b32 a223, 0
  v_mfma_f32_16x16x32_bf16 a[120:123], v[136:139], v[208:211], 0
  v_mfma_f32_16x16x32_bf16 a[124:127], v[140:143], v[208:211], 0
  v_mfma_f32_16x16x32_bf16 v[216:219], v[236:239], v[204:207], 0
  v_max3_f32 v248, v188, v189, v190
  v_max3_f32 v248, v248, v191, v192
  v_max3_f32 v248, v248, v193, v194
  v_max_f32_e64 v248, v248, v195
  v_mfma_f32_16x16x32_bf16 v[196:199], a[224:227], v[96:99], 0
  v_mov_b32_e32 v249, v248
  s_nop 1
  v_mfma_f32_16x16x32_bf16 v[200:203], a[240:243], v[96:99], 0
  v_permlane16_swap_b32 v248, v249
  v_max_f32_e32 v248, v248, v249
  v_mov_b32_e64 v249, v248
  v_mfma_f32_16x16x32_bf16 v[196:199], a[228:231], v[100:103], v[196:199]
  s_nop 1
  v_permlane32_swap_b32 v248, v249
  v_max_f32_e64 v248, v248, v249
  v_mfma_f32_16x16x32_bf16 v[200:203], a[244:247], v[100:103], v[200:203]
  v_sub_f32_e64 v188, v188, v248
  v_sub_f32_e64 v189, v189, v248
  v_sub_f32_e64 v190, v190, v248
  v_sub_f32_e32 v191, v191, v248
  s_cmp_lg_u32 s44, 0
  s_cbranch_scc1 NOARR
  s_mov_b32 s96, s16
  s_mov_b32 s97, s17
  s_nop 0
  s_mov_b32 s98, 0x100
  s_mov_b32 s99, 0x20000
  s_mov_b64 exec, 1
  v_mov_b32_e32 v252, 1
  buffer_atomic_add v252, off, s[96:99], 0 sc1
  s_mov_b64 exec, -1
NOARR:
  s_nop 0
  v_mfma_f32_16x16x32_bf16 v[196:199], a[232:235], v[104:107], v[196:199]
  v_sub_f32_e64 v192, v192, v248
  v_sub_f32_e64 v193, v193, v248
  v_sub_f32_e64 v194, v194, v248
  v_mfma_f32_16x16x32_bf16 v[200:203], a[248:251], v[104:107], v[200:203]
  v_sub_f32_e64 v195, v195, v248
  v_exp_f32_e64 v220, v188
  v_mfma_f32_16x16x32_bf16 v[196:199], a[236:239], v[108:111], v[196:199]
  v_exp_f32_e64 v221, v189
  v_sub_f32_e64 v164, 0, v248
  v_cvt_pk_bf16_f32 v208, v220, v221
  v_mfma_f32_16x16x32_bf16 v[200:203], a[252:255], v[108:111], v[200:203]
  v_exp_f32_e64 v222, v190
  v_exp_f32_e64 v223, v191
  v_mfma_f32_16x16x32_bf16 a[128:131], v[112:115], v[204:207], 0
  v_add_f32_e64 v244, v244, v216
  v_sub_f32_e64 v165, 0, v248
  ds_read_b128 a[224:227], v233 offset:0
  v_mfma_f32_16x16x32_bf16 a[132:135], v[116:119], v[204:207], 0
  v_cvt_pk_bf16_f32 v209, v222, v223
  v_exp_f32_e64 v220, v192
  ds_read_b128 a[240:243], v233 offset:4096
  v_mfma_f32_16x16x32_bf16 a[136:139], v[120:123], v[204:207], 0
  v_exp_f32_e64 v221, v193
  ds_read_b128 a[228:231], v235 offset:0
  v_mfma_f32_16x16x32_bf16 a[140:143], v[124:127], v[204:207], 0
  v_sub_f32_e64 v166, 0, v248
  v_cvt_pk_bf16_f32 v210, v220, v221
  ds_read_b128 a[244:247], v235 offset:4096
  v_mfma_f32_16x16x32_bf16 a[144:147], v[128:131], v[204:207], 0
  v_exp_f32_e64 v222, v194
  v_exp_f32_e64 v223, v195
  ds_read_b128 a[232:235], v233 offset:1024
  v_mfma_f32_16x16x32_bf16 a[148:151], v[132:135], v[204:207], 0
  v_sub_f32_e64 v167, 0, v248
  v_cvt_pk_bf16_f32 v211, v222, v223
  ds_read_b128 a[248:251], v233 offset:5120
  v_mfma_f32_16x16x32_bf16 a[152:155], v[136:139], v[204:207], 0
  ds_read_b128 a[236:239], v235 offset:1024
  v_mfma_f32_16x16x32_bf16 a[156:159], v[140:143], v[204:207], 0
  ds_read_b128 a[252:255], v235 offset:5120
  v_mfma_f32_16x16x32_bf16 v[216:219], v[236:239], v[208:211], 0
  s_waitcnt lgkmcnt(0)
  s_nop 0
  v_max3_f32 v248, v196, v197, v198
  v_max3_f32 v248, v248, v199, v200
  v_max3_f32 v248, v248, v201, v202
  v_mfma_f32_16x16x32_bf16 v[172:175], a[224:227], v[0:3], v[144:147]
  v_max_f32_e64 v248, v248, v203
  v_mov_b32_e32 v249, v248
  s_mov_b32 s56, s57
  v_mfma_f32_16x16x32_bf16 v[176:179], a[240:243], v[0:3], v[144:147]
  s_nop 1
  v_permlane16_swap_b32 v248, v249
  v_max_f32_e32 v248, v248, v249
  s_mov_b32 s60, 10
  v_mfma_f32_16x16x32_bf16 v[172:175], a[228:231], v[4:7], v[172:175]
  v_mov_b32_e32 v249, v248
  s_nop 1
  v_xor_b32_e64 v225, 32, v247
  v_mfma_f32_16x16x32_bf16 v[176:179], a[244:247], v[4:7], v[176:179]
  v_permlane32_swap_b32 v248, v249
  v_max_f32_e32 v248, v248, v249
  v_sub_f32_e64 v196, v196, v248
  v_xor_b32_e32 v227, 0x80, v254
  v_mfma_f32_16x16x32_bf16 v[172:175], a[232:235], v[8:11], v[172:175]
  v_sub_f32_e64 v197, v197, v248
  v_sub_f32_e64 v198, v198, v248
  v_sub_f32_e64 v199, v199, v248
  s_add_u32 m0, s59, 0x2480
  v_mfma_f32_16x16x32_bf16 v[176:179], a[248:251], v[8:11], v[176:179]
  v_sub_f32_e64 v200, v200, v248
  v_sub_f32_e64 v201, v201, v248
  v_sub_f32_e32 v202, v202, v248
  s_nop 0
  v_mfma_f32_16x16x32_bf16 v[172:175], a[236:239], v[12:15], v[172:175]
  v_sub_f32_e64 v203, v203, v248
  buffer_load_dwordx4 v228, s[28:31], s53 offen offset:128 nt lds
  v_mfma_f32_16x16x32_bf16 v[176:179], a[252:255], v[12:15], v[176:179]
  v_exp_f32_e64 v220, v196
  v_exp_f32_e32 v221, v197
  s_nop 0
  v_mfma_f32_16x16x32_bf16 a[160:163], v[112:115], v[208:211], 0
  v_add_f32_e64 v245, v245, v216
  buffer_load_dwordx4 v228, s[28:31], s53 offen offset:2176 nt lds
  v_mfma_f32_16x16x32_bf16 a[164:167], v[116:119], v[208:211], 0
  v_sub_f32_e64 v168, 0, v248
  v_cvt_pk_bf16_f32 v212, v220, v221
  v_exp_f32_e64 v222, v198
  v_mfma_f32_16x16x32_bf16 a[168:171], v[120:123], v[208:211], 0
  v_exp_f32_e64 v223, v199
  v_sub_f32_e64 v169, 0, v248
  v_cvt_pk_bf16_f32 v213, v222, v223
  v_mfma_f32_16x16x32_bf16 a[172:175], v[124:127], v[208:211], 0
  v_exp_f32_e64 v220, v200
  v_exp_f32_e64 v221, v201
  v_mfma_f32_16x16x32_bf16 a[176:179], v[128:131], v[208:211], 0
  v_sub_f32_e64 v170, 0, v248
  v_cvt_pk_bf16_f32 v214, v220, v221
  v_exp_f32_e64 v222, v202
  v_mfma_f32_16x16x32_bf16 a[180:183], v[132:135], v[208:211], 0
  v_exp_f32_e64 v223, v203
  v_sub_f32_e64 v171, 0, v248
  v_cvt_pk_bf16_f32 v215, v222, v223
  v_mfma_f32_16x16x32_bf16 a[184:187], v[136:139], v[208:211], 0
  v_mfma_f32_16x16x32_bf16 a[188:191], v[140:143], v[208:211], 0
.p2align 3
LOOP_A:
  v_mfma_f32_16x16x32_bf16 v[216:219], v[236:239], v[212:215], 0
  v_exp_f32_e64 v220, v172
  v_mfma_f32_16x16x32_bf16 v[180:183], a[224:227], v[16:19], v[148:151]
  v_exp_f32_e64 v221, v173
  v_mfma_f32_16x16x32_bf16 v[184:187], a[240:243], v[16:19], v[148:151]
  v_cvt_pk_bf16_f32 v204, v220, v221
  v_mfma_f32_16x16x32_bf16 v[180:183], a[228:231], v[20:23], v[180:183]
  v_exp_f32_e64 v222, v174
  v_mfma_f32_16x16x32_bf16 v[184:187], a[244:247], v[20:23], v[184:187]
  v_exp_f32_e64 v223, v175
  v_mfma_f32_16x16x32_bf16 v[180:183], a[232:235], v[24:27], v[180:183]
  v_cvt_pk_bf16_f32 v205, v222, v223
  v_cmp_lt_f32_e64 vcc, s61, v216
  v_mfma_f32_16x16x32_bf16 v[184:187], a[248:251], v[24:27], v[184:187]
  v_exp_f32_e64 v220, v176
  v_mfma_f32_16x16x32_bf16 v[180:183], a[236:239], v[28:31], v[180:183]
  v_exp_f32_e64 v221, v177
  v_mfma_f32_16x16x32_bf16 v[184:187], a[252:255], v[28:31], v[184:187]
  s_cbranch_vccnz RAREA_6
RETA_6:
  v_add_f32_e32 v246, v246, v216
  v_cvt_pk_bf16_f32 v206, v220, v221
  v_mfma_f32_16x16x32_bf16 a[192:195], v[112:115], v[212:215], a[192:195]
  v_exp_f32_e64 v222, v178
  v_mfma_f32_16x16x32_bf16 a[196:199], v[116:119], v[212:215], a[196:199]
  v_exp_f32_e64 v223, v179
  v_mfma_f32_16x16x32_bf16 a[200:203], v[120:123], v[212:215], a[200:203]
  v_cvt_pk_bf16_f32 v207, v222, v223
  ds_read_b64_tr_b16 v[112:113], v230 offset:0
  v_mfma_f32_16x16x32_bf16 a[204:207], v[124:127], v[212:215], a[204:207]
  ds_read_b64_tr_b16 v[114:115], v230 offset:4096
  ds_read_b64_tr_b16 v[116:117], v231 offset:0
  v_mfma_f32_16x16x32_bf16 a[208:211], v[128:131], v[212:215], a[208:211]
  ds_read_b64_tr_b16 v[118:119], v231 offset:4096
  ds_read_b64_tr_b16 v[120:121], v230 offset:512
  v_mfma_f32_16x16x32_bf16 a[212:215], v[132:135], v[212:215], a[212:215]
  ds_read_b64_tr_b16 v[122:123], v230 offset:4608
  ds_read_b64_tr_b16 v[124:125], v231 offset:512
  v_mfma_f32_16x16x32_bf16 a[216:219], v[136:139], v[212:215], a[216:219]
  ds_read_b64_tr_b16 v[126:127], v231 offset:4608
  ds_read_b64_tr_b16 v[128:129], v230 offset:1024
  v_mfma_f32_16x16x32_bf16 a[220:223], v[140:143], v[212:215], a[220:223]
  ds_read_b64_tr_b16 v[130:131], v230 offset:5120
  v_mfma_f32_16x16x32_bf16 v[216:219], v[236:239], v[204:207], 0
  ds_read_b64_tr_b16 v[132:133], v231 offset:1024
  ds_read_b64_tr_b16 v[134:135], v231 offset:5120
  v_mfma_f32_16x16x32_bf16 v[188:191], a[224:227], v[32:35], v[152:155]
  ds_read_b64_tr_b16 v[136:137], v230 offset:1536
  ds_read_b64_tr_b16 v[138:139], v230 offset:5632
  v_mfma_f32_16x16x32_bf16 v[192:195], a[240:243], v[32:35], v[152:155]
  v_exp_f32_e64 v220, v180
  v_mfma_f32_16x16x32_bf16 v[188:191], a[228:231], v[36:39], v[188:191]
  v_exp_f32_e64 v221, v181
  v_mfma_f32_16x16x32_bf16 v[192:195], a[244:247], v[36:39], v[192:195]
  v_cvt_pk_bf16_f32 v208, v220, v221
  v_cmp_lt_f32_e64 vcc, s61, v216
  v_mfma_f32_16x16x32_bf16 v[188:191], a[232:235], v[40:43], v[188:191]
  s_waitcnt lgkmcnt(4)
  v_exp_f32_e32 v222, v182
  v_mfma_f32_16x16x32_bf16 v[192:195], a[248:251], v[40:43], v[192:195]
  ds_read_b64_tr_b16 v[140:141], v231 offset:1536
  v_mfma_f32_16x16x32_bf16 v[188:191], a[236:239], v[44:47], v[188:191]
  s_cbranch_vccnz RAREA_0
RETA_0:
  v_exp_f32_e32 v223, v183
  v_mfma_f32_16x16x32_bf16 v[192:195], a[252:255], v[44:47], v[192:195]
  v_cvt_pk_bf16_f32 v209, v222, v223
  ds_read_b64_tr_b16 v[142:143], v231 offset:5632
  v_mfma_f32_16x16x32_bf16 a[0:3], v[112:115], v[204:207], a[0:3]
  v_exp_f32_e64 v220, v184
  v_mfma_f32_16x16x32_bf16 a[4:7], v[116:119], v[204:207], a[4:7]
  v_exp_f32_e64 v221, v185
  v_mfma_f32_16x16x32_bf16 a[8:11], v[120:123], v[204:207], a[8:11]
  v_cvt_pk_bf16_f32 v210, v220, v221
  v_add_f32_e64 v240, v240, v216
  v_mfma_f32_16x16x32_bf16 a[12:15], v[124:127], v[204:207], a[12:15]
  s_waitcnt lgkmcnt(2)
  v_exp_f32_e32 v222, v186
  v_mfma_f32_16x16x32_bf16 a[16:19], v[128:131], v[204:207], a[16:19]
  s_waitcnt lgkmcnt(0)
  v_exp_f32_e32 v223, v187
  v_mfma_f32_16x16x32_bf16 a[20:23], v[132:135], v[204:207], a[20:23]
  v_cvt_pk_bf16_f32 v211, v222, v223
  v_mfma_f32_16x16x32_bf16 a[24:27], v[136:139], v[204:207], a[24:27]
  v_mfma_f32_16x16x32_bf16 a[28:31], v[140:143], v[204:207], a[28:31]
  v_mfma_f32_16x16x32_bf16 v[216:219], v[236:239], v[208:211], 0
  s_waitcnt vmcnt(24)
  v_exp_f32_e32 v220, v188
  v_mfma_f32_16x16x32_bf16 v[172:175], a[224:227], v[48:51], v[156:159]
  s_barrier
  v_exp_f32_e32 v221, v189
  v_mfma_f32_16x16x32_bf16 v[176:179], a[240:243], v[48:51], v[156:159]
  v_cvt_pk_bf16_f32 v204, v220, v221
  v_mfma_f32_16x16x32_bf16 v[172:175], a[228:231], v[52:55], v[172:175]
  s_add_u32 s59, s11, s56
  v_exp_f32_e32 v222, v190
  v_mfma_f32_16x16x32_bf16 v[176:179], a[244:247], v[52:55], v[176:179]
  s_add_u32 s53, s53, 0x2000
  v_exp_f32_e64 v223, v191
  v_mfma_f32_16x16x32_bf16 v[172:175], a[232:235], v[56:59], v[172:175]
  v_cvt_pk_bf16_f32 v205, v222, v223
  v_cmp_lt_f32_e64 vcc, s61, v216
  v_mfma_f32_16x16x32_bf16 v[176:179], a[248:251], v[56:59], v[176:179]
  s_and_b32 s53, s53, 0x1ffff
  v_mfma_f32_16x16x32_bf16 v[172:175], a[236:239], v[60:63], v[172:175]
  v_exp_f32_e64 v220, v192
  v_mfma_f32_16x16x32_bf16 v[176:179], a[252:255], v[60:63], v[176:179]
  s_cbranch_vccnz RAREA_1
RETA_1:
  v_exp_f32_e32 v221, v193
  v_mfma_f32_16x16x32_bf16 a[32:35], v[112:115], v[208:211], a[32:35]
  s_add_u32 m0, s59, 0x100
  v_cvt_pk_bf16_f32 v206, v220, v221
  v_add_f32_e64 v241, v241, v216
  v_mfma_f32_16x16x32_bf16 a[36:39], v[116:119], v[208:211], a[36:39]
  buffer_load_dwordx4 v226, s[24:27], s53 offen offset:0 nt lds
  v_mfma_f32_16x16x32_bf16 a[40:43], v[120:123], v[208:211], a[40:43]
  v_exp_f32_e64 v222, v194
  v_mfma_f32_16x16x32_bf16 a[44:47], v[124:127], v[208:211], a[44:47]
  v_exp_f32_e64 v223, v195
  v_mfma_f32_16x16x32_bf16 a[48:51], v[128:131], v[208:211], a[48:51]
  v_cvt_pk_bf16_f32 v207, v222, v223
  v_mfma_f32_16x16x32_bf16 a[52:55], v[132:135], v[208:211], a[52:55]
  v_mfma_f32_16x16x32_bf16 a[56:59], v[136:139], v[208:211], a[56:59]
  buffer_load_dwordx4 v226, s[24:27], s53 offen offset:2048 nt lds
  v_mfma_f32_16x16x32_bf16 a[60:63], v[140:143], v[208:211], a[60:63]
  v_mfma_f32_16x16x32_bf16 v[216:219], v[236:239], v[204:207], 0
  s_add_u32 s57, s56, 0x4000
  v_exp_f32_e64 v220, v172
  v_mfma_f32_16x16x32_bf16 v[180:183], a[224:227], v[64:67], v[160:163]
  s_cmp_eq_u32 s57, 0x14000
  v_exp_f32_e64 v221, v173
  v_mfma_f32_16x16x32_bf16 v[184:187], a[240:243], v[64:67], v[160:163]
  v_cvt_pk_bf16_f32 v208, v220, v221
  v_mfma_f32_16x16x32_bf16 v[180:183], a[228:231], v[68:71], v[180:183]
  s_cselect_b32 s57, 0, s57
  v_exp_f32_e32 v222, v174
  v_mfma_f32_16x16x32_bf16 v[184:187], a[244:247], v[68:71], v[184:187]
  s_sub_u32 s58, s57, s56
  v_exp_f32_e32 v223, v175
  v_mfma_f32_16x16x32_bf16 v[180:183], a[232:235], v[72:75], v[180:183]
  v_cvt_pk_bf16_f32 v209, v222, v223
  v_cmp_lt_f32_e64 vcc, s61, v216
  v_mfma_f32_16x16x32_bf16 v[184:187], a[248:251], v[72:75], v[184:187]
  v_mfma_f32_16x16x32_bf16 v[180:183], a[236:239], v[76:79], v[180:183]
  v_exp_f32_e64 v220, v176
  v_mfma_f32_16x16x32_bf16 v[184:187], a[252:255], v[76:79], v[184:187]
  s_cbranch_vccnz RAREA_2
RETA_2:
  v_exp_f32_e32 v221, v177
  v_mfma_f32_16x16x32_bf16 a[64:67], v[112:115], v[204:207], a[64:67]
  s_add_u32 m0, s59, 0x480
  v_cvt_pk_bf16_f32 v210, v220, v221
  v_add_f32_e64 v242, v242, v216
  v_mfma_f32_16x16x32_bf16 a[68:71], v[116:119], v[204:207], a[68:71]
  buffer_load_dwordx4 v226, s[24:27], s53 offen offset:128 nt lds
  v_mfma_f32_16x16x32_bf16 a[72:75], v[120:123], v[204:207], a[72:75]
  v_exp_f32_e64 v222, v178
  v_mfma_f32_16x16x32_bf16 a[76:79], v[124:127], v[204:207], a[76:79]
  v_exp_f32_e64 v223, v179
  v_mfma_f32_16x16x32_bf16 a[80:83], v[128:131], v[204:207], a[80:83]
  v_cvt_pk_bf16_f32 v211, v222, v223
  v_mfma_f32_16x16x32_bf16 a[84:87], v[132:135], v[204:207], a[84:87]
  v_mfma_f32_16x16x32_bf16 a[88:91], v[136:139], v[204:207], a[88:91]
  buffer_load_dwordx4 v226, s[24:27], s53 offen offset:2176 nt lds
  v_mfma_f32_16x16x32_bf16 a[92:95], v[140:143], v[204:207], a[92:95]
  v_mfma_f32_16x16x32_bf16 v[216:219], v[236:239], v[208:211], 0
  v_exp_f32_e64 v220, v180
  v_mfma_f32_16x16x32_bf16 v[188:191], a[224:227], v[80:83], v[164:167]
  v_exp_f32_e64 v221, v181
  v_mfma_f32_16x16x32_bf16 v[192:195], a[240:243], v[80:83], v[164:167]
  v_cvt_pk_bf16_f32 v204, v220, v221
  v_add_u32_e64 v233, s58, v233
  v_mfma_f32_16x16x32_bf16 v[188:191], a[228:231], v[84:87], v[188:191]
  v_exp_f32_e64 v222, v182
  v_mfma_f32_16x16x32_bf16 v[192:195], a[244:247], v[84:87], v[192:195]
  v_exp_f32_e64 v223, v183
  v_mfma_f32_16x16x32_bf16 v[188:191], a[232:235], v[88:91], v[188:191]
  v_cvt_pk_bf16_f32 v205, v222, v223
  v_cmp_lt_f32_e64 vcc, s61, v216
  v_mfma_f32_16x16x32_bf16 v[192:195], a[248:251], v[88:91], v[192:195]
  v_add_u32_e64 v230, s58, v230
  v_mfma_f32_16x16x32_bf16 v[188:191], a[236:239], v[92:95], v[188:191]
  v_exp_f32_e64 v220, v184
  v_mfma_f32_16x16x32_bf16 v[192:195], a[252:255], v[92:95], v[192:195]
  s_cbranch_vccnz RAREA_3
RETA_3:
  v_exp_f32_e32 v221, v185
  v_mfma_f32_16x16x32_bf16 a[96:99], v[112:115], v[208:211], a[96:99]
  s_add_u32 m0, s59, 0x2100
  v_cvt_pk_bf16_f32 v206, v220, v221
  v_add_f32_e64 v243, v243, v216
  v_mfma_f32_16x16x32_bf16 a[100:103], v[116:119], v[208:211], a[100:103]
  buffer_load_dwordx4 v228, s[28:31], s53 offen offset:0 nt lds
  v_mfma_f32_16x16x32_bf16 a[104:107], v[120:123], v[208:211], a[104:107]
  v_exp_f32_e64 v222, v186
  v_mfma_f32_16x16x32_bf16 a[108:111], v[124:127], v[208:211], a[108:111]
  v_exp_f32_e64 v223, v187
  v_mfma_f32_16x16x32_bf16 a[112:115], v[128:131], v[208:211], a[112:115]
  v_cvt_pk_bf16_f32 v207, v222, v223
  v_add_u32_e64 v235, s58, v235
  v_mfma_f32_16x16x32_bf16 a[116:119], v[132:135], v[208:211], a[116:119]
  v_add_u32_e64 v231, s58, v231
  v_mfma_f32_16x16x32_bf16 a[120:123], v[136:139], v[208:211], a[120:123]
  buffer_load_dwordx4 v228, s[28:31], s53 offen offset:2048 nt lds
  v_mfma_f32_16x16x32_bf16 a[124:127], v[140:143], v[208:211], a[124:127]
  v_mfma_f32_16x16x32_bf16 v[216:219], v[236:239], v[204:207], 0
  s_mov_b32 s56, s57
  v_exp_f32_e32 v220, v188
  v_mfma_f32_16x16x32_bf16 v[196:199], a[224:227], v[96:99], v[168:171]
  v_exp_f32_e64 v221, v189
  v_mfma_f32_16x16x32_bf16 v[200:203], a[240:243], v[96:99], v[168:171]
  v_cvt_pk_bf16_f32 v208, v220, v221
  ds_read_b128 a[224:227], v233 offset:0
  v_mfma_f32_16x16x32_bf16 v[196:199], a[228:231], v[100:103], v[196:199]
  v_exp_f32_e64 v222, v190
  v_mfma_f32_16x16x32_bf16 v[200:203], a[244:247], v[100:103], v[200:203]
  v_exp_f32_e64 v223, v191
  v_mfma_f32_16x16x32_bf16 v[196:199], a[232:235], v[104:107], v[196:199]
  v_cvt_pk_bf16_f32 v209, v222, v223
  v_cmp_lt_f32_e64 vcc, s61, v216
  v_mfma_f32_16x16x32_bf16 v[200:203], a[248:251], v[104:107], v[200:203]
  ds_read_b128 a[240:243], v233 offset:4096
  ds_read_b128 a[228:231], v235 offset:0
  v_mfma_f32_16x16x32_bf16 v[196:199], a[236:239], v[108:111], v[196:199]
  v_exp_f32_e64 v220, v192
  v_mfma_f32_16x16x32_bf16 v[200:203], a[252:255], v[108:111], v[200:203]
  s_cbranch_vccnz RAREA_4
RETA_4:
  v_exp_f32_e32 v221, v193
  v_mfma_f32_16x16x32_bf16 a[128:131], v[112:115], v[204:207], a[128:131]
  v_cvt_pk_bf16_f32 v210, v220, v221
  v_add_f32_e64 v244, v244, v216
  v_mfma_f32_16x16x32_bf16 a[132:135], v[116:119], v[204:207], a[132:135]
  v_exp_f32_e64 v222, v194
  v_mfma_f32_16x16x32_bf16 a[136:139], v[120:123], v[204:207], a[136:139]
  v_exp_f32_e64 v223, v195
  v_mfma_f32_16x16x32_bf16 a[140:143], v[124:127], v[204:207], a[140:143]
  v_cvt_pk_bf16_f32 v211, v222, v223
  ds_read_b128 a[244:247], v235 offset:4096
  v_mfma_f32_16x16x32_bf16 a[144:147], v[128:131], v[204:207], a[144:147]
  ds_read_b128 a[232:235], v233 offset:1024
  v_mfma_f32_16x16x32_bf16 a[148:151], v[132:135], v[204:207], a[148:151]
  ds_read_b128 a[248:251], v233 offset:5120
  v_mfma_f32_16x16x32_bf16 a[152:155], v[136:139], v[204:207], a[152:155]
  ds_read_b128 a[236:239], v235 offset:1024
  v_mfma_f32_16x16x32_bf16 a[156:159], v[140:143], v[204:207], a[156:159]
  ds_read_b128 a[252:255], v235 offset:5120
  v_mfma_f32_16x16x32_bf16 v[216:219], v[236:239], v[208:211], 0
  s_waitcnt lgkmcnt(4)
  v_exp_f32_e32 v220, v196
  v_mfma_f32_16x16x32_bf16 v[172:175], a[224:227], v[0:3], v[144:147]
  v_exp_f32_e64 v221, v197
  v_mfma_f32_16x16x32_bf16 v[176:179], a[240:243], v[0:3], v[144:147]
  v_cvt_pk_bf16_f32 v212, v220, v221
  v_mfma_f32_16x16x32_bf16 v[172:175], a[228:231], v[4:7], v[172:175]
  v_exp_f32_e64 v222, v198
  v_mfma_f32_16x16x32_bf16 v[176:179], a[244:247], v[4:7], v[176:179]
  s_waitcnt lgkmcnt(2)
  v_exp_f32_e32 v223, v199
  v_mfma_f32_16x16x32_bf16 v[172:175], a[232:235], v[8:11], v[172:175]
  v_cvt_pk_bf16_f32 v213, v222, v223
  v_cmp_lt_f32_e64 vcc, s61, v216
  v_mfma_f32_16x16x32_bf16 v[176:179], a[248:251], v[8:11], v[176:179]
  s_waitcnt lgkmcnt(0)
  s_sub_u32 s60, s60, 1
  v_mfma_f32_16x16x32_bf16 v[172:175], a[236:239], v[12:15], v[172:175]
  v_exp_f32_e64 v220, v200
  v_mfma_f32_16x16x32_bf16 v[176:179], a[252:255], v[12:15], v[176:179]
  s_cbranch_vccnz RAREA_5
RETA_5:
  v_exp_f32_e32 v221, v201
  v_mfma_f32_16x16x32_bf16 a[160:163], v[112:115], v[208:211], a[160:163]
  s_add_u32 m0, s59, 0x2480
  v_cvt_pk_bf16_f32 v214, v220, v221
  v_add_f32_e64 v245, v245, v216
  v_mfma_f32_16x16x32_bf16 a[164:167], v[116:119], v[208:211], a[164:167]
  buffer_load_dwordx4 v228, s[28:31], s53 offen offset:128 nt lds
  v_mfma_f32_16x16x32_bf16 a[168:171], v[120:123], v[208:211], a[168:171]
  v_exp_f32_e64 v222, v202
  v_mfma_f32_16x16x32_bf16 a[172:175], v[124:127], v[208:211], a[172:175]
  v_exp_f32_e64 v223, v203
  v_mfma_f32_16x16x32_bf16 a[176:179], v[128:131], v[208:211], a[176:179]
  v_cvt_pk_bf16_f32 v215, v222, v223
  v_mfma_f32_16x16x32_bf16 a[180:183], v[132:135], v[208:211], a[180:183]
  v_mfma_f32_16x16x32_bf16 a[184:187], v[136:139], v[208:211], a[184:187]
  buffer_load_dwordx4 v228, s[28:31], s53 offen offset:2176 nt lds
  v_mfma_f32_16x16x32_bf16 a[188:191], v[140:143], v[208:211], a[188:191]
  s_cmp_lg_u32 s60, 0
  s_cbranch_scc1 LOOP_A
  s_mov_b32 s60, 5
  s_add_u32 s24, s4, 0
  s_add_u32 s25, s4, 0x8000
  s_add_u32 s26, s4, 0x10000
  s_add_u32 s27, s4, 0x18000
  s_add_u32 s28, s5, 0
  s_add_u32 s29, s6, 0
  s_add_u32 s30, s7, 0
  s_nop 0
  s_add_u32 s31, s5, 0x8000
  s_add_u32 s32, s6, 0x8000
  s_add_u32 s33, s7, 0x8000
.p2align 3
LOOP_B:
  v_mfma_f32_16x16x32_bf16 v[216:219], v[236:239], v[212:215], 0
  s_mov_b64 s[22:23], s[24:25]
  v_exp_f32_e32 v220, v172
  v_mfma_f32_16x16x32_bf16 v[180:183], a[224:227], v[16:19], v[148:151]
  s_mov_b64 s[24:25], s[26:27]
  v_exp_f32_e32 v221, v173
  v_mfma_f32_16x16x32_bf16 v[184:187], a[240:243], v[16:19], v[148:151]
  v_cvt_pk_bf16_f32 v204, v220, v221
  v_mfma_f32_16x16x32_bf16 v[180:183], a[228:231], v[20:23], v[180:183]
  s_mov_b64 s[26:27], s[28:29]
  v_exp_f32_e32 v222, v174
  v_mfma_f32_16x16x32_bf16 v[184:187], a[244:247], v[20:23], v[184:187]
  s_mov_b64 s[28:29], s[30:31]
  v_exp_f32_e32 v223, v175
  v_mfma_f32_16x16x32_bf16 v[180:183], a[232:235], v[24:27], v[180:183]
  v_cvt_pk_bf16_f32 v205, v222, v223
  v_cmp_lt_f32_e64 vcc, s61, v216
  v_mfma_f32_16x16x32_bf16 v[184:187], a[248:251], v[24:27], v[184:187]
  s_mov_b64 s[30:31], s[32:33]
  v_exp_f32_e32 v220, v176
  v_mfma_f32_16x16x32_bf16 v[180:183], a[236:239], v[28:31], v[180:183]
  v_exp_f32_e64 v221, v177
  v_mfma_f32_16x16x32_bf16 v[184:187], a[252:255], v[28:31], v[184:187]
  s_cbranch_vccnz RAREB_6
RETB_6:
  v_add_f32_e32 v246, v246, v216
  v_cvt_pk_bf16_f32 v206, v220, v221
  v_mfma_f32_16x16x32_bf16 a[192:195], v[112:115], v[212:215], a[192:195]
  v_exp_f32_e64 v222, v178
  v_mfma_f32_16x16x32_bf16 a[196:199], v[116:119], v[212:215], a[196:199]
  v_exp_f32_e64 v223, v179
  v_mfma_f32_16x16x32_bf16 a[200:203], v[120:123], v[212:215], a[200:203]
  v_cvt_pk_bf16_f32 v207, v222, v223
  ds_read_b64_tr_b16 v[112:113], v230 offset:0
  v_mfma_f32_16x16x32_bf16 a[204:207], v[124:127], v[212:215], a[204:207]
  ds_read_b64_tr_b16 v[114:115], v230 offset:4096
  ds_read_b64_tr_b16 v[116:117], v231 offset:0
  v_mfma_f32_16x16x32_bf16 a[208:211], v[128:131], v[212:215], a[208:211]
  ds_read_b64_tr_b16 v[118:119], v231 offset:4096
  ds_read_b64_tr_b16 v[120:121], v230 offset:512
  v_mfma_f32_16x16x32_bf16 a[212:215], v[132:135], v[212:215], a[212:215]
  ds_read_b64_tr_b16 v[122:123], v230 offset:4608
  ds_read_b64_tr_b16 v[124:125], v231 offset:512
  v_mfma_f32_16x16x32_bf16 a[216:219], v[136:139], v[212:215], a[216:219]
  ds_read_b64_tr_b16 v[126:127], v231 offset:4608
  ds_read_b64_tr_b16 v[128:129], v230 offset:1024
  v_mfma_f32_16x16x32_bf16 a[220:223], v[140:143], v[212:215], a[220:223]
  ds_read_b64_tr_b16 v[130:131], v230 offset:5120
  v_mfma_f32_16x16x32_bf16 v[216:219], v[236:239], v[204:207], 0
  ds_read_b64_tr_b16 v[132:133], v231 offset:1024
  ds_read_b64_tr_b16 v[134:135], v231 offset:5120
  v_mfma_f32_16x16x32_bf16 v[188:191], a[224:227], v[32:35], v[152:155]
  ds_read_b64_tr_b16 v[136:137], v230 offset:1536
  ds_read_b64_tr_b16 v[138:139], v230 offset:5632
  v_mfma_f32_16x16x32_bf16 v[192:195], a[240:243], v[32:35], v[152:155]
  v_exp_f32_e64 v220, v180
  v_mfma_f32_16x16x32_bf16 v[188:191], a[228:231], v[36:39], v[188:191]
  v_exp_f32_e64 v221, v181
  v_mfma_f32_16x16x32_bf16 v[192:195], a[244:247], v[36:39], v[192:195]
  v_cvt_pk_bf16_f32 v208, v220, v221
  v_cmp_lt_f32_e64 vcc, s61, v216
  v_mfma_f32_16x16x32_bf16 v[188:191], a[232:235], v[40:43], v[188:191]
  s_waitcnt lgkmcnt(4)
  v_exp_f32_e32 v222, v182
  v_mfma_f32_16x16x32_bf16 v[192:195], a[248:251], v[40:43], v[192:195]
  ds_read_b64_tr_b16 v[140:141], v231 offset:1536
  v_mfma_f32_16x16x32_bf16 v[188:191], a[236:239], v[44:47], v[188:191]
  s_cbranch_vccnz RAREB_0
RETB_0:
  v_exp_f32_e32 v223, v183
  v_mfma_f32_16x16x32_bf16 v[192:195], a[252:255], v[44:47], v[192:195]
  v_cvt_pk_bf16_f32 v209, v222, v223
  ds_read_b64_tr_b16 v[142:143], v231 offset:5632
  v_mfma_f32_16x16x32_bf16 a[0:3], v[112:115], v[204:207], a[0:3]
  v_exp_f32_e64 v220, v184
  v_mfma_f32_16x16x32_bf16 a[4:7], v[116:119], v[204:207], a[4:7]
  v_exp_f32_e64 v221, v185
  v_mfma_f32_16x16x32_bf16 a[8:11], v[120:123], v[204:207], a[8:11]
  v_cvt_pk_bf16_f32 v210, v220, v221
  v_add_f32_e64 v240, v240, v216
  v_mfma_f32_16x16x32_bf16 a[12:15], v[124:127], v[204:207], a[12:15]
  s_waitcnt lgkmcnt(2)
  v_exp_f32_e32 v222, v186
  v_mfma_f32_16x16x32_bf16 a[16:19], v[128:131], v[204:207], a[16:19]
  s_waitcnt lgkmcnt(0)
  v_exp_f32_e32 v223, v187
  v_mfma_f32_16x16x32_bf16 a[20:23], v[132:135], v[204:207], a[20:23]
  v_cvt_pk_bf16_f32 v211, v222, v223
  v_mfma_f32_16x16x32_bf16 a[24:27], v[136:139], v[204:207], a[24:27]
  v_mfma_f32_16x16x32_bf16 a[28:31], v[140:143], v[204:207], a[28:31]
  v_mfma_f32_16x16x32_bf16 v[216:219], v[236:239], v[208:211], 0
  s_waitcnt vmcnt(24)
  v_exp_f32_e32 v220, v188
  v_mfma_f32_16x16x32_bf16 v[172:175], a[224:227], v[48:51], v[156:159]
  s_barrier
  v_exp_f32_e32 v221, v189
  v_mfma_f32_16x16x32_bf16 v[176:179], a[240:243], v[48:51], v[156:159]
  v_cvt_pk_bf16_f32 v204, v220, v221
  v_mfma_f32_16x16x32_bf16 v[172:175], a[228:231], v[52:55], v[172:175]
  s_add_u32 s59, s11, s56
  v_exp_f32_e32 v222, v190
  v_mfma_f32_16x16x32_bf16 v[176:179], a[244:247], v[52:55], v[176:179]
  v_exp_f32_e64 v223, v191
  v_mfma_f32_16x16x32_bf16 v[172:175], a[232:235], v[56:59], v[172:175]
  v_cvt_pk_bf16_f32 v205, v222, v223
  v_cmp_lt_f32_e64 vcc, s61, v216
  v_mfma_f32_16x16x32_bf16 v[176:179], a[248:251], v[56:59], v[176:179]
  v_mfma_f32_16x16x32_bf16 v[172:175], a[236:239], v[60:63], v[172:175]
  v_exp_f32_e64 v220, v192
  v_mfma_f32_16x16x32_bf16 v[176:179], a[252:255], v[60:63], v[176:179]
  s_cbranch_vccnz RAREB_1
RETB_1:
  v_exp_f32_e32 v221, v193
  v_mfma_f32_16x16x32_bf16 a[32:35], v[112:115], v[208:211], a[32:35]
  s_add_u32 m0, s59, 0x100
  v_cvt_pk_bf16_f32 v206, v220, v221
  v_add_f32_e64 v241, v241, v216
  v_mfma_f32_16x16x32_bf16 a[36:39], v[116:119], v[208:211], a[36:39]
  buffer_load_dwordx4 v254, s[36:39], s22 offen offset:0 lds
  v_mfma_f32_16x16x32_bf16 a[40:43], v[120:123], v[208:211], a[40:43]
  v_exp_f32_e64 v222, v194
  v_mfma_f32_16x16x32_bf16 a[44:47], v[124:127], v[208:211], a[44:47]
  v_exp_f32_e64 v223, v195
  v_mfma_f32_16x16x32_bf16 a[48:51], v[128:131], v[208:211], a[48:51]
  v_cvt_pk_bf16_f32 v207, v222, v223
  v_mfma_f32_16x16x32_bf16 a[52:55], v[132:135], v[208:211], a[52:55]
  s_add_u32 m0, s59, 0x500
  v_mfma_f32_16x16x32_bf16 a[56:59], v[136:139], v[208:211], a[56:59]
  buffer_load_dwordx4 v227, s[36:39], s22 offen offset:0 lds
  v_mfma_f32_16x16x32_bf16 a[60:63], v[140:143], v[208:211], a[60:63]
  v_mfma_f32_16x16x32_bf16 v[216:219], v[236:239], v[204:207], 0
  s_add_u32 s57, s56, 0x4000
  v_exp_f32_e64 v220, v172
  v_mfma_f32_16x16x32_bf16 v[180:183], a[224:227], v[64:67], v[160:163]
  s_cmp_eq_u32 s57, 0x14000
  v_exp_f32_e64 v221, v173
  v_mfma_f32_16x16x32_bf16 v[184:187], a[240:243], v[64:67], v[160:163]
  v_cvt_pk_bf16_f32 v208, v220, v221
  v_mfma_f32_16x16x32_bf16 v[180:183], a[228:231], v[68:71], v[180:183]
  s_cselect_b32 s57, 0, s57
  v_exp_f32_e32 v222, v174
  v_mfma_f32_16x16x32_bf16 v[184:187], a[244:247], v[68:71], v[184:187]
  s_sub_u32 s58, s57, s56
  v_exp_f32_e32 v223, v175
  v_mfma_f32_16x16x32_bf16 v[180:183], a[232:235], v[72:75], v[180:183]
  v_cvt_pk_bf16_f32 v209, v222, v223
  v_cmp_lt_f32_e64 vcc, s61, v216
  v_mfma_f32_16x16x32_bf16 v[184:187], a[248:251], v[72:75], v[184:187]
  v_mfma_f32_16x16x32_bf16 v[180:183], a[236:239], v[76:79], v[180:183]
  s_add_u32 s51, s22, 0x2000
  v_exp_f32_e64 v220, v176
  v_mfma_f32_16x16x32_bf16 v[184:187], a[252:255], v[76:79], v[184:187]
  s_cbranch_vccnz RAREB_2
RETB_2:
  v_exp_f32_e32 v221, v177
  v_mfma_f32_16x16x32_bf16 a[64:67], v[112:115], v[204:207], a[64:67]
  s_add_u32 m0, s59, 0x900
  v_cvt_pk_bf16_f32 v210, v220, v221
  v_add_f32_e64 v242, v242, v216
  v_mfma_f32_16x16x32_bf16 a[68:71], v[116:119], v[204:207], a[68:71]
  buffer_load_dwordx4 v254, s[36:39], s51 offen offset:0 lds
  v_mfma_f32_16x16x32_bf16 a[72:75], v[120:123], v[204:207], a[72:75]
  v_exp_f32_e64 v222, v178
  v_mfma_f32_16x16x32_bf16 a[76:79], v[124:127], v[204:207], a[76:79]
  v_exp_f32_e64 v223, v179
  v_mfma_f32_16x16x32_bf16 a[80:83], v[128:131], v[204:207], a[80:83]
  v_cvt_pk_bf16_f32 v211, v222, v223
  v_mfma_f32_16x16x32_bf16 a[84:87], v[132:135], v[204:207], a[84:87]
  s_add_u32 m0, s59, 0xd00
  v_mfma_f32_16x16x32_bf16 a[88:91], v[136:139], v[204:207], a[88:91]
  buffer_load_dwordx4 v227, s[36:39], s51 offen offset:0 lds
  v_mfma_f32_16x16x32_bf16 a[92:95], v[140:143], v[204:207], a[92:95]
  v_mfma_f32_16x16x32_bf16 v[216:219], v[236:239], v[208:211], 0
  v_exp_f32_e64 v220, v180
  v_mfma_f32_16x16x32_bf16 v[188:191], a[224:227], v[80:83], v[164:167]
  v_exp_f32_e64 v221, v181
  v_mfma_f32_16x16x32_bf16 v[192:195], a[240:243], v[80:83], v[164:167]
  v_cvt_pk_bf16_f32 v204, v220, v221
  v_add_u32_e64 v233, s58, v233
  v_mfma_f32_16x16x32_bf16 v[188:191], a[228:231], v[84:87], v[188:191]
  v_exp_f32_e64 v222, v182
  v_mfma_f32_16x16x32_bf16 v[192:195], a[244:247], v[84:87], v[192:195]
  v_exp_f32_e64 v223, v183
  v_mfma_f32_16x16x32_bf16 v[188:191], a[232:235], v[88:91], v[188:191]
  v_cvt_pk_bf16_f32 v205, v222, v223
  v_cmp_lt_f32_e64 vcc, s61, v216
  v_mfma_f32_16x16x32_bf16 v[192:195], a[248:251], v[88:91], v[192:195]
  v_add_u32_e64 v230, s58, v230
  v_mfma_f32_16x16x32_bf16 v[188:191], a[236:239], v[92:95], v[188:191]
  v_exp_f32_e64 v220, v184
  v_mfma_f32_16x16x32_bf16 v[192:195], a[252:255], v[92:95], v[192:195]
  s_cbranch_vccnz RAREB_3
RETB_3:
  v_exp_f32_e32 v221, v185
  v_mfma_f32_16x16x32_bf16 a[96:99], v[112:115], v[208:211], a[96:99]
  s_add_u32 m0, s59, 0x2100
  v_cvt_pk_bf16_f32 v206, v220, v221
  v_add_f32_e64 v243, v243, v216
  v_mfma_f32_16x16x32_bf16 a[100:103], v[116:119], v[208:211], a[100:103]
  buffer_load_dwordx4 v254, s[36:39], s23 offen offset:0 lds
  v_mfma_f32_16x16x32_bf16 a[104:107], v[120:123], v[208:211], a[104:107]
  v_exp_f32_e64 v222, v186
  v_mfma_f32_16x16x32_bf16 a[108:111], v[124:127], v[208:211], a[108:111]
  v_exp_f32_e64 v223, v187
  v_mfma_f32_16x16x32_bf16 a[112:115], v[128:131], v[208:211], a[112:115]
  v_cvt_pk_bf16_f32 v207, v222, v223
  v_add_u32_e64 v235, s58, v235
  v_mfma_f32_16x16x32_bf16 a[116:119], v[132:135], v[208:211], a[116:119]
  s_add_u32 m0, s59, 0x2500
  v_add_u32_e64 v231, s58, v231
  v_mfma_f32_16x16x32_bf16 a[120:123], v[136:139], v[208:211], a[120:123]
  buffer_load_dwordx4 v227, s[36:39], s23 offen offset:0 lds
  v_mfma_f32_16x16x32_bf16 a[124:127], v[140:143], v[208:211], a[124:127]
  v_mfma_f32_16x16x32_bf16 v[216:219], v[236:239], v[204:207], 0
  s_mov_b32 s56, s57
  v_exp_f32_e32 v220, v188
  v_mfma_f32_16x16x32_bf16 v[196:199], a[224:227], v[96:99], v[168:171]
  v_exp_f32_e64 v221, v189
  v_mfma_f32_16x16x32_bf16 v[200:203], a[240:243], v[96:99], v[168:171]
  v_cvt_pk_bf16_f32 v208, v220, v221
  ds_read_b128 a[224:227], v233 offset:0
  v_mfma_f32_16x16x32_bf16 v[196:199], a[228:231], v[100:103], v[196:199]
  v_exp_f32_e64 v222, v190
  v_mfma_f32_16x16x32_bf16 v[200:203], a[244:247], v[100:103], v[200:203]
  v_exp_f32_e64 v223, v191
  v_mfma_f32_16x16x32_bf16 v[196:199], a[232:235], v[104:107], v[196:199]
  v_cvt_pk_bf16_f32 v209, v222, v223
  v_cmp_lt_f32_e64 vcc, s61, v216
  v_mfma_f32_16x16x32_bf16 v[200:203], a[248:251], v[104:107], v[200:203]
  ds_read_b128 a[240:243], v233 offset:4096
  ds_read_b128 a[228:231], v235 offset:0
  v_mfma_f32_16x16x32_bf16 v[196:199], a[236:239], v[108:111], v[196:199]
  v_exp_f32_e64 v220, v192
  v_mfma_f32_16x16x32_bf16 v[200:203], a[252:255], v[108:111], v[200:203]
  s_cbranch_vccnz RAREB_4
RETB_4:
  v_exp_f32_e32 v221, v193
  v_mfma_f32_16x16x32_bf16 a[128:131], v[112:115], v[204:207], a[128:131]
  v_cvt_pk_bf16_f32 v210, v220, v221
  v_add_f32_e64 v244, v244, v216
  v_mfma_f32_16x16x32_bf16 a[132:135], v[116:119], v[204:207], a[132:135]
  v_exp_f32_e64 v222, v194
  v_mfma_f32_16x16x32_bf16 a[136:139], v[120:123], v[204:207], a[136:139]
  v_exp_f32_e64 v223, v195
  v_mfma_f32_16x16x32_bf16 a[140:143], v[124:127], v[204:207], a[140:143]
  v_cvt_pk_bf16_f32 v211, v222, v223
  ds_read_b128 a[244:247], v235 offset:4096
  v_mfma_f32_16x16x32_bf16 a[144:147], v[128:131], v[204:207], a[144:147]
  ds_read_b128 a[232:235], v233 offset:1024
  v_mfma_f32_16x16x32_bf16 a[148:151], v[132:135], v[204:207], a[148:151]
  ds_read_b128 a[248:251], v233 offset:5120
  v_mfma_f32_16x16x32_bf16 a[152:155], v[136:139], v[204:207], a[152:155]
  ds_read_b128 a[236:239], v235 offset:1024
  v_mfma_f32_16x16x32_bf16 a[156:159], v[140:143], v[204:207], a[156:159]
  ds_read_b128 a[252:255], v235 offset:5120
  v_mfma_f32_16x16x32_bf16 v[216:219], v[236:239], v[208:211], 0
  s_waitcnt lgkmcnt(4)
  v_exp_f32_e32 v220, v196
  v_mfma_f32_16x16x32_bf16 v[172:175], a[224:227], v[0:3], v[144:147]
  v_exp_f32_e64 v221, v197
  v_mfma_f32_16x16x32_bf16 v[176:179], a[240:243], v[0:3], v[144:147]
  v_cvt_pk_bf16_f32 v212, v220, v221
  v_mfma_f32_16x16x32_bf16 v[172:175], a[228:231], v[4:7], v[172:175]
  v_exp_f32_e64 v222, v198
  v_mfma_f32_16x16x32_bf16 v[176:179], a[244:247], v[4:7], v[176:179]
  s_waitcnt lgkmcnt(2)
  v_exp_f32_e32 v223, v199
  v_mfma_f32_16x16x32_bf16 v[172:175], a[232:235], v[8:11], v[172:175]
  v_cvt_pk_bf16_f32 v213, v222, v223
  v_cmp_lt_f32_e64 vcc, s61, v216
  v_mfma_f32_16x16x32_bf16 v[176:179], a[248:251], v[8:11], v[176:179]
  s_waitcnt lgkmcnt(0)
  s_sub_u32 s60, s60, 1
  v_mfma_f32_16x16x32_bf16 v[172:175], a[236:239], v[12:15], v[172:175]
  s_add_u32 s51, s23, 0x2000
  v_exp_f32_e64 v220, v200
  v_mfma_f32_16x16x32_bf16 v[176:179], a[252:255], v[12:15], v[176:179]
  s_cbranch_vccnz RAREB_5
RETB_5:
  v_exp_f32_e32 v221, v201
  v_mfma_f32_16x16x32_bf16 a[160:163], v[112:115], v[208:211], a[160:163]
  s_add_u32 m0, s59, 0x2900
  v_cvt_pk_bf16_f32 v214, v220, v221
  v_add_f32_e64 v245, v245, v216
  v_mfma_f32_16x16x32_bf16 a[164:167], v[116:119], v[208:211], a[164:167]
  buffer_load_dwordx4 v254, s[36:39], s51 offen offset:0 lds
  v_mfma_f32_16x16x32_bf16 a[168:171], v[120:123], v[208:211], a[168:171]
  v_exp_f32_e64 v222, v202
  v_mfma_f32_16x16x32_bf16 a[172:175], v[124:127], v[208:211], a[172:175]
  v_exp_f32_e64 v223, v203
  v_mfma_f32_16x16x32_bf16 a[176:179], v[128:131], v[208:211], a[176:179]
  v_cvt_pk_bf16_f32 v215, v222, v223
  v_mfma_f32_16x16x32_bf16 a[180:183], v[132:135], v[208:211], a[180:183]
  s_add_u32 m0, s59, 0x2d00
  v_mfma_f32_16x16x32_bf16 a[184:187], v[136:139], v[208:211], a[184:187]
  buffer_load_dwordx4 v227, s[36:39], s51 offen offset:0 lds
  v_mfma_f32_16x16x32_bf16 a[188:191], v[140:143], v[208:211], a[188:191]
  s_cmp_lg_u32 s60, 0
  s_cbranch_scc1 LOOP_B
  v_mfma_f32_16x16x32_bf16 v[216:219], v[236:239], v[212:215], 0
  v_add_u32_e32 v230, 0x10000, v247
  v_add_u32_e32 v231, 0x10000, v225
  ds_read_b64_tr_b16 a[224:225], v230 offset:0
  ds_read_b64_tr_b16 a[226:227], v230 offset:4096
  ds_read_b64_tr_b16 a[228:229], v231 offset:0
  ds_read_b64_tr_b16 a[230:231], v231 offset:4096
  ds_read_b64_tr_b16 a[232:233], v230 offset:512
  ds_read_b64_tr_b16 a[234:235], v230 offset:4608
  ds_read_b64_tr_b16 a[236:237], v231 offset:512
  ds_read_b64_tr_b16 a[238:239], v231 offset:4608
  v_cmp_lt_f32_e32 vcc, s61, v216
  s_cbranch_vccnz RAREF_6
RETF_6:
  v_add_f32_e32 v246, v246, v216
  s_mov_b32 s32, s16
  s_mov_b32 s33, s17
  s_nop 0
  s_mov_b32 s34, 0x100
  s_mov_b32 s35, 0x20000
  s_mov_b32 s20, s14
  s_mov_b32 s21, s15
  s_mov_b32 s22, 0x380000
  s_mov_b32 s23, 0x20000
  s_mov_b32 s52, 0x30d40
  buffer_load_dword v253, off, s[32:35], 0 sc1
  v_mfma_f32_16x16x32_bf16 a[192:195], v[112:115], v[212:215], a[192:195]
  v_rcp_f32_e64 v144, v240
  v_rcp_f32_e64 v146, v241
  v_mfma_f32_16x16x32_bf16 a[196:199], v[116:119], v[212:215], a[196:199]
  v_rcp_f32_e64 v148, v242
  v_rcp_f32_e64 v150, v243
  v_mfma_f32_16x16x32_bf16 a[200:203], v[120:123], v[212:215], a[200:203]
  v_rcp_f32_e64 v152, v244
  v_rcp_f32_e64 v154, v245
  v_mfma_f32_16x16x32_bf16 a[204:207], v[124:127], v[212:215], a[204:207]
  v_rcp_f32_e64 v156, v246
  v_mfma_f32_16x16x32_bf16 a[208:211], v[128:131], v[212:215], a[208:211]
  ds_read_b64_tr_b16 a[240:241], v230 offset:1024
  ds_read_b64_tr_b16 a[242:243], v230 offset:5120
  v_mfma_f32_16x16x32_bf16 a[212:215], v[132:135], v[212:215], a[212:215]
  ds_read_b64_tr_b16 a[244:245], v231 offset:1024
  ds_read_b64_tr_b16 a[246:247], v231 offset:5120
  v_mfma_f32_16x16x32_bf16 a[216:219], v[136:139], v[212:215], a[216:219]
  ds_read_b64_tr_b16 a[248:249], v230 offset:1536
  ds_read_b64_tr_b16 a[250:251], v230 offset:5632
  v_mfma_f32_16x16x32_bf16 a[220:223], v[140:143], v[212:215], a[220:223]
  ds_read_b64_tr_b16 a[252:253], v231 offset:1536
  ds_read_b64_tr_b16 a[254:255], v231 offset:5632
  v_accvgpr_read_b32 v200, a0
  v_accvgpr_read_b32 v201, a1
  v_accvgpr_read_b32 v202, a2
  v_accvgpr_read_b32 v203, a3
  v_accvgpr_read_b32 v204, a4
  v_accvgpr_read_b32 v205, a5
  v_accvgpr_read_b32 v206, a6
  v_accvgpr_read_b32 v207, a7
  v_pk_mul_f32 v[200:201], v[200:201], v[144:145] op_sel_hi:[1,0]
  v_pk_mul_f32 v[202:203], v[202:203], v[144:145] op_sel_hi:[1,0]
  v_pk_mul_f32 v[204:205], v[204:205], v[144:145] op_sel_hi:[1,0]
  v_pk_mul_f32 v[206:207], v[206:207], v[144:145] op_sel_hi:[1,0]
  v_cvt_pk_bf16_f32 v0, v200, v201
  v_cvt_pk_bf16_f32 v1, v202, v203
  v_cvt_pk_bf16_f32 v2, v204, v205
  v_cvt_pk_bf16_f32 v3, v206, v207
  s_add_u32 s54, s62, 0
  s_nop 0
  buffer_store_dwordx4 v[0:3], v234, s[40:43], s54 offen offset:0 sc1
  v_accvgpr_read_b32 v208, a8
  v_accvgpr_read_b32 v209, a9
  v_accvgpr_read_b32 v210, a10
  v_accvgpr_read_b32 v211, a11
  v_accvgpr_read_b32 v212, a12
  v_accvgpr_read_b32 v213, a13
  v_accvgpr_read_b32 v214, a14
  v_accvgpr_read_b32 v215, a15
  v_pk_mul_f32 v[208:209], v[208:209], v[144:145] op_sel_hi:[1,0]
  v_pk_mul_f32 v[210:211], v[210:211], v[144:145] op_sel_hi:[1,0]
  v_pk_mul_f32 v[212:213], v[212:213], v[144:145] op_sel_hi:[1,0]
  v_pk_mul_f32 v[214:215], v[214:215], v[144:145] op_sel_hi:[1,0]
  v_cvt_pk_bf16_f32 v28, v208, v209
  v_cvt_pk_bf16_f32 v29, v210, v211
  v_cvt_pk_bf16_f32 v30, v212, v213
  v_cvt_pk_bf16_f32 v31, v214, v215
  s_add_u32 s54, s62, 0x1c00
  buffer_store_dwordx4 v[28:31], v234, s[40:43], s54 offen offset:0 sc1
  v_accvgpr_read_b32 v200, a16
  v_accvgpr_read_b32 v201, a17
  v_accvgpr_read_b32 v202, a18
  v_accvgpr_read_b32 v203, a19
  v_accvgpr_read_b32 v204, a20
  v_accvgpr_read_b32 v205, a21
  v_accvgpr_read_b32 v206, a22
  v_accvgpr_read_b32 v207, a23
  v_pk_mul_f32 v[200:201], v[200:201], v[144:145] op_sel_hi:[1,0]
  v_pk_mul_f32 v[202:203], v[202:203], v[144:145] op_sel_hi:[1,0]
  v_pk_mul_f32 v[204:205], v[204:205], v[144:145] op_sel_hi:[1,0]
  v_pk_mul_f32 v[206:207], v[206:207], v[144:145] op_sel_hi:[1,0]
  v_cvt_pk_bf16_f32 v56, v200, v201
  v_cvt_pk_bf16_f32 v57, v202, v203
  v_cvt_pk_bf16_f32 v58, v204, v205
  v_cvt_pk_bf16_f32 v59, v206, v207
  s_add_u32 s54, s62, 0x3800
  buffer_store_dwordx4 v[56:59], v234, s[40:43], s54 offen offset:0 sc1
  v_accvgpr_read_b32 v208, a24
  v_accvgpr_read_b32 v209, a25
  v_accvgpr_read_b32 v210, a26
  v_accvgpr_read_b32 v211, a27
  v_accvgpr_read_b32 v212, a28
  v_accvgpr_read_b32 v213, a29
  v_accvgpr_read_b32 v214, a30
  v_accvgpr_read_b32 v215, a31
  v_pk_mul_f32 v[208:209], v[208:209], v[144:145] op_sel_hi:[1,0]
  v_pk_mul_f32 v[210:211], v[210:211], v[144:145] op_sel_hi:[1,0]
  v_pk_mul_f32 v[212:213], v[212:213], v[144:145] op_sel_hi:[1,0]
  v_pk_mul_f32 v[214:215], v[214:215], v[144:145] op_sel_hi:[1,0]
  v_cvt_pk_bf16_f32 v84, v208, v209
  v_cvt_pk_bf16_f32 v85, v210, v211
  v_cvt_pk_bf16_f32 v86, v212, v213
  v_cvt_pk_bf16_f32 v87, v214, v215
  s_add_u32 s54, s62, 0x5400
  buffer_store_dwordx4 v[84:87], v234, s[40:43], s54 offen offset:0 sc1
  s_waitcnt lgkmcnt(0)
  s_nop 0
  v_mfma_f32_16x16x32_bf16 a[0:3], a[224:227], v[0:3], 0
  v_accvgpr_read_b32 v200, a32
  v_accvgpr_read_b32 v201, a33
  v_mfma_f32_16x16x32_bf16 a[4:7], a[228:231], v[0:3], 0
  v_accvgpr_read_b32 v202, a34
  v_accvgpr_read_b32 v203, a35
  v_mfma_f32_16x16x32_bf16 a[8:11], a[232:235], v[0:3], 0
  v_accvgpr_read_b32 v204, a36
  v_accvgpr_read_b32 v205, a37
  v_mfma_f32_16x16x32_bf16 a[12:15], a[236:239], v[0:3], 0
  v_accvgpr_read_b32 v206, a38
  v_accvgpr_read_b32 v207, a39
  v_mfma_f32_16x16x32_bf16 a[16:19], a[240:243], v[0:3], 0
  v_pk_mul_f32 v[200:201], v[200:201], v[146:147] op_sel_hi:[1,0]
  v_pk_mul_f32 v[202:203], v[202:203], v[146:147] op_sel_hi:[1,0]
  v_mfma_f32_16x16x32_bf16 a[20:23], a[244:247], v[0:3], 0
  v_pk_mul_f32 v[204:205], v[204:205], v[146:147] op_sel_hi:[1,0]
  v_pk_mul_f32 v[206:207], v[206:207], v[146:147] op_sel_hi:[1,0]
  v_mfma_f32_16x16x32_bf16 a[24:27], a[248:251], v[0:3], 0
  v_cvt_pk_bf16_f32 v4, v200, v201
  v_cvt_pk_bf16_f32 v5, v202, v203
  v_mfma_f32_16x16x32_bf16 a[28:31], a[252:255], v[0:3], 0
  v_cvt_pk_bf16_f32 v6, v204, v205
  v_cvt_pk_bf16_f32 v7, v206, v207
  s_add_u32 s54, s62, 0
  s_nop 0
  buffer_store_dwordx4 v[4:7], v234, s[40:43], s54 offen offset:1024 sc1
  v_accvgpr_read_b32 v208, a40
  v_accvgpr_read_b32 v209, a41
  v_accvgpr_read_b32 v210, a42
  v_accvgpr_read_b32 v211, a43
  v_accvgpr_read_b32 v212, a44
  v_accvgpr_read_b32 v213, a45
  v_accvgpr_read_b32 v214, a46
  v_accvgpr_read_b32 v215, a47
  v_pk_mul_f32 v[208:209], v[208:209], v[146:147] op_sel_hi:[1,0]
  v_pk_mul_f32 v[210:211], v[210:211], v[146:147] op_sel_hi:[1,0]
  v_pk_mul_f32 v[212:213], v[212:213], v[146:147] op_sel_hi:[1,0]
  v_pk_mul_f32 v[214:215], v[214:215], v[146:147] op_sel_hi:[1,0]
  v_cvt_pk_bf16_f32 v32, v208, v209
  v_cvt_pk_bf16_f32 v33, v210, v211
  v_cvt_pk_bf16_f32 v34, v212, v213
  v_cvt_pk_bf16_f32 v35, v214, v215
  s_add_u32 s54, s62, 0x1c00
  buffer_store_dwordx4 v[32:35], v234, s[40:43], s54 offen offset:1024 sc1
  v_accvgpr_read_b32 v200, a48
  v_accvgpr_read_b32 v201, a49
  v_accvgpr_read_b32 v202, a50
  v_accvgpr_read_b32 v203, a51
  v_accvgpr_read_b32 v204, a52
  v_accvgpr_read_b32 v205, a53
  v_accvgpr_read_b32 v206, a54
  v_accvgpr_read_b32 v207, a55
  v_pk_mul_f32 v[200:201], v[200:201], v[146:147] op_sel_hi:[1,0]
  v_pk_mul_f32 v[202:203], v[202:203], v[146:147] op_sel_hi:[1,0]
  v_pk_mul_f32 v[204:205], v[204:205], v[146:147] op_sel_hi:[1,0]
  v_pk_mul_f32 v[206:207], v[206:207], v[146:147] op_sel_hi:[1,0]
  v_cvt_pk_bf16_f32 v60, v200, v201
  v_cvt_pk_bf16_f32 v61, v202, v203
  v_cvt_pk_bf16_f32 v62, v204, v205
  v_cvt_pk_bf16_f32 v63, v206, v207
  s_add_u32 s54, s62, 0x3800
  buffer_store_dwordx4 v[60:63], v234, s[40:43], s54 offen offset:1024 sc1
  v_accvgpr_read_b32 v208, a56
  v_accvgpr_read_b32 v209, a57
  v_accvgpr_read_b32 v210, a58
  v_accvgpr_read_b32 v211, a59
  v_accvgpr_read_b32 v212, a60
  v_accvgpr_read_b32 v213, a61
  v_accvgpr_read_b32 v214, a62
  v_accvgpr_read_b32 v215, a63
  v_pk_mul_f32 v[208:209], v[208:209], v[146:147] op_sel_hi:[1,0]
  v_pk_mul_f32 v[210:211], v[210:211], v[146:147] op_sel_hi:[1,0]
  v_pk_mul_f32 v[212:213], v[212:213], v[146:147] op_sel_hi:[1,0]
  v_pk_mul_f32 v[214:215], v[214:215], v[146:147] op_sel_hi:[1,0]
  v_cvt_pk_bf16_f32 v88, v208, v209
  v_cvt_pk_bf16_f32 v89, v210, v211
  v_cvt_pk_bf16_f32 v90, v212, v213
  v_cvt_pk_bf16_f32 v91, v214, v215
  s_add_u32 s54, s62, 0x5400
  buffer_store_dwordx4 v[88:91], v234, s[40:43], s54 offen offset:1024 sc1
  s_nop 0
  s_nop 0
  v_mfma_f32_16x16x32_bf16 a[32:35], a[224:227], v[4:7], 0
  v_accvgpr_read_b32 v200, a64
  v_accvgpr_read_b32 v201, a65
  v_mfma_f32_16x16x32_bf16 a[36:39], a[228:231], v[4:7], 0
  v_accvgpr_read_b32 v202, a66
  v_accvgpr_read_b32 v203, a67
  v_mfma_f32_16x16x32_bf16 a[40:43], a[232:235], v[4:7], 0
  v_accvgpr_read_b32 v204, a68
  v_accvgpr_read_b32 v205, a69
  v_mfma_f32_16x16x32_bf16 a[44:47], a[236:239], v[4:7], 0
  v_accvgpr_read_b32 v206, a70
  v_accvgpr_read_b32 v207, a71
  v_mfma_f32_16x16x32_bf16 a[48:51], a[240:243], v[4:7], 0
  v_pk_mul_f32 v[200:201], v[200:201], v[148:149] op_sel_hi:[1,0]
  v_pk_mul_f32 v[202:203], v[202:203], v[148:149] op_sel_hi:[1,0]
  v_mfma_f32_16x16x32_bf16 a[52:55], a[244:247], v[4:7], 0
  v_pk_mul_f32 v[204:205], v[204:205], v[148:149] op_sel_hi:[1,0]
  v_pk_mul_f32 v[206:207], v[206:207], v[148:149] op_sel_hi:[1,0]
  v_mfma_f32_16x16x32_bf16 a[56:59], a[248:251], v[4:7], 0
  v_cvt_pk_bf16_f32 v8, v200, v201
  v_cvt_pk_bf16_f32 v9, v202, v203
  v_mfma_f32_16x16x32_bf16 a[60:63], a[252:255], v[4:7], 0
  v_cvt_pk_bf16_f32 v10, v204, v205
  v_cvt_pk_bf16_f32 v11, v206, v207
  s_add_u32 s54, s62, 0
  s_nop 0
  buffer_store_dwordx4 v[8:11], v234, s[40:43], s54 offen offset:2048 sc1
  v_accvgpr_read_b32 v208, a72
  v_accvgpr_read_b32 v209, a73
  v_accvgpr_read_b32 v210, a74
  v_accvgpr_read_b32 v211, a75
  v_accvgpr_read_b32 v212, a76
  v_accvgpr_read_b32 v213, a77
  v_accvgpr_read_b32 v214, a78
  v_accvgpr_read_b32 v215, a79
  v_pk_mul_f32 v[208:209], v[208:209], v[148:149] op_sel_hi:[1,0]
  v_pk_mul_f32 v[210:211], v[210:211], v[148:149] op_sel_hi:[1,0]
  v_pk_mul_f32 v[212:213], v[212:213], v[148:149] op_sel_hi:[1,0]
  v_pk_mul_f32 v[214:215], v[214:215], v[148:149] op_sel_hi:[1,0]
  v_cvt_pk_bf16_f32 v36, v208, v209
  v_cvt_pk_bf16_f32 v37, v210, v211
  v_cvt_pk_bf16_f32 v38, v212, v213
  v_cvt_pk_bf16_f32 v39, v214, v215
  s_add_u32 s54, s62, 0x1c00
  buffer_store_dwordx4 v[36:39], v234, s[40:43], s54 offen offset:2048 sc1
  v_accvgpr_read_b32 v200, a80
  v_accvgpr_read_b32 v201, a81
  v_accvgpr_read_b32 v202, a82
  v_accvgpr_read_b32 v203, a83
  v_accvgpr_read_b32 v204, a84
  v_accvgpr_read_b32 v205, a85
  v_accvgpr_read_b32 v206, a86
  v_accvgpr_read_b32 v207, a87
  v_pk_mul_f32 v[200:201], v[200:201], v[148:149] op_sel_hi:[1,0]
  v_pk_mul_f32 v[202:203], v[202:203], v[148:149] op_sel_hi:[1,0]
  v_pk_mul_f32 v[204:205], v[204:205], v[148:149] op_sel_hi:[1,0]
  v_pk_mul_f32 v[206:207], v[206:207], v[148:149] op_sel_hi:[1,0]
  v_cvt_pk_bf16_f32 v64, v200, v201
  v_cvt_pk_bf16_f32 v65, v202, v203
  v_cvt_pk_bf16_f32 v66, v204, v205
  v_cvt_pk_bf16_f32 v67, v206, v207
  s_add_u32 s54, s62, 0x3800
  buffer_store_dwordx4 v[64:67], v234, s[40:43], s54 offen offset:2048 sc1
  v_accvgpr_read_b32 v208, a88
  v_accvgpr_read_b32 v209, a89
  v_accvgpr_read_b32 v210, a90
  v_accvgpr_read_b32 v211, a91
  v_accvgpr_read_b32 v212, a92
  v_accvgpr_read_b32 v213, a93
  v_accvgpr_read_b32 v214, a94
  v_accvgpr_read_b32 v215, a95
  v_pk_mul_f32 v[208:209], v[208:209], v[148:149] op_sel_hi:[1,0]
  v_pk_mul_f32 v[210:211], v[210:211], v[148:149] op_sel_hi:[1,0]
  v_pk_mul_f32 v[212:213], v[212:213], v[148:149] op_sel_hi:[1,0]
  v_pk_mul_f32 v[214:215], v[214:215], v[148:149] op_sel_hi:[1,0]
  v_cvt_pk_bf16_f32 v92, v208, v209
  v_cvt_pk_bf16_f32 v93, v210, v211
  v_cvt_pk_bf16_f32 v94, v212, v213
  v_cvt_pk_bf16_f32 v95, v214, v215
  s_add_u32 s54, s62, 0x5400
  buffer_store_dwordx4 v[92:95], v234, s[40:43], s54 offen offset:2048 sc1
  s_nop 0
  s_nop 0
  v_mfma_f32_16x16x32_bf16 a[64:67], a[224:227], v[8:11], 0
  v_accvgpr_read_b32 v200, a96
  v_accvgpr_read_b32 v201, a97
  v_mfma_f32_16x16x32_bf16 a[68:71], a[228:231], v[8:11], 0
  v_accvgpr_read_b32 v202, a98
  v_accvgpr_read_b32 v203, a99
  v_mfma_f32_16x16x32_bf16 a[72:75], a[232:235], v[8:11], 0
  v_accvgpr_read_b32 v204, a100
  v_accvgpr_read_b32 v205, a101
  v_mfma_f32_16x16x32_bf16 a[76:79], a[236:239], v[8:11], 0
  v_accvgpr_read_b32 v206, a102
  v_accvgpr_read_b32 v207, a103
  v_mfma_f32_16x16x32_bf16 a[80:83], a[240:243], v[8:11], 0
  v_pk_mul_f32 v[200:201], v[200:201], v[150:151] op_sel_hi:[1,0]
  v_pk_mul_f32 v[202:203], v[202:203], v[150:151] op_sel_hi:[1,0]
  v_mfma_f32_16x16x32_bf16 a[84:87], a[244:247], v[8:11], 0
  v_pk_mul_f32 v[204:205], v[204:205], v[150:151] op_sel_hi:[1,0]
  v_pk_mul_f32 v[206:207], v[206:207], v[150:151] op_sel_hi:[1,0]
  v_mfma_f32_16x16x32_bf16 a[88:91], a[248:251], v[8:11], 0
  v_cvt_pk_bf16_f32 v12, v200, v201
  v_cvt_pk_bf16_f32 v13, v202, v203
  v_mfma_f32_16x16x32_bf16 a[92:95], a[252:255], v[8:11], 0
  v_cvt_pk_bf16_f32 v14, v204, v205
  v_cvt_pk_bf16_f32 v15, v206, v207
  s_add_u32 s54, s62, 0
  s_nop 0
  buffer_store_dwordx4 v[12:15], v234, s[40:43], s54 offen offset:3072 sc1
  v_accvgpr_read_b32 v208, a104
  v_accvgpr_read_b32 v209, a105
  v_accvgpr_read_b32 v210, a106
  v_accvgpr_read_b32 v211, a107
  v_accvgpr_read_b32 v212, a108
  v_accvgpr_read_b32 v213, a109
  v_accvgpr_read_b32 v214, a110
  v_accvgpr_read_b32 v215, a111
  v_pk_mul_f32 v[208:209], v[208:209], v[150:151] op_sel_hi:[1,0]
  v_pk_mul_f32 v[210:211], v[210:211], v[150:151] op_sel_hi:[1,0]
  v_pk_mul_f32 v[212:213], v[212:213], v[150:151] op_sel_hi:[1,0]
  v_pk_mul_f32 v[214:215], v[214:215], v[150:151] op_sel_hi:[1,0]
  v_cvt_pk_bf16_f32 v40, v208, v209
  v_cvt_pk_bf16_f32 v41, v210, v211
  v_cvt_pk_bf16_f32 v42, v212, v213
  v_cvt_pk_bf16_f32 v43, v214, v215
  s_add_u32 s54, s62, 0x1c00
  buffer_store_dwordx4 v[40:43], v234, s[40:43], s54 offen offset:3072 sc1
  v_accvgpr_read_b32 v200, a112
  v_accvgpr_read_b32 v201, a113
  v_accvgpr_read_b32 v202, a114
  v_accvgpr_read_b32 v203, a115
  v_accvgpr_read_b32 v204, a116
  v_accvgpr_read_b32 v205, a117
  v_accvgpr_read_b32 v206, a118
  v_accvgpr_read_b32 v207, a119
  v_pk_mul_f32 v[200:201], v[200:201], v[150:151] op_sel_hi:[1,0]
  v_pk_mul_f32 v[202:203], v[202:203], v[150:151] op_sel_hi:[1,0]
  v_pk_mul_f32 v[204:205], v[204:205], v[150:151] op_sel_hi:[1,0]
  v_pk_mul_f32 v[206:207], v[206:207], v[150:151] op_sel_hi:[1,0]
  v_cvt_pk_bf16_f32 v68, v200, v201
  v_cvt_pk_bf16_f32 v69, v202, v203
  v_cvt_pk_bf16_f32 v70, v204, v205
  v_cvt_pk_bf16_f32 v71, v206, v207
  s_add_u32 s54, s62, 0x3800
  buffer_store_dwordx4 v[68:71], v234, s[40:43], s54 offen offset:3072 sc1
  v_accvgpr_read_b32 v208, a120
  v_accvgpr_read_b32 v209, a121
  v_accvgpr_read_b32 v210, a122
  v_accvgpr_read_b32 v211, a123
  v_accvgpr_read_b32 v212, a124
  v_accvgpr_read_b32 v213, a125
  v_accvgpr_read_b32 v214, a126
  v_accvgpr_read_b32 v215, a127
  v_pk_mul_f32 v[208:209], v[208:209], v[150:151] op_sel_hi:[1,0]
  v_pk_mul_f32 v[210:211], v[210:211], v[150:151] op_sel_hi:[1,0]
  v_pk_mul_f32 v[212:213], v[212:213], v[150:151] op_sel_hi:[1,0]
  v_pk_mul_f32 v[214:215], v[214:215], v[150:151] op_sel_hi:[1,0]
  v_cvt_pk_bf16_f32 v96, v208, v209
  v_cvt_pk_bf16_f32 v97, v210, v211
  v_cvt_pk_bf16_f32 v98, v212, v213
  v_cvt_pk_bf16_f32 v99, v214, v215
  s_add_u32 s54, s62, 0x5400
  buffer_store_dwordx4 v[96:99], v234, s[40:43], s54 offen offset:3072 sc1
  s_nop 0
  s_nop 0
  v_mfma_f32_16x16x32_bf16 a[96:99], a[224:227], v[12:15], 0
  v_accvgpr_read_b32 v200, a128
  v_accvgpr_read_b32 v201, a129
  v_mfma_f32_16x16x32_bf16 a[100:103], a[228:231], v[12:15], 0
  v_accvgpr_read_b32 v202, a130
  v_accvgpr_read_b32 v203, a131
  v_mfma_f32_16x16x32_bf16 a[104:107], a[232:235], v[12:15], 0
  v_accvgpr_read_b32 v204, a132
  v_accvgpr_read_b32 v205, a133
  v_mfma_f32_16x16x32_bf16 a[108:111], a[236:239], v[12:15], 0
  v_accvgpr_read_b32 v206, a134
  v_accvgpr_read_b32 v207, a135
  v_mfma_f32_16x16x32_bf16 a[112:115], a[240:243], v[12:15], 0
  v_pk_mul_f32 v[200:201], v[200:201], v[152:153] op_sel_hi:[1,0]
  v_pk_mul_f32 v[202:203], v[202:203], v[152:153] op_sel_hi:[1,0]
  v_mfma_f32_16x16x32_bf16 a[116:119], a[244:247], v[12:15], 0
  v_pk_mul_f32 v[204:205], v[204:205], v[152:153] op_sel_hi:[1,0]
  v_pk_mul_f32 v[206:207], v[206:207], v[152:153] op_sel_hi:[1,0]
  v_mfma_f32_16x16x32_bf16 a[120:123], a[248:251], v[12:15], 0
  v_cvt_pk_bf16_f32 v16, v200, v201
  v_cvt_pk_bf16_f32 v17, v202, v203
  v_mfma_f32_16x16x32_bf16 a[124:127], a[252:255], v[12:15], 0
  v_cvt_pk_bf16_f32 v18, v204, v205
  v_cvt_pk_bf16_f32 v19, v206, v207
  s_add_u32 s54, s62, 0x1000
  buffer_store_dwordx4 v[16:19], v234, s[40:43], s54 offen offset:0 sc1
  v_accvgpr_read_b32 v208, a136
  v_accvgpr_read_b32 v209, a137
  v_accvgpr_read_b32 v210, a138
  v_accvgpr_read_b32 v211, a139
  v_accvgpr_read_b32 v212, a140
  v_accvgpr_read_b32 v213, a141
  v_accvgpr_read_b32 v214, a142
  v_accvgpr_read_b32 v215, a143
  v_pk_mul_f32 v[208:209], v[208:209], v[152:153] op_sel_hi:[1,0]
  v_pk_mul_f32 v[210:211], v[210:211], v[152:153] op_sel_hi:[1,0]
  v_pk_mul_f32 v[212:213], v[212:213], v[152:153] op_sel_hi:[1,0]
  v_pk_mul_f32 v[214:215], v[214:215], v[152:153] op_sel_hi:[1,0]
  v_cvt_pk_bf16_f32 v44, v208, v209
  v_cvt_pk_bf16_f32 v45, v210, v211
  v_cvt_pk_bf16_f32 v46, v212, v213
  v_cvt_pk_bf16_f32 v47, v214, v215
  s_add_u32 s54, s62, 0x2c00
  buffer_store_dwordx4 v[44:47], v234, s[40:43], s54 offen offset:0 sc1
  v_accvgpr_read_b32 v200, a144
  v_accvgpr_read_b32 v201, a145
  v_accvgpr_read_b32 v202, a146
  v_accvgpr_read_b32 v203, a147
  v_accvgpr_read_b32 v204, a148
  v_accvgpr_read_b32 v205, a149
  v_accvgpr_read_b32 v206, a150
  v_accvgpr_read_b32 v207, a151
  v_pk_mul_f32 v[200:201], v[200:201], v[152:153] op_sel_hi:[1,0]
  v_pk_mul_f32 v[202:203], v[202:203], v[152:153] op_sel_hi:[1,0]
  v_pk_mul_f32 v[204:205], v[204:205], v[152:153] op_sel_hi:[1,0]
  v_pk_mul_f32 v[206:207], v[206:207], v[152:153] op_sel_hi:[1,0]
  v_cvt_pk_bf16_f32 v72, v200, v201
  v_cvt_pk_bf16_f32 v73, v202, v203
  v_cvt_pk_bf16_f32 v74, v204, v205
  v_cvt_pk_bf16_f32 v75, v206, v207
  s_add_u32 s54, s62, 0x4800
  buffer_store_dwordx4 v[72:75], v234, s[40:43], s54 offen offset:0 sc1
  v_accvgpr_read_b32 v208, a152
  v_accvgpr_read_b32 v209, a153
  v_accvgpr_read_b32 v210, a154
  v_accvgpr_read_b32 v211, a155
  v_accvgpr_read_b32 v212, a156
  v_accvgpr_read_b32 v213, a157
  v_accvgpr_read_b32 v214, a158
  v_accvgpr_read_b32 v215, a159
  v_pk_mul_f32 v[208:209], v[208:209], v[152:153] op_sel_hi:[1,0]
  v_pk_mul_f32 v[210:211], v[210:211], v[152:153] op_sel_hi:[1,0]
  v_pk_mul_f32 v[212:213], v[212:213], v[152:153] op_sel_hi:[1,0]
  v_pk_mul_f32 v[214:215], v[214:215], v[152:153] op_sel_hi:[1,0]
  v_cvt_pk_bf16_f32 v100, v208, v209
  v_cvt_pk_bf16_f32 v101, v210, v211
  v_cvt_pk_bf16_f32 v102, v212, v213
  v_cvt_pk_bf16_f32 v103, v214, v215
  s_add_u32 s54, s62, 0x6400
  buffer_store_dwordx4 v[100:103], v234, s[40:43], s54 offen offset:0 sc1
  s_nop 0
  s_nop 0
  v_mfma_f32_16x16x32_bf16 a[128:131], a[224:227], v[16:19], 0
  v_accvgpr_read_b32 v200, a160
  v_accvgpr_read_b32 v201, a161
  v_mfma_f32_16x16x32_bf16 a[132:135], a[228:231], v[16:19], 0
  v_accvgpr_read_b32 v202, a162
  v_accvgpr_read_b32 v203, a163
  v_mfma_f32_16x16x32_bf16 a[136:139], a[232:235], v[16:19], 0
  v_accvgpr_read_b32 v204, a164
  v_accvgpr_read_b32 v205, a165
  v_mfma_f32_16x16x32_bf16 a[140:143], a[236:239], v[16:19], 0
  v_accvgpr_read_b32 v206, a166
  v_accvgpr_read_b32 v207, a167
  v_mfma_f32_16x16x32_bf16 a[144:147], a[240:243], v[16:19], 0
  v_pk_mul_f32 v[200:201], v[200:201], v[154:155] op_sel_hi:[1,0]
  v_pk_mul_f32 v[202:203], v[202:203], v[154:155] op_sel_hi:[1,0]
  v_mfma_f32_16x16x32_bf16 a[148:151], a[244:247], v[16:19], 0
  v_pk_mul_f32 v[204:205], v[204:205], v[154:155] op_sel_hi:[1,0]
  v_pk_mul_f32 v[206:207], v[206:207], v[154:155] op_sel_hi:[1,0]
  v_mfma_f32_16x16x32_bf16 a[152:155], a[248:251], v[16:19], 0
  v_cvt_pk_bf16_f32 v20, v200, v201
  v_cvt_pk_bf16_f32 v21, v202, v203
  v_mfma_f32_16x16x32_bf16 a[156:159], a[252:255], v[16:19], 0
  v_cvt_pk_bf16_f32 v22, v204, v205
  v_cvt_pk_bf16_f32 v23, v206, v207
  s_add_u32 s54, s62, 0x1000
  buffer_store_dwordx4 v[20:23], v234, s[40:43], s54 offen offset:1024 sc1
  v_accvgpr_read_b32 v208, a168
  v_accvgpr_read_b32 v209, a169
  v_accvgpr_read_b32 v210, a170
  v_accvgpr_read_b32 v211, a171
  v_accvgpr_read_b32 v212, a172
  v_accvgpr_read_b32 v213, a173
  v_accvgpr_read_b32 v214, a174
  v_accvgpr_read_b32 v215, a175
  v_pk_mul_f32 v[208:209], v[208:209], v[154:155] op_sel_hi:[1,0]
  v_pk_mul_f32 v[210:211], v[210:211], v[154:155] op_sel_hi:[1,0]
  v_pk_mul_f32 v[212:213], v[212:213], v[154:155] op_sel_hi:[1,0]
  v_pk_mul_f32 v[214:215], v[214:215], v[154:155] op_sel_hi:[1,0]
  v_cvt_pk_bf16_f32 v48, v208, v209
  v_cvt_pk_bf16_f32 v49, v210, v211
  v_cvt_pk_bf16_f32 v50, v212, v213
  v_cvt_pk_bf16_f32 v51, v214, v215
  s_add_u32 s54, s62, 0x2c00
  buffer_store_dwordx4 v[48:51], v234, s[40:43], s54 offen offset:1024 sc1
  v_accvgpr_read_b32 v200, a176
  v_accvgpr_read_b32 v201, a177
  v_accvgpr_read_b32 v202, a178
  v_accvgpr_read_b32 v203, a179
  v_accvgpr_read_b32 v204, a180
  v_accvgpr_read_b32 v205, a181
  v_accvgpr_read_b32 v206, a182
  v_accvgpr_read_b32 v207, a183
  v_pk_mul_f32 v[200:201], v[200:201], v[154:155] op_sel_hi:[1,0]
  v_pk_mul_f32 v[202:203], v[202:203], v[154:155] op_sel_hi:[1,0]
  v_pk_mul_f32 v[204:205], v[204:205], v[154:155] op_sel_hi:[1,0]
  v_pk_mul_f32 v[206:207], v[206:207], v[154:155] op_sel_hi:[1,0]
  v_cvt_pk_bf16_f32 v76, v200, v201
  v_cvt_pk_bf16_f32 v77, v202, v203
  v_cvt_pk_bf16_f32 v78, v204, v205
  v_cvt_pk_bf16_f32 v79, v206, v207
  s_add_u32 s54, s62, 0x4800
  buffer_store_dwordx4 v[76:79], v234, s[40:43], s54 offen offset:1024 sc1
  v_accvgpr_read_b32 v208, a184
  v_accvgpr_read_b32 v209, a185
  v_accvgpr_read_b32 v210, a186
  v_accvgpr_read_b32 v211, a187
  v_accvgpr_read_b32 v212, a188
  v_accvgpr_read_b32 v213, a189
  v_accvgpr_read_b32 v214, a190
  v_accvgpr_read_b32 v215, a191
  v_pk_mul_f32 v[208:209], v[208:209], v[154:155] op_sel_hi:[1,0]
  v_pk_mul_f32 v[210:211], v[210:211], v[154:155] op_sel_hi:[1,0]
  v_pk_mul_f32 v[212:213], v[212:213], v[154:155] op_sel_hi:[1,0]
  v_pk_mul_f32 v[214:215], v[214:215], v[154:155] op_sel_hi:[1,0]
  v_cvt_pk_bf16_f32 v104, v208, v209
  v_cvt_pk_bf16_f32 v105, v210, v211
  v_cvt_pk_bf16_f32 v106, v212, v213
  v_cvt_pk_bf16_f32 v107, v214, v215
  s_add_u32 s54, s62, 0x6400
  buffer_store_dwordx4 v[104:107], v234, s[40:43], s54 offen offset:1024 sc1
  s_nop 0
  s_nop 0
  v_mfma_f32_16x16x32_bf16 a[160:163], a[224:227], v[20:23], 0
  v_accvgpr_read_b32 v200, a192
  v_accvgpr_read_b32 v201, a193
  v_mfma_f32_16x16x32_bf16 a[164:167], a[228:231], v[20:23], 0
  v_accvgpr_read_b32 v202, a194
  v_accvgpr_read_b32 v203, a195
  v_mfma_f32_16x16x32_bf16 a[168:171], a[232:235], v[20:23], 0
  v_accvgpr_read_b32 v204, a196
  v_accvgpr_read_b32 v205, a197
  v_mfma_f32_16x16x32_bf16 a[172:175], a[236:239], v[20:23], 0
  v_accvgpr_read_b32 v206, a198
  v_accvgpr_read_b32 v207, a199
  v_mfma_f32_16x16x32_bf16 a[176:179], a[240:243], v[20:23], 0
  v_pk_mul_f32 v[200:201], v[200:201], v[156:157] op_sel_hi:[1,0]
  v_pk_mul_f32 v[202:203], v[202:203], v[156:157] op_sel_hi:[1,0]
  v_mfma_f32_16x16x32_bf16 a[180:183], a[244:247], v[20:23], 0
  v_pk_mul_f32 v[204:205], v[204:205], v[156:157] op_sel_hi:[1,0]
  v_pk_mul_f32 v[206:207], v[206:207], v[156:157] op_sel_hi:[1,0]
  v_mfma_f32_16x16x32_bf16 a[184:187], a[248:251], v[20:23], 0
  v_cvt_pk_bf16_f32 v24, v200, v201
  v_cvt_pk_bf16_f32 v25, v202, v203
  v_mfma_f32_16x16x32_bf16 a[188:191], a[252:255], v[20:23], 0
  v_cvt_pk_bf16_f32 v26, v204, v205
  v_cvt_pk_bf16_f32 v27, v206, v207
  s_add_u32 s54, s62, 0x1000
  buffer_store_dwordx4 v[24:27], v234, s[40:43], s54 offen offset:2048 sc1
  v_accvgpr_read_b32 v208, a200
  v_accvgpr_read_b32 v209, a201
  v_accvgpr_read_b32 v210, a202
  v_accvgpr_read_b32 v211, a203
  v_accvgpr_read_b32 v212, a204
  v_accvgpr_read_b32 v213, a205
  v_accvgpr_read_b32 v214, a206
  v_accvgpr_read_b32 v215, a207
  v_pk_mul_f32 v[208:209], v[208:209], v[156:157] op_sel_hi:[1,0]
  v_pk_mul_f32 v[210:211], v[210:211], v[156:157] op_sel_hi:[1,0]
  v_pk_mul_f32 v[212:213], v[212:213], v[156:157] op_sel_hi:[1,0]
  v_pk_mul_f32 v[214:215], v[214:215], v[156:157] op_sel_hi:[1,0]
  v_cvt_pk_bf16_f32 v52, v208, v209
  v_cvt_pk_bf16_f32 v53, v210, v211
  v_cvt_pk_bf16_f32 v54, v212, v213
  v_cvt_pk_bf16_f32 v55, v214, v215
  s_add_u32 s54, s62, 0x2c00
  buffer_store_dwordx4 v[52:55], v234, s[40:43], s54 offen offset:2048 sc1
  v_accvgpr_read_b32 v200, a208
  v_accvgpr_read_b32 v201, a209
  v_accvgpr_read_b32 v202, a210
  v_accvgpr_read_b32 v203, a211
  v_accvgpr_read_b32 v204, a212
  v_accvgpr_read_b32 v205, a213
  v_accvgpr_read_b32 v206, a214
  v_accvgpr_read_b32 v207, a215
  v_pk_mul_f32 v[200:201], v[200:201], v[156:157] op_sel_hi:[1,0]
  v_pk_mul_f32 v[202:203], v[202:203], v[156:157] op_sel_hi:[1,0]
  v_pk_mul_f32 v[204:205], v[204:205], v[156:157] op_sel_hi:[1,0]
  v_pk_mul_f32 v[206:207], v[206:207], v[156:157] op_sel_hi:[1,0]
  v_cvt_pk_bf16_f32 v80, v200, v201
  v_cvt_pk_bf16_f32 v81, v202, v203
  v_cvt_pk_bf16_f32 v82, v204, v205
  v_cvt_pk_bf16_f32 v83, v206, v207
  s_add_u32 s54, s62, 0x4800
  buffer_store_dwordx4 v[80:83], v234, s[40:43], s54 offen offset:2048 sc1
  v_accvgpr_read_b32 v208, a216
  v_accvgpr_read_b32 v209, a217
  v_accvgpr_read_b32 v210, a218
  v_accvgpr_read_b32 v211, a219
  v_accvgpr_read_b32 v212, a220
  v_accvgpr_read_b32 v213, a221
  v_accvgpr_read_b32 v214, a222
  v_accvgpr_read_b32 v215, a223
  v_pk_mul_f32 v[208:209], v[208:209], v[156:157] op_sel_hi:[1,0]
  v_pk_mul_f32 v[210:211], v[210:211], v[156:157] op_sel_hi:[1,0]
  v_pk_mul_f32 v[212:213], v[212:213], v[156:157] op_sel_hi:[1,0]
  v_pk_mul_f32 v[214:215], v[214:215], v[156:157] op_sel_hi:[1,0]
  v_cvt_pk_bf16_f32 v108, v208, v209
  v_cvt_pk_bf16_f32 v109, v210, v211
  v_cvt_pk_bf16_f32 v110, v212, v213
  v_cvt_pk_bf16_f32 v111, v214, v215
  s_add_u32 s54, s62, 0x6400
  buffer_store_dwordx4 v[108:111], v234, s[40:43], s54 offen offset:2048 sc1
  s_nop 0
  s_nop 0
  v_mfma_f32_16x16x32_bf16 a[192:195], a[224:227], v[24:27], 0
  ds_read_b64_tr_b16 v[168:169], v230 offset:8192
  ds_read_b64_tr_b16 v[170:171], v230 offset:12288
  v_mfma_f32_16x16x32_bf16 a[196:199], a[228:231], v[24:27], 0
  ds_read_b64_tr_b16 v[172:173], v231 offset:8192
  ds_read_b64_tr_b16 v[174:175], v231 offset:12288
  v_mfma_f32_16x16x32_bf16 a[200:203], a[232:235], v[24:27], 0
  ds_read_b64_tr_b16 v[176:177], v230 offset:8704
  ds_read_b64_tr_b16 v[178:179], v230 offset:12800
  v_mfma_f32_16x16x32_bf16 a[204:207], a[236:239], v[24:27], 0
  ds_read_b64_tr_b16 v[180:181], v231 offset:8704
  ds_read_b64_tr_b16 v[182:183], v231 offset:12800
  v_mfma_f32_16x16x32_bf16 a[208:211], a[240:243], v[24:27], 0
  ds_read_b64_tr_b16 v[184:185], v230 offset:9216
  ds_read_b64_tr_b16 v[186:187], v230 offset:13312
  v_mfma_f32_16x16x32_bf16 a[212:215], a[244:247], v[24:27], 0
  ds_read_b64_tr_b16 v[188:189], v231 offset:9216
  ds_read_b64_tr_b16 v[190:191], v231 offset:13312
  v_mfma_f32_16x16x32_bf16 a[216:219], a[248:251], v[24:27], 0
  ds_read_b64_tr_b16 v[192:193], v230 offset:9728
  ds_read_b64_tr_b16 v[194:195], v230 offset:13824
  v_mfma_f32_16x16x32_bf16 a[220:223], a[252:255], v[24:27], 0
  ds_read_b64_tr_b16 v[196:197], v231 offset:9728
  ds_read_b64_tr_b16 v[198:199], v231 offset:13824
  s_waitcnt lgkmcnt(0)
  s_nop 0
  v_mfma_f32_16x16x32_bf16 a[0:3], v[168:171], v[28:31], a[0:3]
  s_waitcnt vmcnt(57)
  s_nop 0
  v_mfma_f32_16x16x32_bf16 a[4:7], v[172:175], v[28:31], a[4:7]
  s_barrier
  s_nop 0
  v_mfma_f32_16x16x32_bf16 a[8:11], v[176:179], v[28:31], a[8:11]
  v_mfma_f32_16x16x32_bf16 a[12:15], v[180:183], v[28:31], a[12:15]
  v_mfma_f32_16x16x32_bf16 a[16:19], v[184:187], v[28:31], a[16:19]
  v_mfma_f32_16x16x32_bf16 a[20:23], v[188:191], v[28:31], a[20:23]
  ds_read_b64_tr_b16 a[224:225], v247 offset:0
  v_mfma_f32_16x16x32_bf16 a[24:27], v[192:195], v[28:31], a[24:27]
  ds_read_b64_tr_b16 a[226:227], v247 offset:4096
  v_mfma_f32_16x16x32_bf16 a[28:31], v[196:199], v[28:31], a[28:31]
  ds_read_b64_tr_b16 a[228:229], v225 offset:0
  v_mfma_f32_16x16x32_bf16 a[32:35], v[168:171], v[32:35], a[32:35]
  ds_read_b64_tr_b16 a[230:231], v225 offset:4096
  v_mfma_f32_16x16x32_bf16 a[36:39], v[172:175], v[32:35], a[36:39]
  ds_read_b64_tr_b16 a[232:233], v247 offset:512
  v_mfma_f32_16x16x32_bf16 a[40:43], v[176:179], v[32:35], a[40:43]
  ds_read_b64_tr_b16 a[234:235], v247 offset:4608
  v_mfma_f32_16x16x32_bf16 a[44:47], v[180:183], v[32:35], a[44:47]
  ds_read_b64_tr_b16 a[236:237], v225 offset:512
  v_mfma_f32_16x16x32_bf16 a[48:51], v[184:187], v[32:35], a[48:51]
  ds_read_b64_tr_b16 a[238:239], v225 offset:4608
  v_mfma_f32_16x16x32_bf16 a[52:55], v[188:191], v[32:35], a[52:55]
  ds_read_b64_tr_b16 a[240:241], v247 offset:1024
  v_mfma_f32_16x16x32_bf16 a[56:59], v[192:195], v[32:35], a[56:59]
  ds_read_b64_tr_b16 a[242:243], v247 offset:5120
  v_mfma_f32_16x16x32_bf16 a[60:63], v[196:199], v[32:35], a[60:63]
  ds_read_b64_tr_b16 a[244:245], v225 offset:1024
  v_mfma_f32_16x16x32_bf16 a[64:67], v[168:171], v[36:39], a[64:67]
  ds_read_b64_tr_b16 a[246:247], v225 offset:5120
  v_mfma_f32_16x16x32_bf16 a[68:71], v[172:175], v[36:39], a[68:71]
  ds_read_b64_tr_b16 a[248:249], v247 offset:1536
  v_mfma_f32_16x16x32_bf16 a[72:75], v[176:179], v[36:39], a[72:75]
  ds_read_b64_tr_b16 a[250:251], v247 offset:5632
  v_mfma_f32_16x16x32_bf16 a[76:79], v[180:183], v[36:39], a[76:79]
  ds_read_b64_tr_b16 a[252:253], v225 offset:1536
  v_mfma_f32_16x16x32_bf16 a[80:83], v[184:187], v[36:39], a[80:83]
  ds_read_b64_tr_b16 a[254:255], v225 offset:5632
  v_mfma_f32_16x16x32_bf16 a[84:87], v[188:191], v[36:39], a[84:87]
  v_mfma_f32_16x16x32_bf16 a[88:91], v[192:195], v[36:39], a[88:91]
  v_mfma_f32_16x16x32_bf16 a[92:95], v[196:199], v[36:39], a[92:95]
  v_mfma_f32_16x16x32_bf16 a[96:99], v[168:171], v[40:43], a[96:99]
  v_mfma_f32_16x16x32_bf16 a[100:103], v[172:175], v[40:43], a[100:103]
  v_mfma_f32_16x16x32_bf16 a[104:107], v[176:179], v[40:43], a[104:107]
  v_mfma_f32_16x16x32_bf16 a[108:111], v[180:183], v[40:43], a[108:111]
  v_mfma_f32_16x16x32_bf16 a[112:115], v[184:187], v[40:43], a[112:115]
  v_mfma_f32_16x16x32_bf16 a[116:119], v[188:191], v[40:43], a[116:119]
  v_mfma_f32_16x16x32_bf16 a[120:123], v[192:195], v[40:43], a[120:123]
  v_mfma_f32_16x16x32_bf16 a[124:127], v[196:199], v[40:43], a[124:127]
  v_mfma_f32_16x16x32_bf16 a[128:131], v[168:171], v[44:47], a[128:131]
  v_mfma_f32_16x16x32_bf16 a[132:135], v[172:175], v[44:47], a[132:135]
  v_mfma_f32_16x16x32_bf16 a[136:139], v[176:179], v[44:47], a[136:139]
  v_mfma_f32_16x16x32_bf16 a[140:143], v[180:183], v[44:47], a[140:143]
  v_mfma_f32_16x16x32_bf16 a[144:147], v[184:187], v[44:47], a[144:147]
  v_mfma_f32_16x16x32_bf16 a[148:151], v[188:191], v[44:47], a[148:151]
  v_mfma_f32_16x16x32_bf16 a[152:155], v[192:195], v[44:47], a[152:155]
  v_mfma_f32_16x16x32_bf16 a[156:159], v[196:199], v[44:47], a[156:159]
  v_mfma_f32_16x16x32_bf16 a[160:163], v[168:171], v[48:51], a[160:163]
  v_mfma_f32_16x16x32_bf16 a[164:167], v[172:175], v[48:51], a[164:167]
  v_mfma_f32_16x16x32_bf16 a[168:171], v[176:179], v[48:51], a[168:171]
  v_mfma_f32_16x16x32_bf16 a[172:175], v[180:183], v[48:51], a[172:175]
  v_mfma_f32_16x16x32_bf16 a[176:179], v[184:187], v[48:51], a[176:179]
  v_mfma_f32_16x16x32_bf16 a[180:183], v[188:191], v[48:51], a[180:183]
  v_mfma_f32_16x16x32_bf16 a[184:187], v[192:195], v[48:51], a[184:187]
  v_mfma_f32_16x16x32_bf16 a[188:191], v[196:199], v[48:51], a[188:191]
  v_mfma_f32_16x16x32_bf16 a[192:195], v[168:171], v[52:55], a[192:195]
  v_mfma_f32_16x16x32_bf16 a[196:199], v[172:175], v[52:55], a[196:199]
  v_mfma_f32_16x16x32_bf16 a[200:203], v[176:179], v[52:55], a[200:203]
  v_mfma_f32_16x16x32_bf16 a[204:207], v[180:183], v[52:55], a[204:207]
  v_mfma_f32_16x16x32_bf16 a[208:211], v[184:187], v[52:55], a[208:211]
  v_mfma_f32_16x16x32_bf16 a[212:215], v[188:191], v[52:55], a[212:215]
  v_mfma_f32_16x16x32_bf16 a[216:219], v[192:195], v[52:55], a[216:219]
  v_mfma_f32_16x16x32_bf16 a[220:223], v[196:199], v[52:55], a[220:223]
  s_waitcnt lgkmcnt(0)
  s_nop 0
  v_mfma_f32_16x16x32_bf16 a[0:3], a[224:227], v[56:59], a[0:3]
  s_waitcnt vmcnt(0)
  s_nop 0
  v_mfma_f32_16x16x32_bf16 a[4:7], a[228:231], v[56:59], a[4:7]
  s_barrier
  s_nop 0
  v_mfma_f32_16x16x32_bf16 a[8:11], a[232:235], v[56:59], a[8:11]
  s_and_b32 s67, s3, 3
  s_lshl_b32 s67, s67, 2
  s_add_u32 s67, s67, s90
  s_nop 0
  v_mfma_f32_16x16x32_bf16 a[12:15], a[236:239], v[56:59], a[12:15]
  buffer_store_dword v236, off, s[40:43], s67 sc1
  v_mfma_f32_16x16x32_bf16 a[16:19], a[240:243], v[56:59], a[16:19]
CNT_CHK:
  v_readfirstlane_b32 s66, v253
  s_nop 1
  s_cmp_ge_u32 s66, 0x100
  s_cbranch_scc0 CNT_SPIN
CNT_OK:
  s_nop 0
  v_mfma_f32_16x16x32_bf16 a[20:23], a[244:247], v[56:59], a[20:23]
  ds_read_b64_tr_b16 v[168:169], v247 offset:8192
  v_mfma_f32_16x16x32_bf16 a[24:27], a[248:251], v[56:59], a[24:27]
  s_add_u32 m0, s49, 0x10000
  s_add_u32 s54, s5, 0x10000
  ds_read_b64_tr_b16 v[170:171], v247 offset:12288
  v_mfma_f32_16x16x32_bf16 a[28:31], a[252:255], v[56:59], a[28:31]
  buffer_load_dwordx4 v254, s[36:39], s54 offen offset:0 lds
  v_mfma_f32_16x16x32_bf16 a[32:35], a[224:227], v[60:63], a[32:35]
  ds_read_b64_tr_b16 v[172:173], v225 offset:8192
  v_mfma_f32_16x16x32_bf16 a[36:39], a[228:231], v[60:63], a[36:39]
  s_add_u32 m0, s49, 0x10400
  ds_read_b64_tr_b16 v[174:175], v225 offset:12288
  v_mfma_f32_16x16x32_bf16 a[40:43], a[232:235], v[60:63], a[40:43]
  buffer_load_dwordx4 v227, s[36:39], s54 offen offset:0 lds
  v_mfma_f32_16x16x32_bf16 a[44:47], a[236:239], v[60:63], a[44:47]
  s_add_u32 m0, s49, 0x10800
  ds_read_b64_tr_b16 v[176:177], v247 offset:8704
  v_mfma_f32_16x16x32_bf16 a[48:51], a[240:243], v[60:63], a[48:51]
  s_add_u32 s54, s5, 0x12000
  ds_read_b64_tr_b16 v[178:179], v247 offset:12800
  v_mfma_f32_16x16x32_bf16 a[52:55], a[244:247], v[60:63], a[52:55]
  buffer_load_dwordx4 v254, s[36:39], s54 offen offset:0 lds
  v_mfma_f32_16x16x32_bf16 a[56:59], a[248:251], v[60:63], a[56:59]
  ds_read_b64_tr_b16 v[180:181], v225 offset:8704
  v_mfma_f32_16x16x32_bf16 a[60:63], a[252:255], v[60:63], a[60:63]
  s_add_u32 m0, s49, 0x10c00
  ds_read_b64_tr_b16 v[182:183], v225 offset:12800
  v_mfma_f32_16x16x32_bf16 a[64:67], a[224:227], v[64:67], a[64:67]
  buffer_load_dwordx4 v227, s[36:39], s54 offen offset:0 lds
  v_mfma_f32_16x16x32_bf16 a[68:71], a[228:231], v[64:67], a[68:71]
  s_add_u32 m0, s49, 0x12000
  ds_read_b64_tr_b16 v[184:185], v247 offset:9216
  v_mfma_f32_16x16x32_bf16 a[72:75], a[232:235], v[64:67], a[72:75]
  s_add_u32 s54, s6, 0x10000
  ds_read_b64_tr_b16 v[186:187], v247 offset:13312
  v_mfma_f32_16x16x32_bf16 a[76:79], a[236:239], v[64:67], a[76:79]
  buffer_load_dwordx4 v254, s[36:39], s54 offen offset:0 lds
  v_mfma_f32_16x16x32_bf16 a[80:83], a[240:243], v[64:67], a[80:83]
  ds_read_b64_tr_b16 v[188:189], v225 offset:9216
  v_mfma_f32_16x16x32_bf16 a[84:87], a[244:247], v[64:67], a[84:87]
  s_add_u32 m0, s49, 0x12400
  ds_read_b64_tr_b16 v[190:191], v225 offset:13312
  v_mfma_f32_16x16x32_bf16 a[88:91], a[248:251], v[64:67], a[88:91]
  buffer_load_dwordx4 v227, s[36:39], s54 offen offset:0 lds
  v_mfma_f32_16x16x32_bf16 a[92:95], a[252:255], v[64:67], a[92:95]
  s_add_u32 m0, s49, 0x12800
  ds_read_b64_tr_b16 v[192:193], v247 offset:9728
  v_mfma_f32_16x16x32_bf16 a[96:99], a[224:227], v[68:71], a[96:99]
  s_add_u32 s54, s6, 0x12000
  ds_read_b64_tr_b16 v[194:195], v247 offset:13824
  v_mfma_f32_16x16x32_bf16 a[100:103], a[228:231], v[68:71], a[100:103]
  buffer_load_dwordx4 v254, s[36:39], s54 offen offset:0 lds
  v_mfma_f32_16x16x32_bf16 a[104:107], a[232:235], v[68:71], a[104:107]
  ds_read_b64_tr_b16 v[196:197], v225 offset:9728
  v_mfma_f32_16x16x32_bf16 a[108:111], a[236:239], v[68:71], a[108:111]
  s_add_u32 m0, s49, 0x12c00
  ds_read_b64_tr_b16 v[198:199], v225 offset:13824
  v_mfma_f32_16x16x32_bf16 a[112:115], a[240:243], v[68:71], a[112:115]
  buffer_load_dwordx4 v227, s[36:39], s54 offen offset:0 lds
  v_mfma_f32_16x16x32_bf16 a[116:119], a[244:247], v[68:71], a[116:119]
  s_add_u32 m0, s49, 0
  s_nop 0
  v_mfma_f32_16x16x32_bf16 a[120:123], a[248:251], v[68:71], a[120:123]
  s_add_u32 s54, s7, 0x10000
  v_mfma_f32_16x16x32_bf16 a[124:127], a[252:255], v[68:71], a[124:127]
  buffer_load_dwordx4 v254, s[36:39], s54 offen offset:0 lds
  v_mfma_f32_16x16x32_bf16 a[128:131], a[224:227], v[72:75], a[128:131]
  v_mfma_f32_16x16x32_bf16 a[132:135], a[228:231], v[72:75], a[132:135]
  s_add_u32 m0, s49, 0x400
  v_mfma_f32_16x16x32_bf16 a[136:139], a[232:235], v[72:75], a[136:139]
  buffer_load_dwordx4 v227, s[36:39], s54 offen offset:0 lds
  v_mfma_f32_16x16x32_bf16 a[140:143], a[236:239], v[72:75], a[140:143]
  s_add_u32 m0, s49, 0x800
  v_mfma_f32_16x16x32_bf16 a[144:147], a[240:243], v[72:75], a[144:147]
  s_add_u32 s54, s7, 0x12000
  v_mfma_f32_16x16x32_bf16 a[148:151], a[244:247], v[72:75], a[148:151]
  buffer_load_dwordx4 v254, s[36:39], s54 offen offset:0 lds
  v_mfma_f32_16x16x32_bf16 a[152:155], a[248:251], v[72:75], a[152:155]
  v_mfma_f32_16x16x32_bf16 a[156:159], a[252:255], v[72:75], a[156:159]
  s_add_u32 m0, s49, 0xc00
  v_mfma_f32_16x16x32_bf16 a[160:163], a[224:227], v[76:79], a[160:163]
  buffer_load_dwordx4 v227, s[36:39], s54 offen offset:0 lds
  v_mfma_f32_16x16x32_bf16 a[164:167], a[228:231], v[76:79], a[164:167]
  v_mfma_f32_16x16x32_bf16 a[168:171], a[232:235], v[76:79], a[168:171]
  v_mfma_f32_16x16x32_bf16 a[172:175], a[236:239], v[76:79], a[172:175]
  v_mfma_f32_16x16x32_bf16 a[176:179], a[240:243], v[76:79], a[176:179]
  v_mfma_f32_16x16x32_bf16 a[180:183], a[244:247], v[76:79], a[180:183]
  v_mfma_f32_16x16x32_bf16 a[184:187], a[248:251], v[76:79], a[184:187]
  v_mfma_f32_16x16x32_bf16 a[188:191], a[252:255], v[76:79], a[188:191]
  v_mfma_f32_16x16x32_bf16 a[192:195], a[224:227], v[80:83], a[192:195]
  v_mfma_f32_16x16x32_bf16 a[196:199], a[228:231], v[80:83], a[196:199]
  v_mfma_f32_16x16x32_bf16 a[200:203], a[232:235], v[80:83], a[200:203]
  v_mfma_f32_16x16x32_bf16 a[204:207], a[236:239], v[80:83], a[204:207]
  v_mfma_f32_16x16x32_bf16 a[208:211], a[240:243], v[80:83], a[208:211]
  v_mfma_f32_16x16x32_bf16 a[212:215], a[244:247], v[80:83], a[212:215]
  v_mfma_f32_16x16x32_bf16 a[216:219], a[248:251], v[80:83], a[216:219]
  v_mfma_f32_16x16x32_bf16 a[220:223], a[252:255], v[80:83], a[220:223]
  s_waitcnt lgkmcnt(0)
  s_nop 0
  v_mfma_f32_16x16x32_bf16 a[0:3], v[168:171], v[84:87], a[0:3]
  buffer_load_dwordx4 v[200:203], off, s[40:43], s90 sc1
  v_mfma_f32_16x16x32_bf16 a[4:7], v[172:175], v[84:87], a[4:7]
  v_mfma_f32_16x16x32_bf16 a[8:11], v[176:179], v[84:87], a[8:11]
  v_mfma_f32_16x16x32_bf16 a[12:15], v[180:183], v[84:87], a[12:15]
  v_mfma_f32_16x16x32_bf16 a[16:19], v[184:187], v[84:87], a[16:19]
  v_mfma_f32_16x16x32_bf16 a[20:23], v[188:191], v[84:87], a[20:23]
  ds_read_b64_tr_b16 a[224:225], v247 offset:16384
  v_mfma_f32_16x16x32_bf16 a[24:27], v[192:195], v[84:87], a[24:27]
  ds_read_b64_tr_b16 a[226:227], v247 offset:20480
  v_mfma_f32_16x16x32_bf16 a[28:31], v[196:199], v[84:87], a[28:31]
  ds_read_b64_tr_b16 a[228:229], v225 offset:16384
  v_mfma_f32_16x16x32_bf16 a[32:35], v[168:171], v[88:91], a[32:35]
  ds_read_b64_tr_b16 a[230:231], v225 offset:20480
  v_mfma_f32_16x16x32_bf16 a[36:39], v[172:175], v[88:91], a[36:39]
  ds_read_b64_tr_b16 a[232:233], v247 offset:16896
  v_mfma_f32_16x16x32_bf16 a[40:43], v[176:179], v[88:91], a[40:43]
  ds_read_b64_tr_b16 a[234:235], v247 offset:20992
  v_mfma_f32_16x16x32_bf16 a[44:47], v[180:183], v[88:91], a[44:47]
  ds_read_b64_tr_b16 a[236:237], v225 offset:16896
  v_mfma_f32_16x16x32_bf16 a[48:51], v[184:187], v[88:91], a[48:51]
  ds_read_b64_tr_b16 a[238:239], v225 offset:20992
  v_mfma_f32_16x16x32_bf16 a[52:55], v[188:191], v[88:91], a[52:55]
  ds_read_b64_tr_b16 a[240:241], v247 offset:17408
  v_mfma_f32_16x16x32_bf16 a[56:59], v[192:195], v[88:91], a[56:59]
  ds_read_b64_tr_b16 a[242:243], v247 offset:21504
  v_mfma_f32_16x16x32_bf16 a[60:63], v[196:199], v[88:91], a[60:63]
  ds_read_b64_tr_b16 a[244:245], v225 offset:17408
  v_mfma_f32_16x16x32_bf16 a[64:67], v[168:171], v[92:95], a[64:67]
  ds_read_b64_tr_b16 a[246:247], v225 offset:21504
  v_mfma_f32_16x16x32_bf16 a[68:71], v[172:175], v[92:95], a[68:71]
  ds_read_b64_tr_b16 a[248:249], v247 offset:17920
  v_mfma_f32_16x16x32_bf16 a[72:75], v[176:179], v[92:95], a[72:75]
  ds_read_b64_tr_b16 a[250:251], v247 offset:22016
  v_mfma_f32_16x16x32_bf16 a[76:79], v[180:183], v[92:95], a[76:79]
  ds_read_b64_tr_b16 a[252:253], v225 offset:17920
  v_mfma_f32_16x16x32_bf16 a[80:83], v[184:187], v[92:95], a[80:83]
  ds_read_b64_tr_b16 a[254:255], v225 offset:22016
  v_mfma_f32_16x16x32_bf16 a[84:87], v[188:191], v[92:95], a[84:87]
  v_mfma_f32_16x16x32_bf16 a[88:91], v[192:195], v[92:95], a[88:91]
  v_mfma_f32_16x16x32_bf16 a[92:95], v[196:199], v[92:95], a[92:95]
  v_mfma_f32_16x16x32_bf16 a[96:99], v[168:171], v[96:99], a[96:99]
  v_mfma_f32_16x16x32_bf16 a[100:103], v[172:175], v[96:99], a[100:103]
  v_mfma_f32_16x16x32_bf16 a[104:107], v[176:179], v[96:99], a[104:107]
  v_mfma_f32_16x16x32_bf16 a[108:111], v[180:183], v[96:99], a[108:111]
  v_mfma_f32_16x16x32_bf16 a[112:115], v[184:187], v[96:99], a[112:115]
  v_mfma_f32_16x16x32_bf16 a[116:119], v[188:191], v[96:99], a[116:119]
  v_mfma_f32_16x16x32_bf16 a[120:123], v[192:195], v[96:99], a[120:123]
  v_mfma_f32_16x16x32_bf16 a[124:127], v[196:199], v[96:99], a[124:127]
  v_mfma_f32_16x16x32_bf16 a[128:131], v[168:171], v[100:103], a[128:131]
  v_mfma_f32_16x16x32_bf16 a[132:135], v[172:175], v[100:103], a[132:135]
  v_mfma_f32_16x16x32_bf16 a[136:139], v[176:179], v[100:103], a[136:139]
  v_mfma_f32_16x16x32_bf16 a[140:143], v[180:183], v[100:103], a[140:143]
  v_mfma_f32_16x16x32_bf16 a[144:147], v[184:187], v[100:103], a[144:147]
  s_waitcnt vmcnt(0)
FO_CHK:
  s_nop 0
  v_min3_u32 v200, v200, v201, v202
  v_min_u32_e32 v200, v200, v203
  s_nop 0
  v_readfirstlane_b32 s66, v200
  s_nop 1
  s_cmp_lg_u32 s66, 0
  s_cbranch_scc0 FO_SPIN
FO_OK:
  v_mfma_f32_16x16x32_bf16 a[148:151], v[188:191], v[100:103], a[148:151]
  s_add_u32 s55, s8, 0
  s_nop 0
  v_mfma_f32_16x16x32_bf16 a[152:155], v[192:195], v[100:103], a[152:155]
  buffer_load_dwordx4 v[112:115], v234, s[40:43], s55 offen offset:0 sc1
  v_mfma_f32_16x16x32_bf16 a[156:159], v[196:199], v[100:103], a[156:159]
  v_mfma_f32_16x16x32_bf16 a[160:163], v[168:171], v[104:107], a[160:163]
  buffer_load_dwordx4 v[116:119], v234, s[40:43], s55 offen offset:1024 sc1
  v_mfma_f32_16x16x32_bf16 a[164:167], v[172:175], v[104:107], a[164:167]
  v_mfma_f32_16x16x32_bf16 a[168:171], v[176:179], v[104:107], a[168:171]
  buffer_load_dwordx4 v[120:123], v234, s[40:43], s55 offen offset:2048 sc1
  v_mfma_f32_16x16x32_bf16 a[172:175], v[180:183], v[104:107], a[172:175]
  v_mfma_f32_16x16x32_bf16 a[176:179], v[184:187], v[104:107], a[176:179]
  buffer_load_dwordx4 v[124:127], v234, s[40:43], s55 offen offset:3072 sc1
  v_mfma_f32_16x16x32_bf16 a[180:183], v[188:191], v[104:107], a[180:183]
  s_add_u32 s55, s8, 0x1000
  v_mfma_f32_16x16x32_bf16 a[184:187], v[192:195], v[104:107], a[184:187]
  buffer_load_dwordx4 v[128:131], v234, s[40:43], s55 offen offset:0 sc1
  v_mfma_f32_16x16x32_bf16 a[188:191], v[196:199], v[104:107], a[188:191]
  v_mfma_f32_16x16x32_bf16 a[192:195], v[168:171], v[108:111], a[192:195]
  buffer_load_dwordx4 v[132:135], v234, s[40:43], s55 offen offset:1024 sc1
  v_mfma_f32_16x16x32_bf16 a[196:199], v[172:175], v[108:111], a[196:199]
  v_mfma_f32_16x16x32_bf16 a[200:203], v[176:179], v[108:111], a[200:203]
  buffer_load_dwordx4 v[136:139], v234, s[40:43], s55 offen offset:2048 sc1
  v_mfma_f32_16x16x32_bf16 a[204:207], v[180:183], v[108:111], a[204:207]
  v_mfma_f32_16x16x32_bf16 a[208:211], v[184:187], v[108:111], a[208:211]
  v_mfma_f32_16x16x32_bf16 a[212:215], v[188:191], v[108:111], a[212:215]
  v_mfma_f32_16x16x32_bf16 a[216:219], v[192:195], v[108:111], a[216:219]
  v_mfma_f32_16x16x32_bf16 a[220:223], v[196:199], v[108:111], a[220:223]
  s_waitcnt lgkmcnt(0)
  s_waitcnt vmcnt(0)
  v_mfma_f32_16x16x32_bf16 a[0:3], a[224:227], v[112:115], a[0:3]
  v_mfma_f32_16x16x32_bf16 a[4:7], a[228:231], v[112:115], a[4:7]
  s_add_u32 s55, s9, 0
  s_nop 0
  v_mfma_f32_16x16x32_bf16 a[8:11], a[232:235], v[112:115], a[8:11]
  buffer_load_dwordx4 v[140:143], v234, s[40:43], s55 offen offset:0 sc1
  v_mfma_f32_16x16x32_bf16 a[12:15], a[236:239], v[112:115], a[12:15]
  v_mfma_f32_16x16x32_bf16 a[16:19], a[240:243], v[112:115], a[16:19]
  v_mfma_f32_16x16x32_bf16 a[20:23], a[244:247], v[112:115], a[20:23]
  buffer_load_dwordx4 v[144:147], v234, s[40:43], s55 offen offset:1024 sc1
  v_mfma_f32_16x16x32_bf16 a[24:27], a[248:251], v[112:115], a[24:27]
  ds_read_b64_tr_b16 v[168:169], v247 offset:24576
  v_mfma_f32_16x16x32_bf16 a[28:31], a[252:255], v[112:115], a[28:31]
  ds_read_b64_tr_b16 v[170:171], v247 offset:28672
  v_mfma_f32_16x16x32_bf16 a[32:35], a[224:227], v[116:119], a[32:35]
  buffer_load_dwordx4 v[148:151], v234, s[40:43], s55 offen offset:2048 sc1
  v_mfma_f32_16x16x32_bf16 a[36:39], a[228:231], v[116:119], a[36:39]
  ds_read_b64_tr_b16 v[172:173], v225 offset:24576
  v_mfma_f32_16x16x32_bf16 a[40:43], a[232:235], v[116:119], a[40:43]
  ds_read_b64_tr_b16 v[174:175], v225 offset:28672
  v_mfma_f32_16x16x32_bf16 a[44:47], a[236:239], v[116:119], a[44:47]
  buffer_load_dwordx4 v[152:155], v234, s[40:43], s55 offen offset:3072 sc1
  v_mfma_f32_16x16x32_bf16 a[48:51], a[240:243], v[116:119], a[48:51]
  ds_read_b64_tr_b16 v[176:177], v247 offset:25088
  v_mfma_f32_16x16x32_bf16 a[52:55], a[244:247], v[116:119], a[52:55]
  s_add_u32 s55, s9, 0x1000
  ds_read_b64_tr_b16 v[178:179], v247 offset:29184
  v_mfma_f32_16x16x32_bf16 a[56:59], a[248:251], v[116:119], a[56:59]
  buffer_load_dwordx4 v[156:159], v234, s[40:43], s55 offen offset:0 sc1
  v_mfma_f32_16x16x32_bf16 a[60:63], a[252:255], v[116:119], a[60:63]
  ds_read_b64_tr_b16 v[180:181], v225 offset:25088
  v_mfma_f32_16x16x32_bf16 a[64:67], a[224:227], v[120:123], a[64:67]
  ds_read_b64_tr_b16 v[182:183], v225 offset:29184
  v_mfma_f32_16x16x32_bf16 a[68:71], a[228:231], v[120:123], a[68:71]
  buffer_load_dwordx4 v[160:163], v234, s[40:43], s55 offen offset:1024 sc1
  v_mfma_f32_16x16x32_bf16 a[72:75], a[232:235], v[120:123], a[72:75]
  ds_read_b64_tr_b16 v[184:185], v247 offset:25600
  v_mfma_f32_16x16x32_bf16 a[76:79], a[236:239], v[120:123], a[76:79]
  ds_read_b64_tr_b16 v[186:187], v247 offset:29696
  v_mfma_f32_16x16x32_bf16 a[80:83], a[240:243], v[120:123], a[80:83]
  buffer_load_dwordx4 v[164:167], v234, s[40:43], s55 offen offset:2048 sc1
  v_mfma_f32_16x16x32_bf16 a[84:87], a[244:247], v[120:123], a[84:87]
  ds_read_b64_tr_b16 v[188:189], v225 offset:25600
  v_mfma_f32_16x16x32_bf16 a[88:91], a[248:251], v[120:123], a[88:91]
  s_add_u32 s55, s10, 0
  s_nop 0
  ds_read_b64_tr_b16 v[190:191], v225 offset:29696
  v_mfma_f32_16x16x32_bf16 a[92:95], a[252:255], v[120:123], a[92:95]
  buffer_load_dwordx4 v[0:3], v234, s[40:43], s55 offen offset:0 sc1
  v_mfma_f32_16x16x32_bf16 a[96:99], a[224:227], v[124:127], a[96:99]
  ds_read_b64_tr_b16 v[192:193], v247 offset:26112
  v_mfma_f32_16x16x32_bf16 a[100:103], a[228:231], v[124:127], a[100:103]
  ds_read_b64_tr_b16 v[194:195], v247 offset:30208
  v_mfma_f32_16x16x32_bf16 a[104:107], a[232:235], v[124:127], a[104:107]
  buffer_load_dwordx4 v[4:7], v234, s[40:43], s55 offen offset:1024 sc1
  v_mfma_f32_16x16x32_bf16 a[108:111], a[236:239], v[124:127], a[108:111]
  ds_read_b64_tr_b16 v[196:197], v225 offset:26112
  v_mfma_f32_16x16x32_bf16 a[112:115], a[240:243], v[124:127], a[112:115]
  ds_read_b64_tr_b16 v[198:199], v225 offset:30208
  v_mfma_f32_16x16x32_bf16 a[116:119], a[244:247], v[124:127], a[116:119]
  buffer_load_dwordx4 v[8:11], v234, s[40:43], s55 offen offset:2048 sc1
  v_mfma_f32_16x16x32_bf16 a[120:123], a[248:251], v[124:127], a[120:123]
  v_mfma_f32_16x16x32_bf16 a[124:127], a[252:255], v[124:127], a[124:127]
  v_mfma_f32_16x16x32_bf16 a[128:131], a[224:227], v[128:131], a[128:131]
  buffer_load_dwordx4 v[12:15], v234, s[40:43], s55 offen offset:3072 sc1
  v_mfma_f32_16x16x32_bf16 a[132:135], a[228:231], v[128:131], a[132:135]
  v_mfma_f32_16x16x32_bf16 a[136:139], a[232:235], v[128:131], a[136:139]
  s_add_u32 s55, s10, 0x1000
  v_mfma_f32_16x16x32_bf16 a[140:143], a[236:239], v[128:131], a[140:143]
  buffer_load_dwordx4 v[16:19], v234, s[40:43], s55 offen offset:0 sc1
  v_mfma_f32_16x16x32_bf16 a[144:147], a[240:243], v[128:131], a[144:147]
  v_mfma_f32_16x16x32_bf16 a[148:151], a[244:247], v[128:131], a[148:151]
  v_mfma_f32_16x16x32_bf16 a[152:155], a[248:251], v[128:131], a[152:155]
  buffer_load_dwordx4 v[20:23], v234, s[40:43], s55 offen offset:1024 sc1
  v_mfma_f32_16x16x32_bf16 a[156:159], a[252:255], v[128:131], a[156:159]
  v_mfma_f32_16x16x32_bf16 a[160:163], a[224:227], v[132:135], a[160:163]
  v_mfma_f32_16x16x32_bf16 a[164:167], a[228:231], v[132:135], a[164:167]
  buffer_load_dwordx4 v[24:27], v234, s[40:43], s55 offen offset:2048 sc1
  v_mfma_f32_16x16x32_bf16 a[168:171], a[232:235], v[132:135], a[168:171]
  v_mfma_f32_16x16x32_bf16 a[172:175], a[236:239], v[132:135], a[172:175]
  v_mfma_f32_16x16x32_bf16 a[176:179], a[240:243], v[132:135], a[176:179]
  v_mfma_f32_16x16x32_bf16 a[180:183], a[244:247], v[132:135], a[180:183]
  v_mfma_f32_16x16x32_bf16 a[184:187], a[248:251], v[132:135], a[184:187]
  v_mfma_f32_16x16x32_bf16 a[188:191], a[252:255], v[132:135], a[188:191]
  v_mfma_f32_16x16x32_bf16 a[192:195], a[224:227], v[136:139], a[192:195]
  v_mfma_f32_16x16x32_bf16 a[196:199], a[228:231], v[136:139], a[196:199]
  v_mfma_f32_16x16x32_bf16 a[200:203], a[232:235], v[136:139], a[200:203]
  v_mfma_f32_16x16x32_bf16 a[204:207], a[236:239], v[136:139], a[204:207]
  v_mfma_f32_16x16x32_bf16 a[208:211], a[240:243], v[136:139], a[208:211]
  v_mfma_f32_16x16x32_bf16 a[212:215], a[244:247], v[136:139], a[212:215]
  v_mfma_f32_16x16x32_bf16 a[216:219], a[248:251], v[136:139], a[216:219]
  v_mfma_f32_16x16x32_bf16 a[220:223], a[252:255], v[136:139], a[220:223]
  s_waitcnt lgkmcnt(0)
  s_waitcnt vmcnt(7)
  v_mfma_f32_16x16x32_bf16 a[0:3], v[168:171], v[140:143], a[0:3]
  v_mfma_f32_16x16x32_bf16 a[4:7], v[172:175], v[140:143], a[4:7]
  s_barrier
  s_nop 0
  v_mfma_f32_16x16x32_bf16 a[8:11], v[176:179], v[140:143], a[8:11]
  v_mfma_f32_16x16x32_bf16 a[12:15], v[180:183], v[140:143], a[12:15]
  v_mfma_f32_16x16x32_bf16 a[16:19], v[184:187], v[140:143], a[16:19]
  v_mfma_f32_16x16x32_bf16 a[20:23], v[188:191], v[140:143], a[20:23]
  ds_read_b64_tr_b16 a[224:225], v247 offset:32768
  v_mfma_f32_16x16x32_bf16 a[24:27], v[192:195], v[140:143], a[24:27]
  s_add_u32 s55, s8, 0x1c00
  ds_read_b64_tr_b16 a[226:227], v247 offset:36864
  v_mfma_f32_16x16x32_bf16 a[28:31], v[196:199], v[140:143], a[28:31]
  buffer_load_dwordx4 v[28:31], v234, s[40:43], s55 offen offset:0 sc1
  v_mfma_f32_16x16x32_bf16 a[32:35], v[168:171], v[144:147], a[32:35]
  ds_read_b64_tr_b16 a[228:229], v225 offset:32768
  v_mfma_f32_16x16x32_bf16 a[36:39], v[172:175], v[144:147], a[36:39]
  ds_read_b64_tr_b16 a[230:231], v225 offset:36864
  v_mfma_f32_16x16x32_bf16 a[40:43], v[176:179], v[144:147], a[40:43]
  ds_read_b64_tr_b16 a[232:233], v247 offset:33280
  v_mfma_f32_16x16x32_bf16 a[44:47], v[180:183], v[144:147], a[44:47]
  buffer_load_dwordx4 v[32:35], v234, s[40:43], s55 offen offset:1024 sc1
  v_mfma_f32_16x16x32_bf16 a[48:51], v[184:187], v[144:147], a[48:51]
  ds_read_b64_tr_b16 a[234:235], v247 offset:37376
  v_mfma_f32_16x16x32_bf16 a[52:55], v[188:191], v[144:147], a[52:55]
  ds_read_b64_tr_b16 a[236:237], v225 offset:33280
  v_mfma_f32_16x16x32_bf16 a[56:59], v[192:195], v[144:147], a[56:59]
  ds_read_b64_tr_b16 a[238:239], v225 offset:37376
  v_mfma_f32_16x16x32_bf16 a[60:63], v[196:199], v[144:147], a[60:63]
  buffer_load_dwordx4 v[36:39], v234, s[40:43], s55 offen offset:2048 sc1
  v_mfma_f32_16x16x32_bf16 a[64:67], v[168:171], v[148:151], a[64:67]
  ds_read_b64_tr_b16 a[240:241], v247 offset:33792
  v_mfma_f32_16x16x32_bf16 a[68:71], v[172:175], v[148:151], a[68:71]
  ds_read_b64_tr_b16 a[242:243], v247 offset:37888
  v_mfma_f32_16x16x32_bf16 a[72:75], v[176:179], v[148:151], a[72:75]
  ds_read_b64_tr_b16 a[244:245], v225 offset:33792
  v_mfma_f32_16x16x32_bf16 a[76:79], v[180:183], v[148:151], a[76:79]
  buffer_load_dwordx4 v[40:43], v234, s[40:43], s55 offen offset:3072 sc1
  v_mfma_f32_16x16x32_bf16 a[80:83], v[184:187], v[148:151], a[80:83]
  ds_read_b64_tr_b16 a[246:247], v225 offset:37888
  v_mfma_f32_16x16x32_bf16 a[84:87], v[188:191], v[148:151], a[84:87]
  ds_read_b64_tr_b16 a[248:249], v247 offset:34304
  v_mfma_f32_16x16x32_bf16 a[88:91], v[192:195], v[148:151], a[88:91]
  s_add_u32 s55, s8, 0x2c00
  ds_read_b64_tr_b16 a[250:251], v247 offset:38400
  v_mfma_f32_16x16x32_bf16 a[92:95], v[196:199], v[148:151], a[92:95]
  buffer_load_dwordx4 v[44:47], v234, s[40:43], s55 offen offset:0 sc1
  v_mfma_f32_16x16x32_bf16 a[96:99], v[168:171], v[152:155], a[96:99]
  ds_read_b64_tr_b16 a[252:253], v225 offset:34304
  v_mfma_f32_16x16x32_bf16 a[100:103], v[172:175], v[152:155], a[100:103]
  ds_read_b64_tr_b16 a[254:255], v225 offset:38400
  v_mfma_f32_16x16x32_bf16 a[104:107], v[176:179], v[152:155], a[104:107]
  v_mfma_f32_16x16x32_bf16 a[108:111], v[180:183], v[152:155], a[108:111]
  buffer_load_dwordx4 v[48:51], v234, s[40:43], s55 offen offset:1024 sc1
  v_mfma_f32_16x16x32_bf16 a[112:115], v[184:187], v[152:155], a[112:115]
  v_mfma_f32_16x16x32_bf16 a[116:119], v[188:191], v[152:155], a[116:119]
  v_mfma_f32_16x16x32_bf16 a[120:123], v[192:195], v[152:155], a[120:123]
  v_mfma_f32_16x16x32_bf16 a[124:127], v[196:199], v[152:155], a[124:127]
  buffer_load_dwordx4 v[52:55], v234, s[40:43], s55 offen offset:2048 sc1
  v_mfma_f32_16x16x32_bf16 a[128:131], v[168:171], v[156:159], a[128:131]
  v_mfma_f32_16x16x32_bf16 a[132:135], v[172:175], v[156:159], a[132:135]
  s_add_u32 m0, s49, 0x2000
  v_mfma_f32_16x16x32_bf16 a[136:139], v[176:179], v[156:159], a[136:139]
  s_add_u32 s54, s5, 0x18000
  v_mfma_f32_16x16x32_bf16 a[140:143], v[180:183], v[156:159], a[140:143]
  buffer_load_dwordx4 v254, s[36:39], s54 offen offset:0 lds
  v_mfma_f32_16x16x32_bf16 a[144:147], v[184:187], v[156:159], a[144:147]
  v_mfma_f32_16x16x32_bf16 a[148:151], v[188:191], v[156:159], a[148:151]
  v_mfma_f32_16x16x32_bf16 a[152:155], v[192:195], v[156:159], a[152:155]
  s_add_u32 m0, s49, 0x2400
  v_mfma_f32_16x16x32_bf16 a[156:159], v[196:199], v[156:159], a[156:159]
  buffer_load_dwordx4 v227, s[36:39], s54 offen offset:0 lds
  v_mfma_f32_16x16x32_bf16 a[160:163], v[168:171], v[160:163], a[160:163]
  v_mfma_f32_16x16x32_bf16 a[164:167], v[172:175], v[160:163], a[164:167]
  s_add_u32 m0, s49, 0x2800
  v_mfma_f32_16x16x32_bf16 a[168:171], v[176:179], v[160:163], a[168:171]
  s_add_u32 s54, s5, 0x1a000
  v_mfma_f32_16x16x32_bf16 a[172:175], v[180:183], v[160:163], a[172:175]
  buffer_load_dwordx4 v254, s[36:39], s54 offen offset:0 lds
  v_mfma_f32_16x16x32_bf16 a[176:179], v[184:187], v[160:163], a[176:179]
  v_mfma_f32_16x16x32_bf16 a[180:183], v[188:191], v[160:163], a[180:183]
  v_mfma_f32_16x16x32_bf16 a[184:187], v[192:195], v[160:163], a[184:187]
  s_add_u32 m0, s49, 0x2c00
  v_mfma_f32_16x16x32_bf16 a[188:191], v[196:199], v[160:163], a[188:191]
  buffer_load_dwordx4 v227, s[36:39], s54 offen offset:0 lds
  v_mfma_f32_16x16x32_bf16 a[192:195], v[168:171], v[164:167], a[192:195]
  v_mfma_f32_16x16x32_bf16 a[196:199], v[172:175], v[164:167], a[196:199]
  v_mfma_f32_16x16x32_bf16 a[200:203], v[176:179], v[164:167], a[200:203]
  v_mfma_f32_16x16x32_bf16 a[204:207], v[180:183], v[164:167], a[204:207]
  v_mfma_f32_16x16x32_bf16 a[208:211], v[184:187], v[164:167], a[208:211]
  v_mfma_f32_16x16x32_bf16 a[212:215], v[188:191], v[164:167], a[212:215]
  v_mfma_f32_16x16x32_bf16 a[216:219], v[192:195], v[164:167], a[216:219]
  v_mfma_f32_16x16x32_bf16 a[220:223], v[196:199], v[164:167], a[220:223]
  s_waitcnt lgkmcnt(0)
  s_waitcnt vmcnt(11)
  v_mfma_f32_16x16x32_bf16 a[0:3], a[224:227], v[0:3], a[0:3]
  v_mfma_f32_16x16x32_bf16 a[4:7], a[228:231], v[0:3], a[4:7]
  v_mfma_f32_16x16x32_bf16 a[8:11], a[232:235], v[0:3], a[8:11]
  v_mfma_f32_16x16x32_bf16 a[12:15], a[236:239], v[0:3], a[12:15]
  v_mfma_f32_16x16x32_bf16 a[16:19], a[240:243], v[0:3], a[16:19]
  v_mfma_f32_16x16x32_bf16 a[20:23], a[244:247], v[0:3], a[20:23]
  ds_read_b64_tr_b16 v[168:169], v247 offset:40960
  v_mfma_f32_16x16x32_bf16 a[24:27], a[248:251], v[0:3], a[24:27]
  s_add_u32 s55, s9, 0x1c00
  ds_read_b64_tr_b16 v[170:171], v247 offset:45056
  v_mfma_f32_16x16x32_bf16 a[28:31], a[252:255], v[0:3], a[28:31]
  buffer_load_dwordx4 v[56:59], v234, s[40:43], s55 offen offset:0 sc1
  v_mfma_f32_16x16x32_bf16 a[32:35], a[224:227], v[4:7], a[32:35]
  ds_read_b64_tr_b16 v[172:173], v225 offset:40960
  v_mfma_f32_16x16x32_bf16 a[36:39], a[228:231], v[4:7], a[36:39]
  ds_read_b64_tr_b16 v[174:175], v225 offset:45056
  v_mfma_f32_16x16x32_bf16 a[40:43], a[232:235], v[4:7], a[40:43]
  buffer_load_dwordx4 v[60:63], v234, s[40:43], s55 offen offset:1024 sc1
  v_mfma_f32_16x16x32_bf16 a[44:47], a[236:239], v[4:7], a[44:47]
  ds_read_b64_tr_b16 v[176:177], v247 offset:41472
  v_mfma_f32_16x16x32_bf16 a[48:51], a[240:243], v[4:7], a[48:51]
  ds_read_b64_tr_b16 v[178:179], v247 offset:45568
  v_mfma_f32_16x16x32_bf16 a[52:55], a[244:247], v[4:7], a[52:55]
  buffer_load_dwordx4 v[64:67], v234, s[40:43], s55 offen offset:2048 sc1
  v_mfma_f32_16x16x32_bf16 a[56:59], a[248:251], v[4:7], a[56:59]
  ds_read_b64_tr_b16 v[180:181], v225 offset:41472
  v_mfma_f32_16x16x32_bf16 a[60:63], a[252:255], v[4:7], a[60:63]
  ds_read_b64_tr_b16 v[182:183], v225 offset:45568
  v_mfma_f32_16x16x32_bf16 a[64:67], a[224:227], v[8:11], a[64:67]
  buffer_load_dwordx4 v[68:71], v234, s[40:43], s55 offen offset:3072 sc1
  v_mfma_f32_16x16x32_bf16 a[68:71], a[228:231], v[8:11], a[68:71]
  ds_read_b64_tr_b16 v[184:185], v247 offset:41984
  v_mfma_f32_16x16x32_bf16 a[72:75], a[232:235], v[8:11], a[72:75]
  s_add_u32 s55, s9, 0x2c00
  ds_read_b64_tr_b16 v[186:187], v247 offset:46080
  v_mfma_f32_16x16x32_bf16 a[76:79], a[236:239], v[8:11], a[76:79]
  buffer_load_dwordx4 v[72:75], v234, s[40:43], s55 offen offset:0 sc1
  v_mfma_f32_16x16x32_bf16 a[80:83], a[240:243], v[8:11], a[80:83]
  ds_read_b64_tr_b16 v[188:189], v225 offset:41984
  v_mfma_f32_16x16x32_bf16 a[84:87], a[244:247], v[8:11], a[84:87]
  ds_read_b64_tr_b16 v[190:191], v225 offset:46080
  v_mfma_f32_16x16x32_bf16 a[88:91], a[248:251], v[8:11], a[88:91]
  buffer_load_dwordx4 v[76:79], v234, s[40:43], s55 offen offset:1024 sc1
  v_mfma_f32_16x16x32_bf16 a[92:95], a[252:255], v[8:11], a[92:95]
  ds_read_b64_tr_b16 v[192:193], v247 offset:42496
  v_mfma_f32_16x16x32_bf16 a[96:99], a[224:227], v[12:15], a[96:99]
  ds_read_b64_tr_b16 v[194:195], v247 offset:46592
  v_mfma_f32_16x16x32_bf16 a[100:103], a[228:231], v[12:15], a[100:103]
  buffer_load_dwordx4 v[80:83], v234, s[40:43], s55 offen offset:2048 sc1
  v_mfma_f32_16x16x32_bf16 a[104:107], a[232:235], v[12:15], a[104:107]
  s_add_u32 m0, s49, 0x4000
  ds_read_b64_tr_b16 v[196:197], v225 offset:42496
  v_mfma_f32_16x16x32_bf16 a[108:111], a[236:239], v[12:15], a[108:111]
  s_add_u32 s54, s6, 0x18000
  ds_read_b64_tr_b16 v[198:199], v225 offset:46592
  v_mfma_f32_16x16x32_bf16 a[112:115], a[240:243], v[12:15], a[112:115]
  buffer_load_dwordx4 v254, s[36:39], s54 offen offset:0 lds
  v_mfma_f32_16x16x32_bf16 a[116:119], a[244:247], v[12:15], a[116:119]
  v_mfma_f32_16x16x32_bf16 a[120:123], a[248:251], v[12:15], a[120:123]
  s_add_u32 m0, s49, 0x4400
  v_mfma_f32_16x16x32_bf16 a[124:127], a[252:255], v[12:15], a[124:127]
  buffer_load_dwordx4 v227, s[36:39], s54 offen offset:0 lds
  v_mfma_f32_16x16x32_bf16 a[128:131], a[224:227], v[16:19], a[128:131]
  s_add_u32 m0, s49, 0x4800
  v_mfma_f32_16x16x32_bf16 a[132:135], a[228:231], v[16:19], a[132:135]
  s_add_u32 s54, s6, 0x1a000
  v_mfma_f32_16x16x32_bf16 a[136:139], a[232:235], v[16:19], a[136:139]
  buffer_load_dwordx4 v254, s[36:39], s54 offen offset:0 lds
  v_mfma_f32_16x16x32_bf16 a[140:143], a[236:239], v[16:19], a[140:143]
  v_mfma_f32_16x16x32_bf16 a[144:147], a[240:243], v[16:19], a[144:147]
  s_add_u32 m0, s49, 0x4c00
  v_mfma_f32_16x16x32_bf16 a[148:151], a[244:247], v[16:19], a[148:151]
  buffer_load_dwordx4 v227, s[36:39], s54 offen offset:0 lds
  v_mfma_f32_16x16x32_bf16 a[152:155], a[248:251], v[16:19], a[152:155]
  s_add_u32 m0, s49, 0x6000
  v_mfma_f32_16x16x32_bf16 a[156:159], a[252:255], v[16:19], a[156:159]
  s_add_u32 s54, s7, 0x18000
  v_mfma_f32_16x16x32_bf16 a[160:163], a[224:227], v[20:23], a[160:163]
  buffer_load_dwordx4 v254, s[36:39], s54 offen offset:0 lds
  v_mfma_f32_16x16x32_bf16 a[164:167], a[228:231], v[20:23], a[164:167]
  v_mfma_f32_16x16x32_bf16 a[168:171], a[232:235], v[20:23], a[168:171]
  s_add_u32 m0, s49, 0x6400
  v_mfma_f32_16x16x32_bf16 a[172:175], a[236:239], v[20:23], a[172:175]
  buffer_load_dwordx4 v227, s[36:39], s54 offen offset:0 lds
  v_mfma_f32_16x16x32_bf16 a[176:179], a[240:243], v[20:23], a[176:179]
  s_add_u32 m0, s49, 0x6800
  v_mfma_f32_16x16x32_bf16 a[180:183], a[244:247], v[20:23], a[180:183]
  s_add_u32 s54, s7, 0x1a000
  v_mfma_f32_16x16x32_bf16 a[184:187], a[248:251], v[20:23], a[184:187]
  buffer_load_dwordx4 v254, s[36:39], s54 offen offset:0 lds
  v_mfma_f32_16x16x32_bf16 a[188:191], a[252:255], v[20:23], a[188:191]
  v_mfma_f32_16x16x32_bf16 a[192:195], a[224:227], v[24:27], a[192:195]
  s_add_u32 m0, s49, 0x6c00
  v_mfma_f32_16x16x32_bf16 a[196:199], a[228:231], v[24:27], a[196:199]
  buffer_load_dwordx4 v227, s[36:39], s54 offen offset:0 lds
  v_mfma_f32_16x16x32_bf16 a[200:203], a[232:235], v[24:27], a[200:203]
  v_mfma_f32_16x16x32_bf16 a[204:207], a[236:239], v[24:27], a[204:207]
  v_mfma_f32_16x16x32_bf16 a[208:211], a[240:243], v[24:27], a[208:211]
  v_mfma_f32_16x16x32_bf16 a[212:215], a[244:247], v[24:27], a[212:215]
  v_mfma_f32_16x16x32_bf16 a[216:219], a[248:251], v[24:27], a[216:219]
  v_mfma_f32_16x16x32_bf16 a[220:223], a[252:255], v[24:27], a[220:223]
  s_waitcnt lgkmcnt(0)
  s_waitcnt vmcnt(19)
  v_mfma_f32_16x16x32_bf16 a[0:3], v[168:171], v[28:31], a[0:3]
  v_mfma_f32_16x16x32_bf16 a[4:7], v[172:175], v[28:31], a[4:7]
  v_mfma_f32_16x16x32_bf16 a[8:11], v[176:179], v[28:31], a[8:11]
  v_mfma_f32_16x16x32_bf16 a[12:15], v[180:183], v[28:31], a[12:15]
  v_mfma_f32_16x16x32_bf16 a[16:19], v[184:187], v[28:31], a[16:19]
  v_mfma_f32_16x16x32_bf16 a[20:23], v[188:191], v[28:31], a[20:23]
  ds_read_b64_tr_b16 a[224:225], v247 offset:49152
  v_mfma_f32_16x16x32_bf16 a[24:27], v[192:195], v[28:31], a[24:27]
  s_add_u32 s55, s10, 0x1c00
  ds_read_b64_tr_b16 a[226:227], v247 offset:53248
  v_mfma_f32_16x16x32_bf16 a[28:31], v[196:199], v[28:31], a[28:31]
  buffer_load_dwordx4 v[84:87], v234, s[40:43], s55 offen offset:0 sc1
  v_mfma_f32_16x16x32_bf16 a[32:35], v[168:171], v[32:35], a[32:35]
  ds_read_b64_tr_b16 a[228:229], v225 offset:49152
  v_mfma_f32_16x16x32_bf16 a[36:39], v[172:175], v[32:35], a[36:39]
  ds_read_b64_tr_b16 a[230:231], v225 offset:53248
  v_mfma_f32_16x16x32_bf16 a[40:43], v[176:179], v[32:35], a[40:43]
  ds_read_b64_tr_b16 a[232:233], v247 offset:49664
  v_mfma_f32_16x16x32_bf16 a[44:47], v[180:183], v[32:35], a[44:47]
  ds_read_b64_tr_b16 a[234:235], v247 offset:53760
  v_mfma_f32_16x16x32_bf16 a[48:51], v[184:187], v[32:35], a[48:51]
  buffer_load_dwordx4 v[88:91], v234, s[40:43], s55 offen offset:1024 sc1
  v_mfma_f32_16x16x32_bf16 a[52:55], v[188:191], v[32:35], a[52:55]
  ds_read_b64_tr_b16 a[236:237], v225 offset:49664
  v_mfma_f32_16x16x32_bf16 a[56:59], v[192:195], v[32:35], a[56:59]
  ds_read_b64_tr_b16 a[238:239], v225 offset:53760
  v_mfma_f32_16x16x32_bf16 a[60:63], v[196:199], v[32:35], a[60:63]
  ds_read_b64_tr_b16 a[240:241], v247 offset:50176
  v_mfma_f32_16x16x32_bf16 a[64:67], v[168:171], v[36:39], a[64:67]
  ds_read_b64_tr_b16 a[242:243], v247 offset:54272
  v_mfma_f32_16x16x32_bf16 a[68:71], v[172:175], v[36:39], a[68:71]
  buffer_load_dwordx4 v[92:95], v234, s[40:43], s55 offen offset:2048 sc1
  v_mfma_f32_16x16x32_bf16 a[72:75], v[176:179], v[36:39], a[72:75]
  ds_read_b64_tr_b16 a[244:245], v225 offset:50176
  v_mfma_f32_16x16x32_bf16 a[76:79], v[180:183], v[36:39], a[76:79]
  ds_read_b64_tr_b16 a[246:247], v225 offset:54272
  v_mfma_f32_16x16x32_bf16 a[80:83], v[184:187], v[36:39], a[80:83]
  ds_read_b64_tr_b16 a[248:249], v247 offset:50688
  v_mfma_f32_16x16x32_bf16 a[84:87], v[188:191], v[36:39], a[84:87]
  ds_read_b64_tr_b16 a[250:251], v247 offset:54784
  v_mfma_f32_16x16x32_bf16 a[88:91], v[192:195], v[36:39], a[88:91]
  buffer_load_dwordx4 v[96:99], v234, s[40:43], s55 offen offset:3072 sc1
  v_mfma_f32_16x16x32_bf16 a[92:95], v[196:199], v[36:39], a[92:95]
  ds_read_b64_tr_b16 a[252:253], v225 offset:50688
  v_mfma_f32_16x16x32_bf16 a[96:99], v[168:171], v[40:43], a[96:99]
  ds_read_b64_tr_b16 a[254:255], v225 offset:54784
  v_mfma_f32_16x16x32_bf16 a[100:103], v[172:175], v[40:43], a[100:103]
  v_mfma_f32_16x16x32_bf16 a[104:107], v[176:179], v[40:43], a[104:107]
  s_add_u32 s55, s10, 0x2c00
  v_mfma_f32_16x16x32_bf16 a[108:111], v[180:183], v[40:43], a[108:111]
  buffer_load_dwordx4 v[100:103], v234, s[40:43], s55 offen offset:0 sc1
  v_mfma_f32_16x16x32_bf16 a[112:115], v[184:187], v[40:43], a[112:115]
  v_mfma_f32_16x16x32_bf16 a[116:119], v[188:191], v[40:43], a[116:119]
  v_mfma_f32_16x16x32_bf16 a[120:123], v[192:195], v[40:43], a[120:123]
  v_mfma_f32_16x16x32_bf16 a[124:127], v[196:199], v[40:43], a[124:127]
  v_mfma_f32_16x16x32_bf16 a[128:131], v[168:171], v[44:47], a[128:131]
  buffer_load_dwordx4 v[104:107], v234, s[40:43], s55 offen offset:1024 sc1
  v_mfma_f32_16x16x32_bf16 a[132:135], v[172:175], v[44:47], a[132:135]
  v_mfma_f32_16x16x32_bf16 a[136:139], v[176:179], v[44:47], a[136:139]
  v_mfma_f32_16x16x32_bf16 a[140:143], v[180:183], v[44:47], a[140:143]
  v_mfma_f32_16x16x32_bf16 a[144:147], v[184:187], v[44:47], a[144:147]
  v_mfma_f32_16x16x32_bf16 a[148:151], v[188:191], v[44:47], a[148:151]
  buffer_load_dwordx4 v[108:111], v234, s[40:43], s55 offen offset:2048 sc1
  v_mfma_f32_16x16x32_bf16 a[152:155], v[192:195], v[44:47], a[152:155]
  v_mfma_f32_16x16x32_bf16 a[156:159], v[196:199], v[44:47], a[156:159]
  v_mfma_f32_16x16x32_bf16 a[160:163], v[168:171], v[48:51], a[160:163]
  v_mfma_f32_16x16x32_bf16 a[164:167], v[172:175], v[48:51], a[164:167]
  v_mfma_f32_16x16x32_bf16 a[168:171], v[176:179], v[48:51], a[168:171]
  v_mfma_f32_16x16x32_bf16 a[172:175], v[180:183], v[48:51], a[172:175]
  v_mfma_f32_16x16x32_bf16 a[176:179], v[184:187], v[48:51], a[176:179]
  v_mfma_f32_16x16x32_bf16 a[180:183], v[188:191], v[48:51], a[180:183]
  v_mfma_f32_16x16x32_bf16 a[184:187], v[192:195], v[48:51], a[184:187]
  v_mfma_f32_16x16x32_bf16 a[188:191], v[196:199], v[48:51], a[188:191]
  v_mfma_f32_16x16x32_bf16 a[192:195], v[168:171], v[52:55], a[192:195]
  v_mfma_f32_16x16x32_bf16 a[196:199], v[172:175], v[52:55], a[196:199]
  v_mfma_f32_16x16x32_bf16 a[200:203], v[176:179], v[52:55], a[200:203]
  v_mfma_f32_16x16x32_bf16 a[204:207], v[180:183], v[52:55], a[204:207]
  v_mfma_f32_16x16x32_bf16 a[208:211], v[184:187], v[52:55], a[208:211]
  v_mfma_f32_16x16x32_bf16 a[212:215], v[188:191], v[52:55], a[212:215]
  v_mfma_f32_16x16x32_bf16 a[216:219], v[192:195], v[52:55], a[216:219]
  v_mfma_f32_16x16x32_bf16 a[220:223], v[196:199], v[52:55], a[220:223]
  s_waitcnt lgkmcnt(0)
  s_waitcnt vmcnt(15)
  v_mfma_f32_16x16x32_bf16 a[0:3], a[224:227], v[56:59], a[0:3]
  v_mfma_f32_16x16x32_bf16 a[4:7], a[228:231], v[56:59], a[4:7]
  v_mfma_f32_16x16x32_bf16 a[8:11], a[232:235], v[56:59], a[8:11]
  v_mfma_f32_16x16x32_bf16 a[12:15], a[236:239], v[56:59], a[12:15]
  v_mfma_f32_16x16x32_bf16 a[16:19], a[240:243], v[56:59], a[16:19]
  v_mfma_f32_16x16x32_bf16 a[20:23], a[244:247], v[56:59], a[20:23]
  ds_read_b64_tr_b16 v[168:169], v247 offset:57344
  v_mfma_f32_16x16x32_bf16 a[24:27], a[248:251], v[56:59], a[24:27]
  s_add_u32 s55, s8, 0x3800
  ds_read_b64_tr_b16 v[170:171], v247 offset:61440
  v_mfma_f32_16x16x32_bf16 a[28:31], a[252:255], v[56:59], a[28:31]
  buffer_load_dwordx4 v[112:115], v234, s[40:43], s55 offen offset:0 sc1
  v_mfma_f32_16x16x32_bf16 a[32:35], a[224:227], v[60:63], a[32:35]
  ds_read_b64_tr_b16 v[172:173], v225 offset:57344
  v_mfma_f32_16x16x32_bf16 a[36:39], a[228:231], v[60:63], a[36:39]
  ds_read_b64_tr_b16 v[174:175], v225 offset:61440
  v_mfma_f32_16x16x32_bf16 a[40:43], a[232:235], v[60:63], a[40:43]
  ds_read_b64_tr_b16 v[176:177], v247 offset:57856
  v_mfma_f32_16x16x32_bf16 a[44:47], a[236:239], v[60:63], a[44:47]
  ds_read_b64_tr_b16 v[178:179], v247 offset:61952
  v_mfma_f32_16x16x32_bf16 a[48:51], a[240:243], v[60:63], a[48:51]
  buffer_load_dwordx4 v[116:119], v234, s[40:43], s55 offen offset:1024 sc1
  v_mfma_f32_16x16x32_bf16 a[52:55], a[244:247], v[60:63], a[52:55]
  ds_read_b64_tr_b16 v[180:181], v225 offset:57856
  v_mfma_f32_16x16x32_bf16 a[56:59], a[248:251], v[60:63], a[56:59]
  ds_read_b64_tr_b16 v[182:183], v225 offset:61952
  v_mfma_f32_16x16x32_bf16 a[60:63], a[252:255], v[60:63], a[60:63]
  ds_read_b64_tr_b16 v[184:185], v247 offset:58368
  v_mfma_f32_16x16x32_bf16 a[64:67], a[224:227], v[64:67], a[64:67]
  ds_read_b64_tr_b16 v[186:187], v247 offset:62464
  v_mfma_f32_16x16x32_bf16 a[68:71], a[228:231], v[64:67], a[68:71]
  buffer_load_dwordx4 v[120:123], v234, s[40:43], s55 offen offset:2048 sc1
  v_mfma_f32_16x16x32_bf16 a[72:75], a[232:235], v[64:67], a[72:75]
  ds_read_b64_tr_b16 v[188:189], v225 offset:58368
  v_mfma_f32_16x16x32_bf16 a[76:79], a[236:239], v[64:67], a[76:79]
  ds_read_b64_tr_b16 v[190:191], v225 offset:62464
  v_mfma_f32_16x16x32_bf16 a[80:83], a[240:243], v[64:67], a[80:83]
  ds_read_b64_tr_b16 v[192:193], v247 offset:58880
  v_mfma_f32_16x16x32_bf16 a[84:87], a[244:247], v[64:67], a[84:87]
  ds_read_b64_tr_b16 v[194:195], v247 offset:62976
  v_mfma_f32_16x16x32_bf16 a[88:91], a[248:251], v[64:67], a[88:91]
  buffer_load_dwordx4 v[124:127], v234, s[40:43], s55 offen offset:3072 sc1
  v_mfma_f32_16x16x32_bf16 a[92:95], a[252:255], v[64:67], a[92:95]
  ds_read_b64_tr_b16 v[196:197], v225 offset:58880
  v_mfma_f32_16x16x32_bf16 a[96:99], a[224:227], v[68:71], a[96:99]
  ds_read_b64_tr_b16 v[198:199], v225 offset:62976
  v_mfma_f32_16x16x32_bf16 a[100:103], a[228:231], v[68:71], a[100:103]
  v_mfma_f32_16x16x32_bf16 a[104:107], a[232:235], v[68:71], a[104:107]
  s_add_u32 s55, s8, 0x4800
  v_mfma_f32_16x16x32_bf16 a[108:111], a[236:239], v[68:71], a[108:111]
  buffer_load_dwordx4 v[128:131], v234, s[40:43], s55 offen offset:0 sc1
  v_mfma_f32_16x16x32_bf16 a[112:115], a[240:243], v[68:71], a[112:115]
  v_mfma_f32_16x16x32_bf16 a[116:119], a[244:247], v[68:71], a[116:119]
  v_mfma_f32_16x16x32_bf16 a[120:123], a[248:251], v[68:71], a[120:123]
  v_mfma_f32_16x16x32_bf16 a[124:127], a[252:255], v[68:71], a[124:127]
  v_mfma_f32_16x16x32_bf16 a[128:131], a[224:227], v[72:75], a[128:131]
  buffer_load_dwordx4 v[132:135], v234, s[40:43], s55 offen offset:1024 sc1
  v_mfma_f32_16x16x32_bf16 a[132:135], a[228:231], v[72:75], a[132:135]
  v_mfma_f32_16x16x32_bf16 a[136:139], a[232:235], v[72:75], a[136:139]
  v_mfma_f32_16x16x32_bf16 a[140:143], a[236:239], v[72:75], a[140:143]
  v_mfma_f32_16x16x32_bf16 a[144:147], a[240:243], v[72:75], a[144:147]
  v_mfma_f32_16x16x32_bf16 a[148:151], a[244:247], v[72:75], a[148:151]
  buffer_load_dwordx4 v[136:139], v234, s[40:43], s55 offen offset:2048 sc1
  v_mfma_f32_16x16x32_bf16 a[152:155], a[248:251], v[72:75], a[152:155]
  v_mfma_f32_16x16x32_bf16 a[156:159], a[252:255], v[72:75], a[156:159]
  v_mfma_f32_16x16x32_bf16 a[160:163], a[224:227], v[76:79], a[160:163]
  v_mfma_f32_16x16x32_bf16 a[164:167], a[228:231], v[76:79], a[164:167]
  v_mfma_f32_16x16x32_bf16 a[168:171], a[232:235], v[76:79], a[168:171]
  v_mfma_f32_16x16x32_bf16 a[172:175], a[236:239], v[76:79], a[172:175]
  v_mfma_f32_16x16x32_bf16 a[176:179], a[240:243], v[76:79], a[176:179]
  v_mfma_f32_16x16x32_bf16 a[180:183], a[244:247], v[76:79], a[180:183]
  v_mfma_f32_16x16x32_bf16 a[184:187], a[248:251], v[76:79], a[184:187]
  v_mfma_f32_16x16x32_bf16 a[188:191], a[252:255], v[76:79], a[188:191]
  v_mfma_f32_16x16x32_bf16 a[192:195], a[224:227], v[80:83], a[192:195]
  v_mfma_f32_16x16x32_bf16 a[196:199], a[228:231], v[80:83], a[196:199]
  v_mfma_f32_16x16x32_bf16 a[200:203], a[232:235], v[80:83], a[200:203]
  v_mfma_f32_16x16x32_bf16 a[204:207], a[236:239], v[80:83], a[204:207]
  v_mfma_f32_16x16x32_bf16 a[208:211], a[240:243], v[80:83], a[208:211]
  v_mfma_f32_16x16x32_bf16 a[212:215], a[244:247], v[80:83], a[212:215]
  v_mfma_f32_16x16x32_bf16 a[216:219], a[248:251], v[80:83], a[216:219]
  v_mfma_f32_16x16x32_bf16 a[220:223], a[252:255], v[80:83], a[220:223]
  s_waitcnt lgkmcnt(0)
  s_waitcnt vmcnt(7)
  v_mfma_f32_16x16x32_bf16 a[0:3], v[168:171], v[84:87], a[0:3]
  s_waitcnt vmcnt(14)
  s_nop 0
  v_mfma_f32_16x16x32_bf16 a[4:7], v[172:175], v[84:87], a[4:7]
  s_barrier
  s_nop 0
  v_mfma_f32_16x16x32_bf16 a[8:11], v[176:179], v[84:87], a[8:11]
  v_mfma_f32_16x16x32_bf16 a[12:15], v[180:183], v[84:87], a[12:15]
  v_mfma_f32_16x16x32_bf16 a[16:19], v[184:187], v[84:87], a[16:19]
  v_mfma_f32_16x16x32_bf16 a[20:23], v[188:191], v[84:87], a[20:23]
  ds_read_b64_tr_b16 a[224:225], v230 offset:0
  v_mfma_f32_16x16x32_bf16 a[24:27], v[192:195], v[84:87], a[24:27]
  s_add_u32 s55, s9, 0x3800
  ds_read_b64_tr_b16 a[226:227], v230 offset:4096
  v_mfma_f32_16x16x32_bf16 a[28:31], v[196:199], v[84:87], a[28:31]
  buffer_load_dwordx4 v[140:143], v234, s[40:43], s55 offen offset:0 sc1
  v_mfma_f32_16x16x32_bf16 a[32:35], v[168:171], v[88:91], a[32:35]
  ds_read_b64_tr_b16 a[228:229], v231 offset:0
  v_mfma_f32_16x16x32_bf16 a[36:39], v[172:175], v[88:91], a[36:39]
  ds_read_b64_tr_b16 a[230:231], v231 offset:4096
  v_mfma_f32_16x16x32_bf16 a[40:43], v[176:179], v[88:91], a[40:43]
  buffer_load_dwordx4 v[144:147], v234, s[40:43], s55 offen offset:1024 sc1
  v_mfma_f32_16x16x32_bf16 a[44:47], v[180:183], v[88:91], a[44:47]
  ds_read_b64_tr_b16 a[232:233], v230 offset:512
  v_mfma_f32_16x16x32_bf16 a[48:51], v[184:187], v[88:91], a[48:51]
  ds_read_b64_tr_b16 a[234:235], v230 offset:4608
  v_mfma_f32_16x16x32_bf16 a[52:55], v[188:191], v[88:91], a[52:55]
  buffer_load_dwordx4 v[148:151], v234, s[40:43], s55 offen offset:2048 sc1
  v_mfma_f32_16x16x32_bf16 a[56:59], v[192:195], v[88:91], a[56:59]
  ds_read_b64_tr_b16 a[236:237], v231 offset:512
  v_mfma_f32_16x16x32_bf16 a[60:63], v[196:199], v[88:91], a[60:63]
  ds_read_b64_tr_b16 a[238:239], v231 offset:4608
  v_mfma_f32_16x16x32_bf16 a[64:67], v[168:171], v[92:95], a[64:67]
  buffer_load_dwordx4 v[152:155], v234, s[40:43], s55 offen offset:3072 sc1
  v_mfma_f32_16x16x32_bf16 a[68:71], v[172:175], v[92:95], a[68:71]
  ds_read_b64_tr_b16 a[240:241], v230 offset:1024
  v_mfma_f32_16x16x32_bf16 a[72:75], v[176:179], v[92:95], a[72:75]
  s_add_u32 s55, s9, 0x4800
  ds_read_b64_tr_b16 a[242:243], v230 offset:5120
  v_mfma_f32_16x16x32_bf16 a[76:79], v[180:183], v[92:95], a[76:79]
  buffer_load_dwordx4 v[156:159], v234, s[40:43], s55 offen offset:0 sc1
  v_mfma_f32_16x16x32_bf16 a[80:83], v[184:187], v[92:95], a[80:83]
  ds_read_b64_tr_b16 a[244:245], v231 offset:1024
  v_mfma_f32_16x16x32_bf16 a[84:87], v[188:191], v[92:95], a[84:87]
  ds_read_b64_tr_b16 a[246:247], v231 offset:5120
  v_mfma_f32_16x16x32_bf16 a[88:91], v[192:195], v[92:95], a[88:91]
  buffer_load_dwordx4 v[160:163], v234, s[40:43], s55 offen offset:1024 sc1
  v_mfma_f32_16x16x32_bf16 a[92:95], v[196:199], v[92:95], a[92:95]
  ds_read_b64_tr_b16 a[248:249], v230 offset:1536
  v_mfma_f32_16x16x32_bf16 a[96:99], v[168:171], v[96:99], a[96:99]
  ds_read_b64_tr_b16 a[250:251], v230 offset:5632
  v_mfma_f32_16x16x32_bf16 a[100:103], v[172:175], v[96:99], a[100:103]
  buffer_load_dwordx4 v[164:167], v234, s[40:43], s55 offen offset:2048 sc1
  v_mfma_f32_16x16x32_bf16 a[104:107], v[176:179], v[96:99], a[104:107]
  ds_read_b64_tr_b16 a[252:253], v231 offset:1536
  v_mfma_f32_16x16x32_bf16 a[108:111], v[180:183], v[96:99], a[108:111]
  s_add_u32 s55, s10, 0x3800
  ds_read_b64_tr_b16 a[254:255], v231 offset:5632
  v_mfma_f32_16x16x32_bf16 a[112:115], v[184:187], v[96:99], a[112:115]
  buffer_load_dwordx4 v[0:3], v234, s[40:43], s55 offen offset:0 sc1
  v_mfma_f32_16x16x32_bf16 a[116:119], v[188:191], v[96:99], a[116:119]
  v_mfma_f32_16x16x32_bf16 a[120:123], v[192:195], v[96:99], a[120:123]
  v_mfma_f32_16x16x32_bf16 a[124:127], v[196:199], v[96:99], a[124:127]
  buffer_load_dwordx4 v[4:7], v234, s[40:43], s55 offen offset:1024 sc1
  v_mfma_f32_16x16x32_bf16 a[128:131], v[168:171], v[100:103], a[128:131]
  v_mfma_f32_16x16x32_bf16 a[132:135], v[172:175], v[100:103], a[132:135]
  v_mfma_f32_16x16x32_bf16 a[136:139], v[176:179], v[100:103], a[136:139]
  buffer_load_dwordx4 v[8:11], v234, s[40:43], s55 offen offset:2048 sc1
  v_mfma_f32_16x16x32_bf16 a[140:143], v[180:183], v[100:103], a[140:143]
  v_mfma_f32_16x16x32_bf16 a[144:147], v[184:187], v[100:103], a[144:147]
  v_mfma_f32_16x16x32_bf16 a[148:151], v[188:191], v[100:103], a[148:151]
  buffer_load_dwordx4 v[12:15], v234, s[40:43], s55 offen offset:3072 sc1
  v_mfma_f32_16x16x32_bf16 a[152:155], v[192:195], v[100:103], a[152:155]
  v_mfma_f32_16x16x32_bf16 a[156:159], v[196:199], v[100:103], a[156:159]
  s_add_u32 s55, s10, 0x4800
  v_mfma_f32_16x16x32_bf16 a[160:163], v[168:171], v[104:107], a[160:163]
  buffer_load_dwordx4 v[16:19], v234, s[40:43], s55 offen offset:0 sc1
  v_mfma_f32_16x16x32_bf16 a[164:167], v[172:175], v[104:107], a[164:167]
  v_mfma_f32_16x16x32_bf16 a[168:171], v[176:179], v[104:107], a[168:171]
  v_mfma_f32_16x16x32_bf16 a[172:175], v[180:183], v[104:107], a[172:175]
  buffer_load_dwordx4 v[20:23], v234, s[40:43], s55 offen offset:1024 sc1
  v_mfma_f32_16x16x32_bf16 a[176:179], v[184:187], v[104:107], a[176:179]
  v_mfma_f32_16x16x32_bf16 a[180:183], v[188:191], v[104:107], a[180:183]
  v_mfma_f32_16x16x32_bf16 a[184:187], v[192:195], v[104:107], a[184:187]
  buffer_load_dwordx4 v[24:27], v234, s[40:43], s55 offen offset:2048 sc1
  v_mfma_f32_16x16x32_bf16 a[188:191], v[196:199], v[104:107], a[188:191]
  v_mfma_f32_16x16x32_bf16 a[192:195], v[168:171], v[108:111], a[192:195]
  v_mfma_f32_16x16x32_bf16 a[196:199], v[172:175], v[108:111], a[196:199]
  v_mfma_f32_16x16x32_bf16 a[200:203], v[176:179], v[108:111], a[200:203]
  v_mfma_f32_16x16x32_bf16 a[204:207], v[180:183], v[108:111], a[204:207]
  v_mfma_f32_16x16x32_bf16 a[208:211], v[184:187], v[108:111], a[208:211]
  v_mfma_f32_16x16x32_bf16 a[212:215], v[188:191], v[108:111], a[212:215]
  v_mfma_f32_16x16x32_bf16 a[216:219], v[192:195], v[108:111], a[216:219]
  v_mfma_f32_16x16x32_bf16 a[220:223], v[196:199], v[108:111], a[220:223]
  s_waitcnt lgkmcnt(0)
  s_waitcnt vmcnt(14)
  v_mfma_f32_16x16x32_bf16 a[0:3], a[224:227], v[112:115], a[0:3]
  v_mfma_f32_16x16x32_bf16 a[4:7], a[228:231], v[112:115], a[4:7]
  v_mfma_f32_16x16x32_bf16 a[8:11], a[232:235], v[112:115], a[8:11]
  v_mfma_f32_16x16x32_bf16 a[12:15], a[236:239], v[112:115], a[12:15]
  v_mfma_f32_16x16x32_bf16 a[16:19], a[240:243], v[112:115], a[16:19]
  v_mfma_f32_16x16x32_bf16 a[20:23], a[244:247], v[112:115], a[20:23]
  ds_read_b64_tr_b16 v[168:169], v230 offset:8192
  v_mfma_f32_16x16x32_bf16 a[24:27], a[248:251], v[112:115], a[24:27]
  s_add_u32 s55, s8, 0x5400
  ds_read_b64_tr_b16 v[170:171], v230 offset:12288
  v_mfma_f32_16x16x32_bf16 a[28:31], a[252:255], v[112:115], a[28:31]
  buffer_load_dwordx4 v[28:31], v234, s[40:43], s55 offen offset:0 sc1
  v_mfma_f32_16x16x32_bf16 a[32:35], a[224:227], v[116:119], a[32:35]
  ds_read_b64_tr_b16 v[172:173], v231 offset:8192
  v_mfma_f32_16x16x32_bf16 a[36:39], a[228:231], v[116:119], a[36:39]
  ds_read_b64_tr_b16 v[174:175], v231 offset:12288
  v_mfma_f32_16x16x32_bf16 a[40:43], a[232:235], v[116:119], a[40:43]
  buffer_load_dwordx4 v[32:35], v234, s[40:43], s55 offen offset:1024 sc1
  v_mfma_f32_16x16x32_bf16 a[44:47], a[236:239], v[116:119], a[44:47]
  ds_read_b64_tr_b16 v[176:177], v230 offset:8704
  v_mfma_f32_16x16x32_bf16 a[48:51], a[240:243], v[116:119], a[48:51]
  ds_read_b64_tr_b16 v[178:179], v230 offset:12800
  v_mfma_f32_16x16x32_bf16 a[52:55], a[244:247], v[116:119], a[52:55]
  buffer_load_dwordx4 v[36:39], v234, s[40:43], s55 offen offset:2048 sc1
  v_mfma_f32_16x16x32_bf16 a[56:59], a[248:251], v[116:119], a[56:59]
  ds_read_b64_tr_b16 v[180:181], v231 offset:8704
  v_mfma_f32_16x16x32_bf16 a[60:63], a[252:255], v[116:119], a[60:63]
  ds_read_b64_tr_b16 v[182:183], v231 offset:12800
  v_mfma_f32_16x16x32_bf16 a[64:67], a[224:227], v[120:123], a[64:67]
  buffer_load_dwordx4 v[40:43], v234, s[40:43], s55 offen offset:3072 sc1
  v_mfma_f32_16x16x32_bf16 a[68:71], a[228:231], v[120:123], a[68:71]
  ds_read_b64_tr_b16 v[184:185], v230 offset:9216
  v_mfma_f32_16x16x32_bf16 a[72:75], a[232:235], v[120:123], a[72:75]
  s_add_u32 s55, s8, 0x6400
  ds_read_b64_tr_b16 v[186:187], v230 offset:13312
  v_mfma_f32_16x16x32_bf16 a[76:79], a[236:239], v[120:123], a[76:79]
  buffer_load_dwordx4 v[44:47], v234, s[40:43], s55 offen offset:0 sc1
  v_mfma_f32_16x16x32_bf16 a[80:83], a[240:243], v[120:123], a[80:83]
  ds_read_b64_tr_b16 v[188:189], v231 offset:9216
  v_mfma_f32_16x16x32_bf16 a[84:87], a[244:247], v[120:123], a[84:87]
  ds_read_b64_tr_b16 v[190:191], v231 offset:13312
  v_mfma_f32_16x16x32_bf16 a[88:91], a[248:251], v[120:123], a[88:91]
  buffer_load_dwordx4 v[48:51], v234, s[40:43], s55 offen offset:1024 sc1
  v_mfma_f32_16x16x32_bf16 a[92:95], a[252:255], v[120:123], a[92:95]
  ds_read_b64_tr_b16 v[192:193], v230 offset:9728
  v_mfma_f32_16x16x32_bf16 a[96:99], a[224:227], v[124:127], a[96:99]
  ds_read_b64_tr_b16 v[194:195], v230 offset:13824
  v_mfma_f32_16x16x32_bf16 a[100:103], a[228:231], v[124:127], a[100:103]
  buffer_load_dwordx4 v[52:55], v234, s[40:43], s55 offen offset:2048 sc1
  v_mfma_f32_16x16x32_bf16 a[104:107], a[232:235], v[124:127], a[104:107]
  ds_read_b64_tr_b16 v[196:197], v231 offset:9728
  v_mfma_f32_16x16x32_bf16 a[108:111], a[236:239], v[124:127], a[108:111]
  s_add_u32 s55, s9, 0x5400
  ds_read_b64_tr_b16 v[198:199], v231 offset:13824
  v_mfma_f32_16x16x32_bf16 a[112:115], a[240:243], v[124:127], a[112:115]
  buffer_load_dwordx4 v[56:59], v234, s[40:43], s55 offen offset:0 sc1
  v_mfma_f32_16x16x32_bf16 a[116:119], a[244:247], v[124:127], a[116:119]
  v_mfma_f32_16x16x32_bf16 a[120:123], a[248:251], v[124:127], a[120:123]
  v_mfma_f32_16x16x32_bf16 a[124:127], a[252:255], v[124:127], a[124:127]
  buffer_load_dwordx4 v[60:63], v234, s[40:43], s55 offen offset:1024 sc1
  v_mfma_f32_16x16x32_bf16 a[128:131], a[224:227], v[128:131], a[128:131]
  v_mfma_f32_16x16x32_bf16 a[132:135], a[228:231], v[128:131], a[132:135]
  v_mfma_f32_16x16x32_bf16 a[136:139], a[232:235], v[128:131], a[136:139]
  buffer_load_dwordx4 v[64:67], v234, s[40:43], s55 offen offset:2048 sc1
  v_mfma_f32_16x16x32_bf16 a[140:143], a[236:239], v[128:131], a[140:143]
  v_mfma_f32_16x16x32_bf16 a[144:147], a[240:243], v[128:131], a[144:147]
  v_mfma_f32_16x16x32_bf16 a[148:151], a[244:247], v[128:131], a[148:151]
  buffer_load_dwordx4 v[68:71], v234, s[40:43], s55 offen offset:3072 sc1
  v_mfma_f32_16x16x32_bf16 a[152:155], a[248:251], v[128:131], a[152:155]
  v_mfma_f32_16x16x32_bf16 a[156:159], a[252:255], v[128:131], a[156:159]
  s_add_u32 s55, s9, 0x6400
  v_mfma_f32_16x16x32_bf16 a[160:163], a[224:227], v[132:135], a[160:163]
  buffer_load_dwordx4 v[72:75], v234, s[40:43], s55 offen offset:0 sc1
  v_mfma_f32_16x16x32_bf16 a[164:167], a[228:231], v[132:135], a[164:167]
  v_mfma_f32_16x16x32_bf16 a[168:171], a[232:235], v[132:135], a[168:171]
  v_mfma_f32_16x16x32_bf16 a[172:175], a[236:239], v[132:135], a[172:175]
  buffer_load_dwordx4 v[76:79], v234, s[40:43], s55 offen offset:1024 sc1
  v_mfma_f32_16x16x32_bf16 a[176:179], a[240:243], v[132:135], a[176:179]
  v_mfma_f32_16x16x32_bf16 a[180:183], a[244:247], v[132:135], a[180:183]
  v_mfma_f32_16x16x32_bf16 a[184:187], a[248:251], v[132:135], a[184:187]
  buffer_load_dwordx4 v[80:83], v234, s[40:43], s55 offen offset:2048 sc1
  v_mfma_f32_16x16x32_bf16 a[188:191], a[252:255], v[132:135], a[188:191]
  v_mfma_f32_16x16x32_bf16 a[192:195], a[224:227], v[136:139], a[192:195]
  v_mfma_f32_16x16x32_bf16 a[196:199], a[228:231], v[136:139], a[196:199]
  v_mfma_f32_16x16x32_bf16 a[200:203], a[232:235], v[136:139], a[200:203]
  v_mfma_f32_16x16x32_bf16 a[204:207], a[236:239], v[136:139], a[204:207]
  v_mfma_f32_16x16x32_bf16 a[208:211], a[240:243], v[136:139], a[208:211]
  v_mfma_f32_16x16x32_bf16 a[212:215], a[244:247], v[136:139], a[212:215]
  v_mfma_f32_16x16x32_bf16 a[216:219], a[248:251], v[136:139], a[216:219]
  v_mfma_f32_16x16x32_bf16 a[220:223], a[252:255], v[136:139], a[220:223]
  s_waitcnt lgkmcnt(0)
  s_waitcnt vmcnt(21)
  v_mfma_f32_16x16x32_bf16 a[0:3], v[168:171], v[140:143], a[0:3]
  v_mfma_f32_16x16x32_bf16 a[4:7], v[172:175], v[140:143], a[4:7]
  v_mfma_f32_16x16x32_bf16 a[8:11], v[176:179], v[140:143], a[8:11]
  v_mfma_f32_16x16x32_bf16 a[12:15], v[180:183], v[140:143], a[12:15]
  v_mfma_f32_16x16x32_bf16 a[16:19], v[184:187], v[140:143], a[16:19]
  v_mfma_f32_16x16x32_bf16 a[20:23], v[188:191], v[140:143], a[20:23]
  ds_read_b64_tr_b16 a[224:225], v225 offset:1024
  v_mfma_f32_16x16x32_bf16 a[24:27], v[192:195], v[140:143], a[24:27]
  s_add_u32 s55, s10, 0x5400
  ds_read_b64_tr_b16 a[226:227], v225 offset:5120
  v_mfma_f32_16x16x32_bf16 a[28:31], v[196:199], v[140:143], a[28:31]
  buffer_load_dwordx4 v[84:87], v234, s[40:43], s55 offen offset:0 sc1
  v_mfma_f32_16x16x32_bf16 a[32:35], v[168:171], v[144:147], a[32:35]
  ds_read_b64_tr_b16 a[228:229], v225 offset:9216
  v_mfma_f32_16x16x32_bf16 a[36:39], v[172:175], v[144:147], a[36:39]
  ds_read_b64_tr_b16 a[230:231], v225 offset:13312
  v_mfma_f32_16x16x32_bf16 a[40:43], v[176:179], v[144:147], a[40:43]
  ds_read_b64_tr_b16 a[232:233], v225 offset:17408
  v_mfma_f32_16x16x32_bf16 a[44:47], v[180:183], v[144:147], a[44:47]
  ds_read_b64_tr_b16 a[234:235], v225 offset:21504
  v_mfma_f32_16x16x32_bf16 a[48:51], v[184:187], v[144:147], a[48:51]
  buffer_load_dwordx4 v[88:91], v234, s[40:43], s55 offen offset:1024 sc1
  v_mfma_f32_16x16x32_bf16 a[52:55], v[188:191], v[144:147], a[52:55]
  ds_read_b64_tr_b16 a[236:237], v225 offset:25600
  v_mfma_f32_16x16x32_bf16 a[56:59], v[192:195], v[144:147], a[56:59]
  ds_read_b64_tr_b16 a[238:239], v225 offset:29696
  v_mfma_f32_16x16x32_bf16 a[60:63], v[196:199], v[144:147], a[60:63]
  ds_read_b64_tr_b16 a[240:241], v225 offset:0
  v_mfma_f32_16x16x32_bf16 a[64:67], v[168:171], v[148:151], a[64:67]
  ds_read_b64_tr_b16 a[242:243], v225 offset:4096
  v_mfma_f32_16x16x32_bf16 a[68:71], v[172:175], v[148:151], a[68:71]
  buffer_load_dwordx4 v[92:95], v234, s[40:43], s55 offen offset:2048 sc1
  v_mfma_f32_16x16x32_bf16 a[72:75], v[176:179], v[148:151], a[72:75]
  ds_read_b64_tr_b16 a[244:245], v225 offset:8192
  v_mfma_f32_16x16x32_bf16 a[76:79], v[180:183], v[148:151], a[76:79]
  ds_read_b64_tr_b16 a[246:247], v225 offset:12288
  v_mfma_f32_16x16x32_bf16 a[80:83], v[184:187], v[148:151], a[80:83]
  ds_read_b64_tr_b16 a[248:249], v225 offset:16384
  v_mfma_f32_16x16x32_bf16 a[84:87], v[188:191], v[148:151], a[84:87]
  ds_read_b64_tr_b16 a[250:251], v225 offset:20480
  v_mfma_f32_16x16x32_bf16 a[88:91], v[192:195], v[148:151], a[88:91]
  buffer_load_dwordx4 v[96:99], v234, s[40:43], s55 offen offset:3072 sc1
  v_mfma_f32_16x16x32_bf16 a[92:95], v[196:199], v[148:151], a[92:95]
  ds_read_b64_tr_b16 a[252:253], v225 offset:24576
  v_mfma_f32_16x16x32_bf16 a[96:99], v[168:171], v[152:155], a[96:99]
  ds_read_b64_tr_b16 a[254:255], v225 offset:28672
  v_mfma_f32_16x16x32_bf16 a[100:103], v[172:175], v[152:155], a[100:103]
  v_mfma_f32_16x16x32_bf16 a[104:107], v[176:179], v[152:155], a[104:107]
  s_add_u32 s55, s10, 0x6400
  v_mfma_f32_16x16x32_bf16 a[108:111], v[180:183], v[152:155], a[108:111]
  buffer_load_dwordx4 v[100:103], v234, s[40:43], s55 offen offset:0 sc1
  v_mfma_f32_16x16x32_bf16 a[112:115], v[184:187], v[152:155], a[112:115]
  v_mfma_f32_16x16x32_bf16 a[116:119], v[188:191], v[152:155], a[116:119]
  v_mfma_f32_16x16x32_bf16 a[120:123], v[192:195], v[152:155], a[120:123]
  v_mfma_f32_16x16x32_bf16 a[124:127], v[196:199], v[152:155], a[124:127]
  v_mfma_f32_16x16x32_bf16 a[128:131], v[168:171], v[156:159], a[128:131]
  buffer_load_dwordx4 v[104:107], v234, s[40:43], s55 offen offset:1024 sc1
  v_mfma_f32_16x16x32_bf16 a[132:135], v[172:175], v[156:159], a[132:135]
  v_mfma_f32_16x16x32_bf16 a[136:139], v[176:179], v[156:159], a[136:139]
  v_mfma_f32_16x16x32_bf16 a[140:143], v[180:183], v[156:159], a[140:143]
  v_mfma_f32_16x16x32_bf16 a[144:147], v[184:187], v[156:159], a[144:147]
  v_mfma_f32_16x16x32_bf16 a[148:151], v[188:191], v[156:159], a[148:151]
  buffer_load_dwordx4 v[108:111], v234, s[40:43], s55 offen offset:2048 sc1
  v_mfma_f32_16x16x32_bf16 a[152:155], v[192:195], v[156:159], a[152:155]
  v_mfma_f32_16x16x32_bf16 a[156:159], v[196:199], v[156:159], a[156:159]
  v_mfma_f32_16x16x32_bf16 a[160:163], v[168:171], v[160:163], a[160:163]
  v_mfma_f32_16x16x32_bf16 a[164:167], v[172:175], v[160:163], a[164:167]
  v_mfma_f32_16x16x32_bf16 a[168:171], v[176:179], v[160:163], a[168:171]
  v_mfma_f32_16x16x32_bf16 a[172:175], v[180:183], v[160:163], a[172:175]
  v_mfma_f32_16x16x32_bf16 a[176:179], v[184:187], v[160:163], a[176:179]
  v_mfma_f32_16x16x32_bf16 a[180:183], v[188:191], v[160:163], a[180:183]
  v_mfma_f32_16x16x32_bf16 a[184:187], v[192:195], v[160:163], a[184:187]
  v_mfma_f32_16x16x32_bf16 a[188:191], v[196:199], v[160:163], a[188:191]
  v_mfma_f32_16x16x32_bf16 a[192:195], v[168:171], v[164:167], a[192:195]
  v_mfma_f32_16x16x32_bf16 a[196:199], v[172:175], v[164:167], a[196:199]
  v_mfma_f32_16x16x32_bf16 a[200:203], v[176:179], v[164:167], a[200:203]
  v_mfma_f32_16x16x32_bf16 a[204:207], v[180:183], v[164:167], a[204:207]
  v_mfma_f32_16x16x32_bf16 a[208:211], v[184:187], v[164:167], a[208:211]
  v_mfma_f32_16x16x32_bf16 a[212:215], v[188:191], v[164:167], a[212:215]
  v_mfma_f32_16x16x32_bf16 a[216:219], v[192:195], v[164:167], a[216:219]
  v_mfma_f32_16x16x32_bf16 a[220:223], v[196:199], v[164:167], a[220:223]
  s_waitcnt lgkmcnt(0)
  s_waitcnt vmcnt(21)
  v_mfma_f32_16x16x32_bf16 a[20:23], a[224:227], v[0:3], a[20:23]
  s_lshl_b32 s54, s47, 2
  s_and_b32 s55, s3, 3
  v_mfma_f32_16x16x32_bf16 a[52:55], a[224:227], v[4:7], a[52:55]
  s_add_u32 s54, s54, s55
  s_lshl_b32 s54, s54, 4
  v_mfma_f32_16x16x32_bf16 a[84:87], a[224:227], v[8:11], a[84:87]
  s_add_u32 s54, s54, s44
  s_lshr_b32 s55, s3, 2
  v_mfma_f32_16x16x32_bf16 a[116:119], a[224:227], v[12:15], a[116:119]
  s_add_u32 s66, s55, 0
  s_and_b32 s66, s66, 3
  v_mfma_f32_16x16x32_bf16 a[148:151], a[224:227], v[16:19], a[148:151]
  s_lshl_b32 s66, s66, 2
  s_add_u32 s66, s66, s54
  v_mfma_f32_16x16x32_bf16 a[180:183], a[224:227], v[20:23], a[180:183]
  s_mul_i32 s66, s66, 0x3000
  s_add_u32 s51, s66, 0x1c00000
  v_mfma_f32_16x16x32_bf16 a[212:215], a[224:227], v[24:27], a[212:215]
  s_waitcnt vmcnt(14)
  s_add_u32 s66, s55, 1
  s_and_b32 s66, s66, 3
  s_nop 0
  v_mfma_f32_16x16x32_bf16 a[20:23], a[228:231], v[28:31], a[20:23]
  s_lshl_b32 s66, s66, 2
  s_add_u32 s66, s66, s54
  v_mfma_f32_16x16x32_bf16 a[52:55], a[228:231], v[32:35], a[52:55]
  s_mul_i32 s66, s66, 0x3000
  s_add_u32 s4, s66, 0x1c00000
  v_mfma_f32_16x16x32_bf16 a[84:87], a[228:231], v[36:39], a[84:87]
  s_add_u32 s66, s55, 2
  s_and_b32 s66, s66, 3
  v_mfma_f32_16x16x32_bf16 a[116:119], a[228:231], v[40:43], a[116:119]
  s_lshl_b32 s66, s66, 2
  s_add_u32 s66, s66, s54
  v_mfma_f32_16x16x32_bf16 a[148:151], a[228:231], v[44:47], a[148:151]
  s_mul_i32 s66, s66, 0x3000
  s_add_u32 s5, s66, 0x1c01000
  v_mfma_f32_16x16x32_bf16 a[180:183], a[228:231], v[48:51], a[180:183]
  s_add_u32 s66, s55, 3
  s_and_b32 s66, s66, 3
  v_mfma_f32_16x16x32_bf16 a[212:215], a[228:231], v[52:55], a[212:215]
  s_waitcnt vmcnt(7)
  s_lshl_b32 s66, s66, 2
  s_add_u32 s66, s66, s54
  s_nop 0
  v_mfma_f32_16x16x32_bf16 a[20:23], a[232:235], v[56:59], a[20:23]
  s_mul_i32 s66, s66, 0x3000
  s_add_u32 s6, s66, 0x1c02000
  v_mfma_f32_16x16x32_bf16 a[52:55], a[232:235], v[60:63], a[52:55]
  s_mul_i32 s54, s45, 0x1c00
  s_add_u32 s54, s54, 0x8000
  v_mfma_f32_16x16x32_bf16 a[84:87], a[232:235], v[64:67], a[84:87]
  s_mul_i32 s55, s46, 0x14000
  s_add_u32 s66, s54, s55
  s_nop 0
  v_mfma_f32_16x16x32_bf16 a[116:119], a[232:235], v[68:71], a[116:119]
  v_add_u32_e32 v224, s66, v234
  s_sub_u32 s66, s54, s55
  v_mfma_f32_16x16x32_bf16 a[148:151], a[232:235], v[72:75], a[148:151]
  s_add_u32 s66, s66, 0x14000
  v_add_u32_e64 v226, s66, v234
  v_mfma_f32_16x16x32_bf16 a[180:183], a[232:235], v[76:79], a[180:183]
  v_and_b32_e64 v228, 15, v255
  v_lshlrev_b32_e64 v228, 10, v228
  v_mfma_f32_16x16x32_bf16 a[212:215], a[232:235], v[80:83], a[212:215]
  s_waitcnt vmcnt(0)
  v_lshrrev_b32_e32 v229, 4, v255
  v_lshl_add_u32 v228, v229, 3, v228
  v_mfma_f32_16x16x32_bf16 a[20:23], a[236:239], v[84:87], a[20:23]
  s_mul_i32 s54, s47, 0x38000
  s_mul_i32 s55, s45, 0x1c000
  v_mfma_f32_16x16x32_bf16 a[52:55], a[236:239], v[88:91], a[52:55]
  s_add_u32 s54, s54, s55
  s_and_b32 s55, s3, 3
  v_mfma_f32_16x16x32_bf16 a[84:87], a[236:239], v[92:95], a[84:87]
  s_lshl_b32 s55, s55, 8
  s_add_u32 s54, s54, s55
  v_mfma_f32_16x16x32_bf16 a[116:119], a[236:239], v[96:99], a[116:119]
  s_lshl_b32 s55, s46, 7
  s_add_u32 s54, s54, s55
  v_mfma_f32_16x16x32_bf16 a[148:151], a[236:239], v[100:103], a[148:151]
  s_lshr_b32 s55, s3, 2
  s_lshl_b32 s55, s55, 5
  v_mfma_f32_16x16x32_bf16 a[180:183], a[236:239], v[104:107], a[180:183]
  s_add_u32 s62, s54, s55
  s_lshr_b32 s67, s3, 2
  v_mfma_f32_16x16x32_bf16 a[212:215], a[236:239], v[108:111], a[212:215]
  s_lshl_b32 s67, s67, 2
  s_add_u32 s67, s67, s91
  v_mfma_f32_16x16x32_bf16 a[4:7], a[240:243], v[0:3], a[4:7]
  v_mfma_f32_16x16x32_bf16 a[36:39], a[240:243], v[4:7], a[36:39]
  v_mfma_f32_16x16x32_bf16 a[68:71], a[240:243], v[8:11], a[68:71]
  ds_read_b64_tr_b16 v[168:169], v247 offset:1536
  v_mfma_f32_16x16x32_bf16 a[100:103], a[240:243], v[12:15], a[100:103]
  ds_read_b64_tr_b16 v[170:171], v247 offset:5632
  v_mfma_f32_16x16x32_bf16 a[132:135], a[240:243], v[16:19], a[132:135]
  ds_read_b64_tr_b16 v[172:173], v247 offset:9728
  v_mfma_f32_16x16x32_bf16 a[164:167], a[240:243], v[20:23], a[164:167]
  ds_read_b64_tr_b16 v[174:175], v247 offset:13824
  v_mfma_f32_16x16x32_bf16 a[196:199], a[240:243], v[24:27], a[196:199]
  ds_read_b64_tr_b16 v[176:177], v247 offset:17920
  v_mfma_f32_16x16x32_bf16 a[4:7], a[244:247], v[28:31], a[4:7]
  ds_read_b64_tr_b16 v[178:179], v247 offset:22016
  v_mfma_f32_16x16x32_bf16 a[36:39], a[244:247], v[32:35], a[36:39]
  ds_read_b64_tr_b16 v[180:181], v247 offset:26112
  v_mfma_f32_16x16x32_bf16 a[68:71], a[244:247], v[36:39], a[68:71]
  ds_read_b64_tr_b16 v[182:183], v247 offset:30208
  v_mfma_f32_16x16x32_bf16 a[100:103], a[244:247], v[40:43], a[100:103]
  ds_read_b64_tr_b16 v[184:185], v247 offset:512
  v_mfma_f32_16x16x32_bf16 a[132:135], a[244:247], v[44:47], a[132:135]
  ds_read_b64_tr_b16 v[186:187], v247 offset:4608
  v_mfma_f32_16x16x32_bf16 a[164:167], a[244:247], v[48:51], a[164:167]
  ds_read_b64_tr_b16 v[188:189], v247 offset:8704
  v_mfma_f32_16x16x32_bf16 a[196:199], a[244:247], v[52:55], a[196:199]
  ds_read_b64_tr_b16 v[190:191], v247 offset:12800
  v_mfma_f32_16x16x32_bf16 a[4:7], a[248:251], v[56:59], a[4:7]
  ds_read_b64_tr_b16 v[192:193], v247 offset:16896
  v_mfma_f32_16x16x32_bf16 a[36:39], a[248:251], v[60:63], a[36:39]
  ds_read_b64_tr_b16 v[194:195], v247 offset:20992
  v_mfma_f32_16x16x32_bf16 a[68:71], a[248:251], v[64:67], a[68:71]
  ds_read_b64_tr_b16 v[196:197], v247 offset:25088
  v_mfma_f32_16x16x32_bf16 a[100:103], a[248:251], v[68:71], a[100:103]
  ds_read_b64_tr_b16 v[198:199], v247 offset:29184
  v_mfma_f32_16x16x32_bf16 a[132:135], a[248:251], v[72:75], a[132:135]
  v_mfma_f32_16x16x32_bf16 a[164:167], a[248:251], v[76:79], a[164:167]
  v_mfma_f32_16x16x32_bf16 a[196:199], a[248:251], v[80:83], a[196:199]
  ds_write_b128 v224, a[20:23] offset:0
  v_mfma_f32_16x16x32_bf16 a[4:7], a[252:255], v[84:87], a[4:7]
  ds_write_b128 v224, a[52:55] offset:1024
  v_mfma_f32_16x16x32_bf16 a[36:39], a[252:255], v[88:91], a[36:39]
  ds_write_b128 v224, a[84:87] offset:2048
  v_mfma_f32_16x16x32_bf16 a[68:71], a[252:255], v[92:95], a[68:71]
  ds_write_b128 v224, a[116:119] offset:3072
  v_mfma_f32_16x16x32_bf16 a[100:103], a[252:255], v[96:99], a[100:103]
  ds_write_b128 v224, a[148:151] offset:4096
  v_mfma_f32_16x16x32_bf16 a[132:135], a[252:255], v[100:103], a[132:135]
  ds_write_b128 v224, a[180:183] offset:5120
  v_mfma_f32_16x16x32_bf16 a[164:167], a[252:255], v[104:107], a[164:167]
  ds_write_b128 v224, a[212:215] offset:6144
  v_mfma_f32_16x16x32_bf16 a[196:199], a[252:255], v[108:111], a[196:199]
  s_waitcnt lgkmcnt(0)
  s_barrier
  v_mfma_f32_16x16x32_bf16 a[24:27], v[168:171], v[0:3], a[24:27]
  ds_read_b128 v[112:115], v226 offset:0
  ds_read_b128 v[116:119], v226 offset:1024
  v_mfma_f32_16x16x32_bf16 a[56:59], v[168:171], v[4:7], a[56:59]
  ds_read_b128 v[120:123], v226 offset:2048
  ds_read_b128 v[124:127], v226 offset:3072
  v_mfma_f32_16x16x32_bf16 a[88:91], v[168:171], v[8:11], a[88:91]
  ds_read_b128 v[128:131], v226 offset:4096
  ds_read_b128 v[132:135], v226 offset:5120
  v_mfma_f32_16x16x32_bf16 a[120:123], v[168:171], v[12:15], a[120:123]
  ds_read_b128 v[136:139], v226 offset:6144
  v_accvgpr_read_b32 v140, a4
  v_mfma_f32_16x16x32_bf16 a[152:155], v[168:171], v[16:19], a[152:155]
  v_accvgpr_read_b32 v141, a5
  v_accvgpr_read_b32 v142, a6
  v_mfma_f32_16x16x32_bf16 a[184:187], v[168:171], v[20:23], a[184:187]
  v_accvgpr_read_b32 v143, a7
  v_accvgpr_read_b32 v144, a36
  v_mfma_f32_16x16x32_bf16 a[216:219], v[168:171], v[24:27], a[216:219]
  v_accvgpr_read_b32 v145, a37
  v_accvgpr_read_b32 v146, a38
  v_mfma_f32_16x16x32_bf16 a[24:27], v[172:175], v[28:31], a[24:27]
  v_accvgpr_read_b32 v147, a39
  v_accvgpr_read_b32 v148, a68
  v_mfma_f32_16x16x32_bf16 a[56:59], v[172:175], v[32:35], a[56:59]
  v_accvgpr_read_b32 v149, a69
  v_accvgpr_read_b32 v150, a70
  v_mfma_f32_16x16x32_bf16 a[88:91], v[172:175], v[36:39], a[88:91]
  v_accvgpr_read_b32 v151, a71
  v_accvgpr_read_b32 v152, a100
  v_mfma_f32_16x16x32_bf16 a[120:123], v[172:175], v[40:43], a[120:123]
  v_accvgpr_read_b32 v153, a101
  v_accvgpr_read_b32 v154, a102
  v_mfma_f32_16x16x32_bf16 a[152:155], v[172:175], v[44:47], a[152:155]
  v_accvgpr_read_b32 v155, a103
  v_accvgpr_read_b32 v156, a132
  v_mfma_f32_16x16x32_bf16 a[184:187], v[172:175], v[48:51], a[184:187]
  v_accvgpr_read_b32 v157, a133
  v_accvgpr_read_b32 v158, a134
  v_mfma_f32_16x16x32_bf16 a[216:219], v[172:175], v[52:55], a[216:219]
  v_accvgpr_read_b32 v159, a135
  v_accvgpr_read_b32 v160, a164
  v_mfma_f32_16x16x32_bf16 a[24:27], v[176:179], v[56:59], a[24:27]
  v_accvgpr_read_b32 v161, a165
  v_accvgpr_read_b32 v162, a166
  v_mfma_f32_16x16x32_bf16 a[56:59], v[176:179], v[60:63], a[56:59]
  v_accvgpr_read_b32 v163, a167
  v_accvgpr_read_b32 v164, a196
  v_mfma_f32_16x16x32_bf16 a[88:91], v[176:179], v[64:67], a[88:91]
  v_accvgpr_read_b32 v165, a197
  v_accvgpr_read_b32 v166, a198
  v_mfma_f32_16x16x32_bf16 a[120:123], v[176:179], v[68:71], a[120:123]
  v_accvgpr_read_b32 v167, a199
  ds_read_b64_tr_b16 a[224:225], v225 offset:1536
  v_mfma_f32_16x16x32_bf16 a[152:155], v[176:179], v[72:75], a[152:155]
  ds_read_b64_tr_b16 a[226:227], v225 offset:5632
  ds_read_b64_tr_b16 a[228:229], v225 offset:9728
  v_mfma_f32_16x16x32_bf16 a[184:187], v[176:179], v[76:79], a[184:187]
  ds_read_b64_tr_b16 a[230:231], v225 offset:13824
  ds_read_b64_tr_b16 a[232:233], v225 offset:17920
  v_mfma_f32_16x16x32_bf16 a[216:219], v[176:179], v[80:83], a[216:219]
  ds_read_b64_tr_b16 a[234:235], v225 offset:22016
  ds_read_b64_tr_b16 a[236:237], v225 offset:26112
  v_mfma_f32_16x16x32_bf16 a[24:27], v[180:183], v[84:87], a[24:27]
  ds_read_b64_tr_b16 a[238:239], v225 offset:30208
  ds_read_b64_tr_b16 a[240:241], v225 offset:512
  v_mfma_f32_16x16x32_bf16 a[56:59], v[180:183], v[88:91], a[56:59]
  ds_read_b64_tr_b16 a[242:243], v225 offset:4608
  ds_read_b64_tr_b16 a[244:245], v225 offset:8704
  v_mfma_f32_16x16x32_bf16 a[88:91], v[180:183], v[92:95], a[88:91]
  ds_read_b64_tr_b16 a[246:247], v225 offset:12800
  ds_read_b64_tr_b16 a[248:249], v225 offset:16896
  v_mfma_f32_16x16x32_bf16 a[120:123], v[180:183], v[96:99], a[120:123]
  ds_read_b64_tr_b16 a[250:251], v225 offset:20992
  ds_read_b64_tr_b16 a[252:253], v225 offset:25088
  v_mfma_f32_16x16x32_bf16 a[152:155], v[180:183], v[100:103], a[152:155]
  ds_read_b64_tr_b16 a[254:255], v225 offset:29184
  s_waitcnt lgkmcnt(0)
  s_nop 0
  v_pk_add_f32 v[112:113], v[112:113], v[140:141]
  v_mfma_f32_16x16x32_bf16 a[184:187], v[180:183], v[104:107], a[184:187]
  v_pk_add_f32 v[114:115], v[114:115], v[142:143]
  v_cvt_pk_bf16_f32 v140, v112, v113
  v_mfma_f32_16x16x32_bf16 a[216:219], v[180:183], v[108:111], a[216:219]
  v_cvt_pk_bf16_f32 v141, v114, v115
  v_pk_add_f32 v[116:117], v[116:117], v[144:145]
  v_mfma_f32_16x16x32_bf16 a[8:11], v[184:187], v[0:3], a[8:11]
  v_pk_add_f32 v[118:119], v[118:119], v[146:147]
  v_cvt_pk_bf16_f32 v142, v116, v117
  v_mfma_f32_16x16x32_bf16 a[40:43], v[184:187], v[4:7], a[40:43]
  v_cvt_pk_bf16_f32 v143, v118, v119
  v_mfma_f32_16x16x32_bf16 a[72:75], v[184:187], v[8:11], a[72:75]
  buffer_store_dwordx4 v[140:143], v234, s[40:43], s4 offen offset:0 sc1
  v_mfma_f32_16x16x32_bf16 a[104:107], v[184:187], v[12:15], a[104:107]
  v_pk_add_f32 v[120:121], v[120:121], v[148:149]
  v_pk_add_f32 v[122:123], v[122:123], v[150:151]
  v_mfma_f32_16x16x32_bf16 a[136:139], v[184:187], v[16:19], a[136:139]
  v_cvt_pk_bf16_f32 v144, v120, v121
  v_cvt_pk_bf16_f32 v145, v122, v123
  v_mfma_f32_16x16x32_bf16 a[168:171], v[184:187], v[20:23], a[168:171]
  v_pk_add_f32 v[124:125], v[124:125], v[152:153]
  v_pk_add_f32 v[126:127], v[126:127], v[154:155]
  v_mfma_f32_16x16x32_bf16 a[200:203], v[184:187], v[24:27], a[200:203]
  v_cvt_pk_bf16_f32 v146, v124, v125
  v_cvt_pk_bf16_f32 v147, v126, v127
  v_mfma_f32_16x16x32_bf16 a[8:11], v[188:191], v[28:31], a[8:11]
  buffer_store_dwordx4 v[144:147], v234, s[40:43], s4 offen offset:1024 sc1
  v_mfma_f32_16x16x32_bf16 a[40:43], v[188:191], v[32:35], a[40:43]
  v_pk_add_f32 v[128:129], v[128:129], v[156:157]
  v_pk_add_f32 v[130:131], v[130:131], v[158:159]
  v_mfma_f32_16x16x32_bf16 a[72:75], v[188:191], v[36:39], a[72:75]
  v_cvt_pk_bf16_f32 v148, v128, v129
  v_cvt_pk_bf16_f32 v149, v130, v131
  v_mfma_f32_16x16x32_bf16 a[104:107], v[188:191], v[40:43], a[104:107]
  v_pk_add_f32 v[132:133], v[132:133], v[160:161]
  v_pk_add_f32 v[134:135], v[134:135], v[162:163]
  v_mfma_f32_16x16x32_bf16 a[136:139], v[188:191], v[44:47], a[136:139]
  v_cvt_pk_bf16_f32 v150, v132, v133
  v_cvt_pk_bf16_f32 v151, v134, v135
  v_mfma_f32_16x16x32_bf16 a[168:171], v[188:191], v[48:51], a[168:171]
  buffer_store_dwordx4 v[148:151], v234, s[40:43], s4 offen offset:2048 sc1
  v_mfma_f32_16x16x32_bf16 a[200:203], v[188:191], v[52:55], a[200:203]
  v_pk_add_f32 v[136:137], v[136:137], v[164:165]
  v_pk_add_f32 v[138:139], v[138:139], v[166:167]
  v_mfma_f32_16x16x32_bf16 a[8:11], v[192:195], v[56:59], a[8:11]
  v_cvt_pk_bf16_f32 v152, v136, v137
  v_cvt_pk_bf16_f32 v153, v138, v139
  v_mfma_f32_16x16x32_bf16 a[40:43], v[192:195], v[60:63], a[40:43]
  buffer_store_dwordx4 v[152:155], v234, s[40:43], s4 offen offset:3072 sc1
  v_mfma_f32_16x16x32_bf16 a[72:75], v[192:195], v[64:67], a[72:75]
  v_mfma_f32_16x16x32_bf16 a[104:107], v[192:195], v[68:71], a[104:107]
  v_mfma_f32_16x16x32_bf16 a[136:139], v[192:195], v[72:75], a[136:139]
  v_mfma_f32_16x16x32_bf16 a[168:171], v[192:195], v[76:79], a[168:171]
  v_mfma_f32_16x16x32_bf16 a[200:203], v[192:195], v[80:83], a[200:203]
  ds_write_b128 v224, a[24:27] offset:14336
  v_mfma_f32_16x16x32_bf16 a[8:11], v[196:199], v[84:87], a[8:11]
  ds_write_b128 v224, a[56:59] offset:15360
  v_mfma_f32_16x16x32_bf16 a[40:43], v[196:199], v[88:91], a[40:43]
  ds_write_b128 v224, a[88:91] offset:16384
  v_mfma_f32_16x16x32_bf16 a[72:75], v[196:199], v[92:95], a[72:75]
  ds_write_b128 v224, a[120:123] offset:17408
  v_mfma_f32_16x16x32_bf16 a[104:107], v[196:199], v[96:99], a[104:107]
  ds_write_b128 v224, a[152:155] offset:18432
  v_mfma_f32_16x16x32_bf16 a[136:139], v[196:199], v[100:103], a[136:139]
  ds_write_b128 v224, a[184:187] offset:19456
  v_mfma_f32_16x16x32_bf16 a[168:171], v[196:199], v[104:107], a[168:171]
  ds_write_b128 v224, a[216:219] offset:20480
  v_mfma_f32_16x16x32_bf16 a[200:203], v[196:199], v[108:111], a[200:203]
  s_waitcnt lgkmcnt(0)
  s_barrier
  v_mfma_f32_16x16x32_bf16 a[28:31], a[224:227], v[0:3], a[28:31]
  ds_read_b128 v[112:115], v226 offset:14336
  ds_read_b128 v[116:119], v226 offset:15360
  v_mfma_f32_16x16x32_bf16 a[60:63], a[224:227], v[4:7], a[60:63]
  ds_read_b128 v[120:123], v226 offset:16384
  ds_read_b128 v[124:127], v226 offset:17408
  v_mfma_f32_16x16x32_bf16 a[92:95], a[224:227], v[8:11], a[92:95]
  ds_read_b128 v[128:131], v226 offset:18432
  ds_read_b128 v[132:135], v226 offset:19456
  v_mfma_f32_16x16x32_bf16 a[124:127], a[224:227], v[12:15], a[124:127]
  ds_read_b128 v[136:139], v226 offset:20480
  v_accvgpr_read_b32 v140, a8
  v_mfma_f32_16x16x32_bf16 a[156:159], a[224:227], v[16:19], a[156:159]
  v_accvgpr_read_b32 v141, a9
  v_accvgpr_read_b32 v142, a10
  v_mfma_f32_16x16x32_bf16 a[188:191], a[224:227], v[20:23], a[188:191]
  v_accvgpr_read_b32 v143, a11
  v_accvgpr_read_b32 v144, a40
  v_mfma_f32_16x16x32_bf16 a[220:223], a[224:227], v[24:27], a[220:223]
  v_accvgpr_read_b32 v145, a41
  v_accvgpr_read_b32 v146, a42
  v_mfma_f32_16x16x32_bf16 a[28:31], a[228:231], v[28:31], a[28:31]
  v_accvgpr_read_b32 v147, a43
  v_accvgpr_read_b32 v148, a72
  v_mfma_f32_16x16x32_bf16 a[60:63], a[228:231], v[32:35], a[60:63]
  v_accvgpr_read_b32 v149, a73
  v_accvgpr_read_b32 v150, a74
  v_mfma_f32_16x16x32_bf16 a[92:95], a[228:231], v[36:39], a[92:95]
  v_accvgpr_read_b32 v151, a75
  v_accvgpr_read_b32 v152, a104
  v_mfma_f32_16x16x32_bf16 a[124:127], a[228:231], v[40:43], a[124:127]
  v_accvgpr_read_b32 v153, a105
  v_accvgpr_read_b32 v154, a106
  v_mfma_f32_16x16x32_bf16 a[156:159], a[228:231], v[44:47], a[156:159]
  v_accvgpr_read_b32 v155, a107
  v_accvgpr_read_b32 v156, a136
  v_mfma_f32_16x16x32_bf16 a[188:191], a[228:231], v[48:51], a[188:191]
  v_accvgpr_read_b32 v157, a137
  v_accvgpr_read_b32 v158, a138
  v_mfma_f32_16x16x32_bf16 a[220:223], a[228:231], v[52:55], a[220:223]
  v_accvgpr_read_b32 v159, a139
  v_accvgpr_read_b32 v160, a168
  v_mfma_f32_16x16x32_bf16 a[28:31], a[232:235], v[56:59], a[28:31]
  v_accvgpr_read_b32 v161, a169
  v_accvgpr_read_b32 v162, a170
  v_mfma_f32_16x16x32_bf16 a[60:63], a[232:235], v[60:63], a[60:63]
  v_accvgpr_read_b32 v163, a171
  v_accvgpr_read_b32 v164, a200
  v_mfma_f32_16x16x32_bf16 a[92:95], a[232:235], v[64:67], a[92:95]
  v_accvgpr_read_b32 v165, a201
  v_accvgpr_read_b32 v166, a202
  v_mfma_f32_16x16x32_bf16 a[124:127], a[232:235], v[68:71], a[124:127]
  v_accvgpr_read_b32 v167, a203
  ds_read_b64_tr_b16 v[168:169], v247 offset:1024
  v_mfma_f32_16x16x32_bf16 a[156:159], a[232:235], v[72:75], a[156:159]
  ds_read_b64_tr_b16 v[170:171], v247 offset:5120
  ds_read_b64_tr_b16 v[172:173], v247 offset:9216
  v_mfma_f32_16x16x32_bf16 a[188:191], a[232:235], v[76:79], a[188:191]
  ds_read_b64_tr_b16 v[174:175], v247 offset:13312
  ds_read_b64_tr_b16 v[176:177], v247 offset:17408
  v_mfma_f32_16x16x32_bf16 a[220:223], a[232:235], v[80:83], a[220:223]
  ds_read_b64_tr_b16 v[178:179], v247 offset:21504
  ds_read_b64_tr_b16 v[180:181], v247 offset:25600
  v_mfma_f32_16x16x32_bf16 a[28:31], a[236:239], v[84:87], a[28:31]
  ds_read_b64_tr_b16 v[182:183], v247 offset:29696
  ds_read_b64_tr_b16 v[184:185], v247 offset:0
  v_mfma_f32_16x16x32_bf16 a[60:63], a[236:239], v[88:91], a[60:63]
  ds_read_b64_tr_b16 v[186:187], v247 offset:4096
  ds_read_b64_tr_b16 v[188:189], v247 offset:8192
  v_mfma_f32_16x16x32_bf16 a[92:95], a[236:239], v[92:95], a[92:95]
  ds_read_b64_tr_b16 v[190:191], v247 offset:12288
  ds_read_b64_tr_b16 v[192:193], v247 offset:16384
  v_mfma_f32_16x16x32_bf16 a[124:127], a[236:239], v[96:99], a[124:127]
  ds_read_b64_tr_b16 v[194:195], v247 offset:20480
  ds_read_b64_tr_b16 v[196:197], v247 offset:24576
  v_mfma_f32_16x16x32_bf16 a[156:159], a[236:239], v[100:103], a[156:159]
  ds_read_b64_tr_b16 v[198:199], v247 offset:28672
  s_waitcnt lgkmcnt(0)
  s_nop 0
  v_pk_add_f32 v[112:113], v[112:113], v[140:141]
  v_mfma_f32_16x16x32_bf16 a[188:191], a[236:239], v[104:107], a[188:191]
  v_pk_add_f32 v[114:115], v[114:115], v[142:143]
  v_cvt_pk_bf16_f32 v140, v112, v113
  v_mfma_f32_16x16x32_bf16 a[220:223], a[236:239], v[108:111], a[220:223]
  v_cvt_pk_bf16_f32 v141, v114, v115
  v_pk_add_f32 v[116:117], v[116:117], v[144:145]
  v_mfma_f32_16x16x32_bf16 a[12:15], a[240:243], v[0:3], a[12:15]
  v_pk_add_f32 v[118:119], v[118:119], v[146:147]
  v_cvt_pk_bf16_f32 v142, v116, v117
  v_mfma_f32_16x16x32_bf16 a[44:47], a[240:243], v[4:7], a[44:47]
  v_cvt_pk_bf16_f32 v143, v118, v119
  v_mfma_f32_16x16x32_bf16 a[76:79], a[240:243], v[8:11], a[76:79]
  buffer_store_dwordx4 v[140:143], v234, s[40:43], s5 offen offset:0 sc1
  v_mfma_f32_16x16x32_bf16 a[108:111], a[240:243], v[12:15], a[108:111]
  v_pk_add_f32 v[120:121], v[120:121], v[148:149]
  v_pk_add_f32 v[122:123], v[122:123], v[150:151]
  v_mfma_f32_16x16x32_bf16 a[140:143], a[240:243], v[16:19], a[140:143]
  v_cvt_pk_bf16_f32 v144, v120, v121
  v_cvt_pk_bf16_f32 v145, v122, v123
  v_mfma_f32_16x16x32_bf16 a[172:175], a[240:243], v[20:23], a[172:175]
  v_pk_add_f32 v[124:125], v[124:125], v[152:153]
  v_pk_add_f32 v[126:127], v[126:127], v[154:155]
  v_mfma_f32_16x16x32_bf16 a[204:207], a[240:243], v[24:27], a[204:207]
  v_cvt_pk_bf16_f32 v146, v124, v125
  v_cvt_pk_bf16_f32 v147, v126, v127
  v_mfma_f32_16x16x32_bf16 a[12:15], a[244:247], v[28:31], a[12:15]
  buffer_store_dwordx4 v[144:147], v234, s[40:43], s5 offen offset:1024 sc1
  v_mfma_f32_16x16x32_bf16 a[44:47], a[244:247], v[32:35], a[44:47]
  v_pk_add_f32 v[128:129], v[128:129], v[156:157]
  v_pk_add_f32 v[130:131], v[130:131], v[158:159]
  v_mfma_f32_16x16x32_bf16 a[76:79], a[244:247], v[36:39], a[76:79]
  v_cvt_pk_bf16_f32 v148, v128, v129
  v_cvt_pk_bf16_f32 v149, v130, v131
  v_mfma_f32_16x16x32_bf16 a[108:111], a[244:247], v[40:43], a[108:111]
  v_pk_add_f32 v[132:133], v[132:133], v[160:161]
  v_pk_add_f32 v[134:135], v[134:135], v[162:163]
  v_mfma_f32_16x16x32_bf16 a[140:143], a[244:247], v[44:47], a[140:143]
  v_cvt_pk_bf16_f32 v150, v132, v133
  v_cvt_pk_bf16_f32 v151, v134, v135
  v_mfma_f32_16x16x32_bf16 a[172:175], a[244:247], v[48:51], a[172:175]
  buffer_store_dwordx4 v[148:151], v234, s[40:43], s5 offen offset:2048 sc1
  v_mfma_f32_16x16x32_bf16 a[204:207], a[244:247], v[52:55], a[204:207]
  v_pk_add_f32 v[136:137], v[136:137], v[164:165]
  v_pk_add_f32 v[138:139], v[138:139], v[166:167]
  v_mfma_f32_16x16x32_bf16 a[12:15], a[248:251], v[56:59], a[12:15]
  v_cvt_pk_bf16_f32 v152, v136, v137
  v_cvt_pk_bf16_f32 v153, v138, v139
  v_mfma_f32_16x16x32_bf16 a[44:47], a[248:251], v[60:63], a[44:47]
  buffer_store_dwordx4 v[152:155], v234, s[40:43], s5 offen offset:3072 sc1
  v_mfma_f32_16x16x32_bf16 a[76:79], a[248:251], v[64:67], a[76:79]
  v_mfma_f32_16x16x32_bf16 a[108:111], a[248:251], v[68:71], a[108:111]
  v_mfma_f32_16x16x32_bf16 a[140:143], a[248:251], v[72:75], a[140:143]
  v_mfma_f32_16x16x32_bf16 a[172:175], a[248:251], v[76:79], a[172:175]
  v_mfma_f32_16x16x32_bf16 a[204:207], a[248:251], v[80:83], a[204:207]
  ds_write_b128 v224, a[28:31] offset:0
  v_mfma_f32_16x16x32_bf16 a[12:15], a[252:255], v[84:87], a[12:15]
  ds_write_b128 v224, a[60:63] offset:1024
  v_mfma_f32_16x16x32_bf16 a[44:47], a[252:255], v[88:91], a[44:47]
  ds_write_b128 v224, a[92:95] offset:2048
  v_mfma_f32_16x16x32_bf16 a[76:79], a[252:255], v[92:95], a[76:79]
  ds_write_b128 v224, a[124:127] offset:3072
  v_mfma_f32_16x16x32_bf16 a[108:111], a[252:255], v[96:99], a[108:111]
  ds_write_b128 v224, a[156:159] offset:4096
  v_mfma_f32_16x16x32_bf16 a[140:143], a[252:255], v[100:103], a[140:143]
  ds_write_b128 v224, a[188:191] offset:5120
  v_mfma_f32_16x16x32_bf16 a[172:175], a[252:255], v[104:107], a[172:175]
  ds_write_b128 v224, a[220:223] offset:6144
  v_mfma_f32_16x16x32_bf16 a[204:207], a[252:255], v[108:111], a[204:207]
  s_waitcnt lgkmcnt(0)
  s_barrier
  v_mfma_f32_16x16x32_bf16 a[16:19], v[168:171], v[0:3], a[16:19]
  ds_read_b128 v[112:115], v226 offset:0
  ds_read_b128 v[116:119], v226 offset:1024
  v_mfma_f32_16x16x32_bf16 a[48:51], v[168:171], v[4:7], a[48:51]
  ds_read_b128 v[120:123], v226 offset:2048
  ds_read_b128 v[124:127], v226 offset:3072
  v_mfma_f32_16x16x32_bf16 a[80:83], v[168:171], v[8:11], a[80:83]
  ds_read_b128 v[128:131], v226 offset:4096
  ds_read_b128 v[132:135], v226 offset:5120
  v_mfma_f32_16x16x32_bf16 a[112:115], v[168:171], v[12:15], a[112:115]
  ds_read_b128 v[136:139], v226 offset:6144
  v_accvgpr_read_b32 v140, a12
  v_mfma_f32_16x16x32_bf16 a[144:147], v[168:171], v[16:19], a[144:147]
  v_accvgpr_read_b32 v141, a13
  v_accvgpr_read_b32 v142, a14
  v_mfma_f32_16x16x32_bf16 a[176:179], v[168:171], v[20:23], a[176:179]
  v_accvgpr_read_b32 v143, a15
  v_accvgpr_read_b32 v144, a44
  v_mfma_f32_16x16x32_bf16 a[208:211], v[168:171], v[24:27], a[208:211]
  v_accvgpr_read_b32 v145, a45
  v_accvgpr_read_b32 v146, a46
  v_mfma_f32_16x16x32_bf16 a[16:19], v[172:175], v[28:31], a[16:19]
  v_accvgpr_read_b32 v147, a47
  v_accvgpr_read_b32 v148, a76
  v_mfma_f32_16x16x32_bf16 a[48:51], v[172:175], v[32:35], a[48:51]
  v_accvgpr_read_b32 v149, a77
  v_accvgpr_read_b32 v150, a78
  v_mfma_f32_16x16x32_bf16 a[80:83], v[172:175], v[36:39], a[80:83]
  v_accvgpr_read_b32 v151, a79
  v_accvgpr_read_b32 v152, a108
  v_mfma_f32_16x16x32_bf16 a[112:115], v[172:175], v[40:43], a[112:115]
  v_accvgpr_read_b32 v153, a109
  v_accvgpr_read_b32 v154, a110
  v_mfma_f32_16x16x32_bf16 a[144:147], v[172:175], v[44:47], a[144:147]
  v_accvgpr_read_b32 v155, a111
  v_accvgpr_read_b32 v156, a140
  v_mfma_f32_16x16x32_bf16 a[176:179], v[172:175], v[48:51], a[176:179]
  v_accvgpr_read_b32 v157, a141
  v_accvgpr_read_b32 v158, a142
  v_mfma_f32_16x16x32_bf16 a[208:211], v[172:175], v[52:55], a[208:211]
  v_accvgpr_read_b32 v159, a143
  v_accvgpr_read_b32 v160, a172
  v_mfma_f32_16x16x32_bf16 a[16:19], v[176:179], v[56:59], a[16:19]
  v_accvgpr_read_b32 v161, a173
  v_accvgpr_read_b32 v162, a174
  v_mfma_f32_16x16x32_bf16 a[48:51], v[176:179], v[60:63], a[48:51]
  v_accvgpr_read_b32 v163, a175
  v_accvgpr_read_b32 v164, a204
  v_mfma_f32_16x16x32_bf16 a[80:83], v[176:179], v[64:67], a[80:83]
  v_accvgpr_read_b32 v165, a205
  v_accvgpr_read_b32 v166, a206
  v_mfma_f32_16x16x32_bf16 a[112:115], v[176:179], v[68:71], a[112:115]
  v_accvgpr_read_b32 v167, a207
  s_waitcnt lgkmcnt(0)
  s_nop 0
  v_pk_add_f32 v[112:113], v[112:113], v[140:141]
  v_mfma_f32_16x16x32_bf16 a[144:147], v[176:179], v[72:75], a[144:147]
  v_pk_add_f32 v[114:115], v[114:115], v[142:143]
  v_cvt_pk_bf16_f32 v140, v112, v113
  v_mfma_f32_16x16x32_bf16 a[176:179], v[176:179], v[76:79], a[176:179]
  v_cvt_pk_bf16_f32 v141, v114, v115
  v_pk_add_f32 v[116:117], v[116:117], v[144:145]
  v_mfma_f32_16x16x32_bf16 a[208:211], v[176:179], v[80:83], a[208:211]
  v_pk_add_f32 v[118:119], v[118:119], v[146:147]
  v_cvt_pk_bf16_f32 v142, v116, v117
  v_mfma_f32_16x16x32_bf16 a[16:19], v[180:183], v[84:87], a[16:19]
  v_cvt_pk_bf16_f32 v143, v118, v119
  v_mfma_f32_16x16x32_bf16 a[48:51], v[180:183], v[88:91], a[48:51]
  buffer_store_dwordx4 v[140:143], v234, s[40:43], s6 offen offset:0 sc1
  v_mfma_f32_16x16x32_bf16 a[80:83], v[180:183], v[92:95], a[80:83]
  v_pk_add_f32 v[120:121], v[120:121], v[148:149]
  v_pk_add_f32 v[122:123], v[122:123], v[150:151]
  v_mfma_f32_16x16x32_bf16 a[112:115], v[180:183], v[96:99], a[112:115]
  v_cvt_pk_bf16_f32 v144, v120, v121
  v_cvt_pk_bf16_f32 v145, v122, v123
  v_mfma_f32_16x16x32_bf16 a[144:147], v[180:183], v[100:103], a[144:147]
  v_pk_add_f32 v[124:125], v[124:125], v[152:153]
  v_pk_add_f32 v[126:127], v[126:127], v[154:155]
  v_mfma_f32_16x16x32_bf16 a[176:179], v[180:183], v[104:107], a[176:179]
  v_cvt_pk_bf16_f32 v146, v124, v125
  v_cvt_pk_bf16_f32 v147, v126, v127
  v_mfma_f32_16x16x32_bf16 a[208:211], v[180:183], v[108:111], a[208:211]
  buffer_store_dwordx4 v[144:147], v234, s[40:43], s6 offen offset:1024 sc1
  v_mfma_f32_16x16x32_bf16 a[0:3], v[184:187], v[0:3], a[0:3]
  v_pk_add_f32 v[128:129], v[128:129], v[156:157]
  v_pk_add_f32 v[130:131], v[130:131], v[158:159]
  v_mfma_f32_16x16x32_bf16 a[32:35], v[184:187], v[4:7], a[32:35]
  v_cvt_pk_bf16_f32 v148, v128, v129
  v_cvt_pk_bf16_f32 v149, v130, v131
  v_mfma_f32_16x16x32_bf16 a[64:67], v[184:187], v[8:11], a[64:67]
  v_pk_add_f32 v[132:133], v[132:133], v[160:161]
  v_pk_add_f32 v[134:135], v[134:135], v[162:163]
  v_mfma_f32_16x16x32_bf16 a[96:99], v[184:187], v[12:15], a[96:99]
  v_cvt_pk_bf16_f32 v150, v132, v133
  v_cvt_pk_bf16_f32 v151, v134, v135
  v_mfma_f32_16x16x32_bf16 a[128:131], v[184:187], v[16:19], a[128:131]
  buffer_store_dwordx4 v[148:151], v234, s[40:43], s6 offen offset:2048 sc1
  v_mfma_f32_16x16x32_bf16 a[160:163], v[184:187], v[20:23], a[160:163]
  v_pk_add_f32 v[136:137], v[136:137], v[164:165]
  v_pk_add_f32 v[138:139], v[138:139], v[166:167]
  v_mfma_f32_16x16x32_bf16 a[192:195], v[184:187], v[24:27], a[192:195]
  v_cvt_pk_bf16_f32 v152, v136, v137
  v_cvt_pk_bf16_f32 v153, v138, v139
  v_mfma_f32_16x16x32_bf16 a[0:3], v[188:191], v[28:31], a[0:3]
  buffer_store_dwordx4 v[152:155], v234, s[40:43], s6 offen offset:3072 sc1
  v_mfma_f32_16x16x32_bf16 a[32:35], v[188:191], v[32:35], a[32:35]
  v_mfma_f32_16x16x32_bf16 a[64:67], v[188:191], v[36:39], a[64:67]
  v_mfma_f32_16x16x32_bf16 a[96:99], v[188:191], v[40:43], a[96:99]
  v_mfma_f32_16x16x32_bf16 a[128:131], v[188:191], v[44:47], a[128:131]
  v_mfma_f32_16x16x32_bf16 a[160:163], v[188:191], v[48:51], a[160:163]
  v_mfma_f32_16x16x32_bf16 a[192:195], v[188:191], v[52:55], a[192:195]
  v_mfma_f32_16x16x32_bf16 a[0:3], v[192:195], v[56:59], a[0:3]
  v_mfma_f32_16x16x32_bf16 a[32:35], v[192:195], v[60:63], a[32:35]
  v_mfma_f32_16x16x32_bf16 a[64:67], v[192:195], v[64:67], a[64:67]
  v_mfma_f32_16x16x32_bf16 a[96:99], v[192:195], v[68:71], a[96:99]
  v_mfma_f32_16x16x32_bf16 a[128:131], v[192:195], v[72:75], a[128:131]
  v_mfma_f32_16x16x32_bf16 a[160:163], v[192:195], v[76:79], a[160:163]
  v_mfma_f32_16x16x32_bf16 a[192:195], v[192:195], v[80:83], a[192:195]
  ds_write_b128 v224, a[16:19] offset:14336
  v_mfma_f32_16x16x32_bf16 a[0:3], v[196:199], v[84:87], a[0:3]
  ds_write_b128 v224, a[48:51] offset:15360
  v_mfma_f32_16x16x32_bf16 a[32:35], v[196:199], v[88:91], a[32:35]
  ds_write_b128 v224, a[80:83] offset:16384
  v_mfma_f32_16x16x32_bf16 a[64:67], v[196:199], v[92:95], a[64:67]
  ds_write_b128 v224, a[112:115] offset:17408
  v_mfma_f32_16x16x32_bf16 a[96:99], v[196:199], v[96:99], a[96:99]
  ds_write_b128 v224, a[144:147] offset:18432
  v_mfma_f32_16x16x32_bf16 a[128:131], v[196:199], v[100:103], a[128:131]
  ds_write_b128 v224, a[176:179] offset:19456
  v_mfma_f32_16x16x32_bf16 a[160:163], v[196:199], v[104:107], a[160:163]
  ds_write_b128 v224, a[208:211] offset:20480
  v_mfma_f32_16x16x32_bf16 a[192:195], v[196:199], v[108:111], a[192:195]
  s_waitcnt vmcnt(0) lgkmcnt(0)
  s_barrier
  buffer_store_dword v236, off, s[40:43], s67 sc1
  ds_read_b128 v[112:115], v226 offset:14336
  ds_read_b128 v[116:119], v226 offset:15360
  ds_read_b128 v[120:123], v226 offset:16384
  ds_read_b128 v[124:127], v226 offset:17408
  ds_read_b128 v[128:131], v226 offset:18432
  ds_read_b128 v[132:135], v226 offset:19456
  ds_read_b128 v[136:139], v226 offset:20480
  s_nop 3
  s_nop 0
  v_accvgpr_read_b32 v140, a0
  v_accvgpr_read_b32 v141, a1
  v_accvgpr_read_b32 v142, a2
  v_accvgpr_read_b32 v143, a3
  v_accvgpr_read_b32 v144, a32
  v_accvgpr_read_b32 v145, a33
  v_accvgpr_read_b32 v146, a34
  v_accvgpr_read_b32 v147, a35
  v_accvgpr_read_b32 v148, a64
  v_accvgpr_read_b32 v149, a65
  v_accvgpr_read_b32 v150, a66
  v_accvgpr_read_b32 v151, a67
  v_accvgpr_read_b32 v152, a96
  v_accvgpr_read_b32 v153, a97
  v_accvgpr_read_b32 v154, a98
  v_accvgpr_read_b32 v155, a99
  v_accvgpr_read_b32 v156, a128
  v_accvgpr_read_b32 v157, a129
  v_accvgpr_read_b32 v158, a130
  v_accvgpr_read_b32 v159, a131
  v_accvgpr_read_b32 v160, a160
  v_accvgpr_read_b32 v161, a161
  v_accvgpr_read_b32 v162, a162
  v_accvgpr_read_b32 v163, a163
  v_accvgpr_read_b32 v164, a192
  v_accvgpr_read_b32 v165, a193
  v_accvgpr_read_b32 v166, a194
  v_accvgpr_read_b32 v167, a195
  s_waitcnt lgkmcnt(0)
  s_nop 0
  v_pk_add_f32 v[112:113], v[112:113], v[140:141]
  v_pk_add_f32 v[114:115], v[114:115], v[142:143]
  v_pk_add_f32 v[116:117], v[116:117], v[144:145]
  v_pk_add_f32 v[118:119], v[118:119], v[146:147]
  v_pk_add_f32 v[120:121], v[120:121], v[148:149]
  v_pk_add_f32 v[122:123], v[122:123], v[150:151]
  v_pk_add_f32 v[124:125], v[124:125], v[152:153]
  v_pk_add_f32 v[126:127], v[126:127], v[154:155]
  v_pk_add_f32 v[128:129], v[128:129], v[156:157]
  v_pk_add_f32 v[130:131], v[130:131], v[158:159]
  v_pk_add_f32 v[132:133], v[132:133], v[160:161]
  v_pk_add_f32 v[134:135], v[134:135], v[162:163]
  v_pk_add_f32 v[136:137], v[136:137], v[164:165]
  v_pk_add_f32 v[138:139], v[138:139], v[166:167]
  s_branch FP_GO
FP_SPIN:
  s_sleep 1
FP_GO:
  s_sub_u32 s52, s52, 1
  s_cbranch_scc1 FP_OK
  buffer_load_dwordx4 v[200:203], off, s[40:43], s91 sc1
  s_waitcnt vmcnt(0)
  s_nop 0
  v_min3_u32 v200, v200, v201, v202
  v_min_u32_e32 v200, v200, v203
  s_nop 0
  v_readfirstlane_b32 s66, v200
  s_nop 1
  s_cmp_lg_u32 s66, 0
  s_cbranch_scc0 FP_SPIN
FP_OK:
  s_add_u32 s54, s51, 0
  s_nop 0
  buffer_load_dwordx4 v[0:3], v234, s[40:43], s54 offen offset:0 sc1
  s_add_u32 s54, s51, 0x1000
  buffer_load_dwordx4 v[4:7], v234, s[40:43], s54 offen offset:0 sc1
  s_add_u32 s54, s51, 0x2000
  buffer_load_dwordx4 v[8:11], v234, s[40:43], s54 offen offset:0 sc1
  s_add_u32 s54, s51, 0
  s_nop 0
  buffer_load_dwordx4 v[12:15], v234, s[40:43], s54 offen offset:1024 sc1
  s_add_u32 s54, s51, 0x1000
  buffer_load_dwordx4 v[16:19], v234, s[40:43], s54 offen offset:1024 sc1
  s_add_u32 s54, s51, 0x2000
  buffer_load_dwordx4 v[20:23], v234, s[40:43], s54 offen offset:1024 sc1
  s_add_u32 s54, s51, 0
  s_nop 0
  buffer_load_dwordx4 v[24:27], v234, s[40:43], s54 offen offset:2048 sc1
  s_add_u32 s54, s51, 0x1000
  buffer_load_dwordx4 v[28:31], v234, s[40:43], s54 offen offset:2048 sc1
  s_add_u32 s54, s51, 0x2000
  buffer_load_dwordx4 v[32:35], v234, s[40:43], s54 offen offset:2048 sc1
  s_add_u32 s54, s51, 0
  s_nop 0
  buffer_load_dwordx4 v[36:39], v234, s[40:43], s54 offen offset:3072 sc1
  s_add_u32 s54, s51, 0x1000
  buffer_load_dwordx4 v[40:43], v234, s[40:43], s54 offen offset:3072 sc1
  s_add_u32 s54, s51, 0x2000
  buffer_load_dwordx4 v[44:47], v234, s[40:43], s54 offen offset:3072 sc1
  s_waitcnt vmcnt(9)
  v_lshlrev_b32_e32 v64, 16, v0
  v_and_b32_e32 v65, 0xffff0000, v0
  v_lshlrev_b32_e64 v66, 16, v1
  v_and_b32_e32 v67, 0xffff0000, v1
  v_pk_add_f32 v[112:113], v[112:113], v[64:65]
  v_pk_add_f32 v[114:115], v[114:115], v[66:67]
  v_lshlrev_b32_e64 v68, 16, v4
  v_and_b32_e32 v69, 0xffff0000, v4
  v_lshlrev_b32_e64 v70, 16, v5
  v_and_b32_e32 v71, 0xffff0000, v5
  v_pk_add_f32 v[112:113], v[112:113], v[68:69]
  v_pk_add_f32 v[114:115], v[114:115], v[70:71]
  v_lshlrev_b32_e64 v72, 16, v8
  v_and_b32_e32 v73, 0xffff0000, v8
  v_lshlrev_b32_e64 v74, 16, v9
  v_and_b32_e32 v75, 0xffff0000, v9
  v_pk_add_f32 v[112:113], v[112:113], v[72:73]
  v_pk_add_f32 v[114:115], v[114:115], v[74:75]
  v_cvt_pk_bf16_f32 v140, v112, v113
  v_cvt_pk_bf16_f32 v141, v114, v115
  buffer_store_dwordx2 v[140:141], v228, s[20:23], s62 offen offset:0
  s_add_u32 s62, s62, 0x4000
  v_lshlrev_b32_e64 v64, 16, v2
  v_and_b32_e32 v65, 0xffff0000, v2
  v_lshlrev_b32_e64 v66, 16, v3
  v_and_b32_e32 v67, 0xffff0000, v3
  v_pk_add_f32 v[116:117], v[116:117], v[64:65]
  v_pk_add_f32 v[118:119], v[118:119], v[66:67]
  v_lshlrev_b32_e64 v68, 16, v6
  v_and_b32_e32 v69, 0xffff0000, v6
  v_lshlrev_b32_e64 v70, 16, v7
  v_and_b32_e32 v71, 0xffff0000, v7
  v_pk_add_f32 v[116:117], v[116:117], v[68:69]
  v_pk_add_f32 v[118:119], v[118:119], v[70:71]
  v_lshlrev_b32_e64 v72, 16, v10
  v_and_b32_e32 v73, 0xffff0000, v10
  v_lshlrev_b32_e64 v74, 16, v11
  v_and_b32_e32 v75, 0xffff0000, v11
  v_pk_add_f32 v[116:117], v[116:117], v[72:73]
  v_pk_add_f32 v[118:119], v[118:119], v[74:75]
  v_cvt_pk_bf16_f32 v142, v116, v117
  v_cvt_pk_bf16_f32 v143, v118, v119
  buffer_store_dwordx2 v[142:143], v228, s[20:23], s62 offen offset:0
  s_add_u32 s62, s62, 0x4000
  s_waitcnt vmcnt(8)
  v_lshlrev_b32_e32 v64, 16, v12
  v_and_b32_e32 v65, 0xffff0000, v12
  v_lshlrev_b32_e64 v66, 16, v13
  v_and_b32_e32 v67, 0xffff0000, v13
  v_pk_add_f32 v[120:121], v[120:121], v[64:65]
  v_pk_add_f32 v[122:123], v[122:123], v[66:67]
  v_lshlrev_b32_e64 v68, 16, v16
  v_and_b32_e32 v69, 0xffff0000, v16
  v_lshlrev_b32_e64 v70, 16, v17
  v_and_b32_e32 v71, 0xffff0000, v17
  v_pk_add_f32 v[120:121], v[120:121], v[68:69]
  v_pk_add_f32 v[122:123], v[122:123], v[70:71]
  v_lshlrev_b32_e64 v72, 16, v20
  v_and_b32_e32 v73, 0xffff0000, v20
  v_lshlrev_b32_e64 v74, 16, v21
  v_and_b32_e32 v75, 0xffff0000, v21
  v_pk_add_f32 v[120:121], v[120:121], v[72:73]
  v_pk_add_f32 v[122:123], v[122:123], v[74:75]
  v_cvt_pk_bf16_f32 v144, v120, v121
  v_cvt_pk_bf16_f32 v145, v122, v123
  buffer_store_dwordx2 v[144:145], v228, s[20:23], s62 offen offset:0
  s_add_u32 s62, s62, 0x4000
  v_lshlrev_b32_e64 v64, 16, v14
  v_and_b32_e32 v65, 0xffff0000, v14
  v_lshlrev_b32_e64 v66, 16, v15
  v_and_b32_e32 v67, 0xffff0000, v15
  v_pk_add_f32 v[124:125], v[124:125], v[64:65]
  v_pk_add_f32 v[126:127], v[126:127], v[66:67]
  v_lshlrev_b32_e64 v68, 16, v18
  v_and_b32_e32 v69, 0xffff0000, v18
  v_lshlrev_b32_e64 v70, 16, v19
  v_and_b32_e32 v71, 0xffff0000, v19
  v_pk_add_f32 v[124:125], v[124:125], v[68:69]
  v_pk_add_f32 v[126:127], v[126:127], v[70:71]
  v_lshlrev_b32_e64 v72, 16, v22
  v_and_b32_e32 v73, 0xffff0000, v22
  v_lshlrev_b32_e64 v74, 16, v23
  v_and_b32_e32 v75, 0xffff0000, v23
  v_pk_add_f32 v[124:125], v[124:125], v[72:73]
  v_pk_add_f32 v[126:127], v[126:127], v[74:75]
  v_cvt_pk_bf16_f32 v146, v124, v125
  v_cvt_pk_bf16_f32 v147, v126, v127
  buffer_store_dwordx2 v[146:147], v228, s[20:23], s62 offen offset:0
  s_add_u32 s62, s62, 0x4000
  s_waitcnt vmcnt(7)
  v_lshlrev_b32_e32 v64, 16, v24
  v_and_b32_e32 v65, 0xffff0000, v24
  v_lshlrev_b32_e64 v66, 16, v25
  v_and_b32_e32 v67, 0xffff0000, v25
  v_pk_add_f32 v[128:129], v[128:129], v[64:65]
  v_pk_add_f32 v[130:131], v[130:131], v[66:67]
  v_lshlrev_b32_e64 v68, 16, v28
  v_and_b32_e32 v69, 0xffff0000, v28
  v_lshlrev_b32_e64 v70, 16, v29
  v_and_b32_e32 v71, 0xffff0000, v29
  v_pk_add_f32 v[128:129], v[128:129], v[68:69]
  v_pk_add_f32 v[130:131], v[130:131], v[70:71]
  v_lshlrev_b32_e64 v72, 16, v32
  v_and_b32_e32 v73, 0xffff0000, v32
  v_lshlrev_b32_e64 v74, 16, v33
  v_and_b32_e32 v75, 0xffff0000, v33
  v_pk_add_f32 v[128:129], v[128:129], v[72:73]
  v_pk_add_f32 v[130:131], v[130:131], v[74:75]
  v_cvt_pk_bf16_f32 v148, v128, v129
  v_cvt_pk_bf16_f32 v149, v130, v131
  buffer_store_dwordx2 v[148:149], v228, s[20:23], s62 offen offset:0
  s_add_u32 s62, s62, 0x4000
  v_lshlrev_b32_e64 v64, 16, v26
  v_and_b32_e32 v65, 0xffff0000, v26
  v_lshlrev_b32_e64 v66, 16, v27
  v_and_b32_e32 v67, 0xffff0000, v27
  v_pk_add_f32 v[132:133], v[132:133], v[64:65]
  v_pk_add_f32 v[134:135], v[134:135], v[66:67]
  v_lshlrev_b32_e64 v68, 16, v30
  v_and_b32_e32 v69, 0xffff0000, v30
  v_lshlrev_b32_e64 v70, 16, v31
  v_and_b32_e32 v71, 0xffff0000, v31
  v_pk_add_f32 v[132:133], v[132:133], v[68:69]
  v_pk_add_f32 v[134:135], v[134:135], v[70:71]
  v_lshlrev_b32_e64 v72, 16, v34
  v_and_b32_e32 v73, 0xffff0000, v34
  v_lshlrev_b32_e64 v74, 16, v35
  v_and_b32_e32 v75, 0xffff0000, v35
  v_pk_add_f32 v[132:133], v[132:133], v[72:73]
  v_pk_add_f32 v[134:135], v[134:135], v[74:75]
  v_cvt_pk_bf16_f32 v150, v132, v133
  v_cvt_pk_bf16_f32 v151, v134, v135
  buffer_store_dwordx2 v[150:151], v228, s[20:23], s62 offen offset:0
  s_add_u32 s62, s62, 0x4000
  s_waitcnt vmcnt(6)
  v_lshlrev_b32_e32 v64, 16, v36
  v_and_b32_e32 v65, 0xffff0000, v36
  v_lshlrev_b32_e64 v66, 16, v37
  v_and_b32_e32 v67, 0xffff0000, v37
  v_pk_add_f32 v[136:137], v[136:137], v[64:65]
  v_pk_add_f32 v[138:139], v[138:139], v[66:67]
  v_lshlrev_b32_e64 v68, 16, v40
  v_and_b32_e32 v69, 0xffff0000, v40
  v_lshlrev_b32_e64 v70, 16, v41
  v_and_b32_e32 v71, 0xffff0000, v41
  v_pk_add_f32 v[136:137], v[136:137], v[68:69]
  v_pk_add_f32 v[138:139], v[138:139], v[70:71]
  v_lshlrev_b32_e64 v72, 16, v44
  v_and_b32_e32 v73, 0xffff0000, v44
  v_lshlrev_b32_e64 v74, 16, v45
  v_and_b32_e32 v75, 0xffff0000, v45
  v_pk_add_f32 v[136:137], v[136:137], v[72:73]
  v_pk_add_f32 v[138:139], v[138:139], v[74:75]
  v_cvt_pk_bf16_f32 v152, v136, v137
  v_cvt_pk_bf16_f32 v153, v138, v139
  buffer_store_dwordx2 v[152:153], v228, s[20:23], s62 offen offset:0
  s_add_u32 s62, s62, 0x4000
  s_endpgm
RAREA_0:
  s_getpc_b64 s[92:93]
RPCA_0:
  s_sub_u32 s92, s92, RPCA_0-RETA_0
  s_subb_u32 s93, s93, 0
  s_branch RARE_0
RAREB_0:
  s_getpc_b64 s[92:93]
RPCB_0:
  s_nop 0
  s_sub_u32 s92, s92, RPCB_0-RETB_0
  s_subb_u32 s93, s93, 0
  s_branch RARE_0
RARE_0:
  s_nop 7
  s_nop 0
  v_max3_f32 v248, v172, v173, v174
  v_max3_f32 v248, v248, v175, v176
  v_max3_f32 v248, v248, v177, v178
  v_max_f32_e64 v248, v248, v179
  v_mov_b32_e32 v249, v248
  s_nop 1
  v_permlane16_swap_b32 v248, v249
  v_max_f32_e32 v248, v248, v249
  v_mov_b32_e32 v249, v248
  s_nop 1
  v_permlane32_swap_b32 v248, v249
  v_max_f32_e32 v248, v248, v249
  v_max_f32_e64 v248, 0, v248
  v_exp_f32_e64 v250, -v248
  v_sub_f32_e64 v144, v144, v248
  v_sub_f32_e64 v145, v145, v248
  v_sub_f32_e64 v146, v146, v248
  v_sub_f32_e64 v147, v147, v248
  v_mul_f32_e64 v240, v240, v250
  v_accvgpr_read_b32 v251, a0
  v_accvgpr_read_b32 v252, a1
  v_mul_f32_e64 v251, v251, v250
  v_mul_f32_e64 v252, v252, v250
  v_accvgpr_write_b32 a0, v251
  v_accvgpr_write_b32 a1, v252
  v_accvgpr_read_b32 v251, a2
  v_accvgpr_read_b32 v252, a3
  v_mul_f32_e64 v251, v251, v250
  v_mul_f32_e64 v252, v252, v250
  v_accvgpr_write_b32 a2, v251
  v_accvgpr_write_b32 a3, v252
  v_accvgpr_read_b32 v251, a4
  v_accvgpr_read_b32 v252, a5
  v_mul_f32_e64 v251, v251, v250
  v_mul_f32_e64 v252, v252, v250
  v_accvgpr_write_b32 a4, v251
  v_accvgpr_write_b32 a5, v252
  v_accvgpr_read_b32 v251, a6
  v_accvgpr_read_b32 v252, a7
  v_mul_f32_e64 v251, v251, v250
  v_mul_f32_e64 v252, v252, v250
  v_accvgpr_write_b32 a6, v251
  v_accvgpr_write_b32 a7, v252
  v_accvgpr_read_b32 v251, a8
  v_accvgpr_read_b32 v252, a9
  v_mul_f32_e64 v251, v251, v250
  v_mul_f32_e64 v252, v252, v250
  v_accvgpr_write_b32 a8, v251
  v_accvgpr_write_b32 a9, v252
  v_accvgpr_read_b32 v251, a10
  v_accvgpr_read_b32 v252, a11
  v_mul_f32_e64 v251, v251, v250
  v_mul_f32_e64 v252, v252, v250
  v_accvgpr_write_b32 a10, v251
  v_accvgpr_write_b32 a11, v252
  v_accvgpr_read_b32 v251, a12
  v_accvgpr_read_b32 v252, a13
  v_mul_f32_e64 v251, v251, v250
  v_mul_f32_e64 v252, v252, v250
  v_accvgpr_write_b32 a12, v251
  v_accvgpr_write_b32 a13, v252
  v_accvgpr_read_b32 v251, a14
  v_accvgpr_read_b32 v252, a15
  v_mul_f32_e64 v251, v251, v250
  v_mul_f32_e64 v252, v252, v250
  v_accvgpr_write_b32 a14, v251
  v_accvgpr_write_b32 a15, v252
  v_accvgpr_read_b32 v251, a16
  v_accvgpr_read_b32 v252, a17
  v_mul_f32_e64 v251, v251, v250
  v_mul_f32_e64 v252, v252, v250
  v_accvgpr_write_b32 a16, v251
  v_accvgpr_write_b32 a17, v252
  v_accvgpr_read_b32 v251, a18
  v_accvgpr_read_b32 v252, a19
  v_mul_f32_e64 v251, v251, v250
  v_mul_f32_e64 v252, v252, v250
  v_accvgpr_write_b32 a18, v251
  v_accvgpr_write_b32 a19, v252
  v_accvgpr_read_b32 v251, a20
  v_accvgpr_read_b32 v252, a21
  v_mul_f32_e64 v251, v251, v250
  v_mul_f32_e64 v252, v252, v250
  v_accvgpr_write_b32 a20, v251
  v_accvgpr_write_b32 a21, v252
  v_accvgpr_read_b32 v251, a22
  v_accvgpr_read_b32 v252, a23
  v_mul_f32_e64 v251, v251, v250
  v_mul_f32_e64 v252, v252, v250
  v_accvgpr_write_b32 a22, v251
  v_accvgpr_write_b32 a23, v252
  v_accvgpr_read_b32 v251, a24
  v_accvgpr_read_b32 v252, a25
  v_mul_f32_e64 v251, v251, v250
  v_mul_f32_e64 v252, v252, v250
  v_accvgpr_write_b32 a24, v251
  v_accvgpr_write_b32 a25, v252
  v_accvgpr_read_b32 v251, a26
  v_accvgpr_read_b32 v252, a27
  v_mul_f32_e64 v251, v251, v250
  v_mul_f32_e64 v252, v252, v250
  v_accvgpr_write_b32 a26, v251
  v_accvgpr_write_b32 a27, v252
  v_accvgpr_read_b32 v251, a28
  v_accvgpr_read_b32 v252, a29
  v_mul_f32_e64 v251, v251, v250
  v_mul_f32_e64 v252, v252, v250
  v_accvgpr_write_b32 a28, v251
  v_accvgpr_write_b32 a29, v252
  v_accvgpr_read_b32 v251, a30
  v_accvgpr_read_b32 v252, a31
  v_mul_f32_e64 v251, v251, v250
  v_mul_f32_e64 v252, v252, v250
  v_accvgpr_write_b32 a30, v251
  v_accvgpr_write_b32 a31, v252
  v_sub_f32_e64 v172, v172, v248
  v_sub_f32_e64 v173, v173, v248
  v_exp_f32_e64 v251, v172
  v_exp_f32_e32 v252, v173
  s_nop 0
  v_cvt_pk_bf16_f32 v204, v251, v252
  v_sub_f32_e64 v174, v174, v248
  v_sub_f32_e64 v175, v175, v248
  v_exp_f32_e64 v251, v174
  v_exp_f32_e32 v252, v175
  s_nop 0
  v_cvt_pk_bf16_f32 v205, v251, v252
  v_sub_f32_e64 v176, v176, v248
  v_sub_f32_e64 v177, v177, v248
  v_exp_f32_e64 v251, v176
  v_exp_f32_e32 v252, v177
  s_nop 0
  v_cvt_pk_bf16_f32 v206, v251, v252
  v_sub_f32_e64 v178, v178, v248
  v_sub_f32_e64 v179, v179, v248
  v_exp_f32_e64 v251, v178
  v_exp_f32_e32 v252, v179
  s_nop 0
  v_cvt_pk_bf16_f32 v207, v251, v252
  s_nop 1
  s_nop 0
  v_mfma_f32_16x16x32_bf16 v[216:219], v[236:239], v[204:207], 0
  s_nop 7
  s_nop 1
  s_setpc_b64 s[92:93]
RAREA_1:
  s_getpc_b64 s[92:93]
RPCA_1:
  s_sub_u32 s92, s92, RPCA_1-RETA_1
  s_subb_u32 s93, s93, 0
  s_branch RARE_1
RAREB_1:
  s_getpc_b64 s[92:93]
RPCB_1:
  s_nop 0
  s_sub_u32 s92, s92, RPCB_1-RETB_1
  s_subb_u32 s93, s93, 0
  s_branch RARE_1
RARE_1:
  s_nop 7
  s_nop 0
  v_max3_f32 v248, v180, v181, v182
  v_max3_f32 v248, v248, v183, v184
  v_max3_f32 v248, v248, v185, v186
  v_max_f32_e64 v248, v248, v187
  v_mov_b32_e32 v249, v248
  s_nop 1
  v_permlane16_swap_b32 v248, v249
  v_max_f32_e32 v248, v248, v249
  v_mov_b32_e32 v249, v248
  s_nop 1
  v_permlane32_swap_b32 v248, v249
  v_max_f32_e32 v248, v248, v249
  v_max_f32_e64 v248, 0, v248
  v_exp_f32_e64 v250, -v248
  v_sub_f32_e64 v148, v148, v248
  v_sub_f32_e64 v149, v149, v248
  v_sub_f32_e64 v150, v150, v248
  v_sub_f32_e64 v151, v151, v248
  v_mul_f32_e64 v241, v241, v250
  v_accvgpr_read_b32 v251, a32
  v_accvgpr_read_b32 v252, a33
  v_mul_f32_e64 v251, v251, v250
  v_mul_f32_e64 v252, v252, v250
  v_accvgpr_write_b32 a32, v251
  v_accvgpr_write_b32 a33, v252
  v_accvgpr_read_b32 v251, a34
  v_accvgpr_read_b32 v252, a35
  v_mul_f32_e64 v251, v251, v250
  v_mul_f32_e64 v252, v252, v250
  v_accvgpr_write_b32 a34, v251
  v_accvgpr_write_b32 a35, v252
  v_accvgpr_read_b32 v251, a36
  v_accvgpr_read_b32 v252, a37
  v_mul_f32_e64 v251, v251, v250
  v_mul_f32_e64 v252, v252, v250
  v_accvgpr_write_b32 a36, v251
  v_accvgpr_write_b32 a37, v252
  v_accvgpr_read_b32 v251, a38
  v_accvgpr_read_b32 v252, a39
  v_mul_f32_e64 v251, v251, v250
  v_mul_f32_e64 v252, v252, v250
  v_accvgpr_write_b32 a38, v251
  v_accvgpr_write_b32 a39, v252
  v_accvgpr_read_b32 v251, a40
  v_accvgpr_read_b32 v252, a41
  v_mul_f32_e64 v251, v251, v250
  v_mul_f32_e64 v252, v252, v250
  v_accvgpr_write_b32 a40, v251
  v_accvgpr_write_b32 a41, v252
  v_accvgpr_read_b32 v251, a42
  v_accvgpr_read_b32 v252, a43
  v_mul_f32_e64 v251, v251, v250
  v_mul_f32_e64 v252, v252, v250
  v_accvgpr_write_b32 a42, v251
  v_accvgpr_write_b32 a43, v252
  v_accvgpr_read_b32 v251, a44
  v_accvgpr_read_b32 v252, a45
  v_mul_f32_e64 v251, v251, v250
  v_mul_f32_e64 v252, v252, v250
  v_accvgpr_write_b32 a44, v251
  v_accvgpr_write_b32 a45, v252
  v_accvgpr_read_b32 v251, a46
  v_accvgpr_read_b32 v252, a47
  v_mul_f32_e64 v251, v251, v250
  v_mul_f32_e64 v252, v252, v250
  v_accvgpr_write_b32 a46, v251
  v_accvgpr_write_b32 a47, v252
  v_accvgpr_read_b32 v251, a48
  v_accvgpr_read_b32 v252, a49
  v_mul_f32_e64 v251, v251, v250
  v_mul_f32_e64 v252, v252, v250
  v_accvgpr_write_b32 a48, v251
  v_accvgpr_write_b32 a49, v252
  v_accvgpr_read_b32 v251, a50
  v_accvgpr_read_b32 v252, a51
  v_mul_f32_e64 v251, v251, v250
  v_mul_f32_e64 v252, v252, v250
  v_accvgpr_write_b32 a50, v251
  v_accvgpr_write_b32 a51, v252
  v_accvgpr_read_b32 v251, a52
  v_accvgpr_read_b32 v252, a53
  v_mul_f32_e64 v251, v251, v250
  v_mul_f32_e64 v252, v252, v250
  v_accvgpr_write_b32 a52, v251
  v_accvgpr_write_b32 a53, v252
  v_accvgpr_read_b32 v251, a54
  v_accvgpr_read_b32 v252, a55
  v_mul_f32_e64 v251, v251, v250
  v_mul_f32_e64 v252, v252, v250
  v_accvgpr_write_b32 a54, v251
  v_accvgpr_write_b32 a55, v252
  v_accvgpr_read_b32 v251, a56
  v_accvgpr_read_b32 v252, a57
  v_mul_f32_e64 v251, v251, v250
  v_mul_f32_e64 v252, v252, v250
  v_accvgpr_write_b32 a56, v251
  v_accvgpr_write_b32 a57, v252
  v_accvgpr_read_b32 v251, a58
  v_accvgpr_read_b32 v252, a59
  v_mul_f32_e64 v251, v251, v250
  v_mul_f32_e64 v252, v252, v250
  v_accvgpr_write_b32 a58, v251
  v_accvgpr_write_b32 a59, v252
  v_accvgpr_read_b32 v251, a60
  v_accvgpr_read_b32 v252, a61
  v_mul_f32_e64 v251, v251, v250
  v_mul_f32_e64 v252, v252, v250
  v_accvgpr_write_b32 a60, v251
  v_accvgpr_write_b32 a61, v252
  v_accvgpr_read_b32 v251, a62
  v_accvgpr_read_b32 v252, a63
  v_mul_f32_e64 v251, v251, v250
  v_mul_f32_e64 v252, v252, v250
  v_accvgpr_write_b32 a62, v251
  v_accvgpr_write_b32 a63, v252
  v_sub_f32_e64 v180, v180, v248
  v_sub_f32_e64 v181, v181, v248
  v_exp_f32_e64 v251, v180
  v_exp_f32_e32 v252, v181
  s_nop 0
  v_cvt_pk_bf16_f32 v208, v251, v252
  v_sub_f32_e64 v182, v182, v248
  v_sub_f32_e64 v183, v183, v248
  v_exp_f32_e64 v251, v182
  v_exp_f32_e32 v252, v183
  s_nop 0
  v_cvt_pk_bf16_f32 v209, v251, v252
  v_sub_f32_e64 v184, v184, v248
  v_sub_f32_e64 v185, v185, v248
  v_exp_f32_e64 v251, v184
  v_exp_f32_e32 v252, v185
  s_nop 0
  v_cvt_pk_bf16_f32 v210, v251, v252
  v_sub_f32_e64 v186, v186, v248
  v_sub_f32_e64 v187, v187, v248
  v_exp_f32_e64 v251, v186
  v_exp_f32_e32 v252, v187
  s_nop 0
  v_cvt_pk_bf16_f32 v211, v251, v252
  s_nop 1
  s_nop 0
  v_mfma_f32_16x16x32_bf16 v[216:219], v[236:239], v[208:211], 0
  s_nop 7
  s_nop 1
  s_setpc_b64 s[92:93]
RAREA_2:
  s_getpc_b64 s[92:93]
RPCA_2:
  s_sub_u32 s92, s92, RPCA_2-RETA_2
  s_subb_u32 s93, s93, 0
  s_branch RARE_2
RAREB_2:
  s_getpc_b64 s[92:93]
RPCB_2:
  s_nop 0
  s_sub_u32 s92, s92, RPCB_2-RETB_2
  s_subb_u32 s93, s93, 0
  s_branch RARE_2
RARE_2:
  s_nop 7
  s_nop 0
  v_max3_f32 v248, v188, v189, v190
  v_max3_f32 v248, v248, v191, v192
  v_max3_f32 v248, v248, v193, v194
  v_max_f32_e64 v248, v248, v195
  v_mov_b32_e32 v249, v248
  s_nop 1
  v_permlane16_swap_b32 v248, v249
  v_max_f32_e32 v248, v248, v249
  v_mov_b32_e32 v249, v248
  s_nop 1
  v_permlane32_swap_b32 v248, v249
  v_max_f32_e32 v248, v248, v249
  v_max_f32_e64 v248, 0, v248
  v_exp_f32_e64 v250, -v248
  v_sub_f32_e64 v152, v152, v248
  v_sub_f32_e64 v153, v153, v248
  v_sub_f32_e64 v154, v154, v248
  v_sub_f32_e64 v155, v155, v248
  v_mul_f32_e64 v242, v242, v250
  v_accvgpr_read_b32 v251, a64
  v_accvgpr_read_b32 v252, a65
  v_mul_f32_e64 v251, v251, v250
  v_mul_f32_e64 v252, v252, v250
  v_accvgpr_write_b32 a64, v251
  v_accvgpr_write_b32 a65, v252
  v_accvgpr_read_b32 v251, a66
  v_accvgpr_read_b32 v252, a67
  v_mul_f32_e64 v251, v251, v250
  v_mul_f32_e64 v252, v252, v250
  v_accvgpr_write_b32 a66, v251
  v_accvgpr_write_b32 a67, v252
  v_accvgpr_read_b32 v251, a68
  v_accvgpr_read_b32 v252, a69
  v_mul_f32_e64 v251, v251, v250
  v_mul_f32_e64 v252, v252, v250
  v_accvgpr_write_b32 a68, v251
  v_accvgpr_write_b32 a69, v252
  v_accvgpr_read_b32 v251, a70
  v_accvgpr_read_b32 v252, a71
  v_mul_f32_e64 v251, v251, v250
  v_mul_f32_e64 v252, v252, v250
  v_accvgpr_write_b32 a70, v251
  v_accvgpr_write_b32 a71, v252
  v_accvgpr_read_b32 v251, a72
  v_accvgpr_read_b32 v252, a73
  v_mul_f32_e64 v251, v251, v250
  v_mul_f32_e64 v252, v252, v250
  v_accvgpr_write_b32 a72, v251
  v_accvgpr_write_b32 a73, v252
  v_accvgpr_read_b32 v251, a74
  v_accvgpr_read_b32 v252, a75
  v_mul_f32_e64 v251, v251, v250
  v_mul_f32_e64 v252, v252, v250
  v_accvgpr_write_b32 a74, v251
  v_accvgpr_write_b32 a75, v252
  v_accvgpr_read_b32 v251, a76
  v_accvgpr_read_b32 v252, a77
  v_mul_f32_e64 v251, v251, v250
  v_mul_f32_e64 v252, v252, v250
  v_accvgpr_write_b32 a76, v251
  v_accvgpr_write_b32 a77, v252
  v_accvgpr_read_b32 v251, a78
  v_accvgpr_read_b32 v252, a79
  v_mul_f32_e64 v251, v251, v250
  v_mul_f32_e64 v252, v252, v250
  v_accvgpr_write_b32 a78, v251
  v_accvgpr_write_b32 a79, v252
  v_accvgpr_read_b32 v251, a80
  v_accvgpr_read_b32 v252, a81
  v_mul_f32_e64 v251, v251, v250
  v_mul_f32_e64 v252, v252, v250
  v_accvgpr_write_b32 a80, v251
  v_accvgpr_write_b32 a81, v252
  v_accvgpr_read_b32 v251, a82
  v_accvgpr_read_b32 v252, a83
  v_mul_f32_e64 v251, v251, v250
  v_mul_f32_e64 v252, v252, v250
  v_accvgpr_write_b32 a82, v251
  v_accvgpr_write_b32 a83, v252
  v_accvgpr_read_b32 v251, a84
  v_accvgpr_read_b32 v252, a85
  v_mul_f32_e64 v251, v251, v250
  v_mul_f32_e64 v252, v252, v250
  v_accvgpr_write_b32 a84, v251
  v_accvgpr_write_b32 a85, v252
  v_accvgpr_read_b32 v251, a86
  v_accvgpr_read_b32 v252, a87
  v_mul_f32_e64 v251, v251, v250
  v_mul_f32_e64 v252, v252, v250
  v_accvgpr_write_b32 a86, v251
  v_accvgpr_write_b32 a87, v252
  v_accvgpr_read_b32 v251, a88
  v_accvgpr_read_b32 v252, a89
  v_mul_f32_e64 v251, v251, v250
  v_mul_f32_e64 v252, v252, v250
  v_accvgpr_write_b32 a88, v251
  v_accvgpr_write_b32 a89, v252
  v_accvgpr_read_b32 v251, a90
  v_accvgpr_read_b32 v252, a91
  v_mul_f32_e64 v251, v251, v250
  v_mul_f32_e64 v252, v252, v250
  v_accvgpr_write_b32 a90, v251
  v_accvgpr_write_b32 a91, v252
  v_accvgpr_read_b32 v251, a92
  v_accvgpr_read_b32 v252, a93
  v_mul_f32_e64 v251, v251, v250
  v_mul_f32_e64 v252, v252, v250
  v_accvgpr_write_b32 a92, v251
  v_accvgpr_write_b32 a93, v252
  v_accvgpr_read_b32 v251, a94
  v_accvgpr_read_b32 v252, a95
  v_mul_f32_e64 v251, v251, v250
  v_mul_f32_e64 v252, v252, v250
  v_accvgpr_write_b32 a94, v251
  v_accvgpr_write_b32 a95, v252
  v_sub_f32_e64 v188, v188, v248
  v_sub_f32_e64 v189, v189, v248
  v_exp_f32_e64 v251, v188
  v_exp_f32_e32 v252, v189
  s_nop 0
  v_cvt_pk_bf16_f32 v204, v251, v252
  v_sub_f32_e64 v190, v190, v248
  v_sub_f32_e64 v191, v191, v248
  v_exp_f32_e64 v251, v190
  v_exp_f32_e32 v252, v191
  s_nop 0
  v_cvt_pk_bf16_f32 v205, v251, v252
  v_sub_f32_e64 v192, v192, v248
  v_sub_f32_e64 v193, v193, v248
  v_exp_f32_e64 v251, v192
  v_exp_f32_e32 v252, v193
  s_nop 0
  v_cvt_pk_bf16_f32 v206, v251, v252
  v_sub_f32_e64 v194, v194, v248
  v_sub_f32_e64 v195, v195, v248
  v_exp_f32_e64 v251, v194
  v_exp_f32_e32 v252, v195
  s_nop 0
  v_cvt_pk_bf16_f32 v207, v251, v252
  s_nop 1
  s_nop 0
  v_mfma_f32_16x16x32_bf16 v[216:219], v[236:239], v[204:207], 0
  s_nop 7
  s_nop 1
  s_setpc_b64 s[92:93]
RAREA_3:
  s_getpc_b64 s[92:93]
RPCA_3:
  s_sub_u32 s92, s92, RPCA_3-RETA_3
  s_subb_u32 s93, s93, 0
  s_branch RARE_3
RAREB_3:
  s_getpc_b64 s[92:93]
RPCB_3:
  s_nop 0
  s_sub_u32 s92, s92, RPCB_3-RETB_3
  s_subb_u32 s93, s93, 0
  s_branch RARE_3
RARE_3:
  s_nop 7
  s_nop 0
  v_max3_f32 v248, v172, v173, v174
  v_max3_f32 v248, v248, v175, v176
  v_max3_f32 v248, v248, v177, v178
  v_max_f32_e64 v248, v248, v179
  v_mov_b32_e32 v249, v248
  s_nop 1
  v_permlane16_swap_b32 v248, v249
  v_max_f32_e32 v248, v248, v249
  v_mov_b32_e32 v249, v248
  s_nop 1
  v_permlane32_swap_b32 v248, v249
  v_max_f32_e32 v248, v248, v249
  v_max_f32_e64 v248, 0, v248
  v_exp_f32_e64 v250, -v248
  v_sub_f32_e64 v156, v156, v248
  v_sub_f32_e64 v157, v157, v248
  v_sub_f32_e64 v158, v158, v248
  v_sub_f32_e64 v159, v159, v248
  v_mul_f32_e64 v243, v243, v250
  v_accvgpr_read_b32 v251, a96
  v_accvgpr_read_b32 v252, a97
  v_mul_f32_e64 v251, v251, v250
  v_mul_f32_e64 v252, v252, v250
  v_accvgpr_write_b32 a96, v251
  v_accvgpr_write_b32 a97, v252
  v_accvgpr_read_b32 v251, a98
  v_accvgpr_read_b32 v252, a99
  v_mul_f32_e64 v251, v251, v250
  v_mul_f32_e64 v252, v252, v250
  v_accvgpr_write_b32 a98, v251
  v_accvgpr_write_b32 a99, v252
  v_accvgpr_read_b32 v251, a100
  v_accvgpr_read_b32 v252, a101
  v_mul_f32_e64 v251, v251, v250
  v_mul_f32_e64 v252, v252, v250
  v_accvgpr_write_b32 a100, v251
  v_accvgpr_write_b32 a101, v252
  v_accvgpr_read_b32 v251, a102
  v_accvgpr_read_b32 v252, a103
  v_mul_f32_e64 v251, v251, v250
  v_mul_f32_e64 v252, v252, v250
  v_accvgpr_write_b32 a102, v251
  v_accvgpr_write_b32 a103, v252
  v_accvgpr_read_b32 v251, a104
  v_accvgpr_read_b32 v252, a105
  v_mul_f32_e64 v251, v251, v250
  v_mul_f32_e64 v252, v252, v250
  v_accvgpr_write_b32 a104, v251
  v_accvgpr_write_b32 a105, v252
  v_accvgpr_read_b32 v251, a106
  v_accvgpr_read_b32 v252, a107
  v_mul_f32_e64 v251, v251, v250
  v_mul_f32_e64 v252, v252, v250
  v_accvgpr_write_b32 a106, v251
  v_accvgpr_write_b32 a107, v252
  v_accvgpr_read_b32 v251, a108
  v_accvgpr_read_b32 v252, a109
  v_mul_f32_e64 v251, v251, v250
  v_mul_f32_e64 v252, v252, v250
  v_accvgpr_write_b32 a108, v251
  v_accvgpr_write_b32 a109, v252
  v_accvgpr_read_b32 v251, a110
  v_accvgpr_read_b32 v252, a111
  v_mul_f32_e64 v251, v251, v250
  v_mul_f32_e64 v252, v252, v250
  v_accvgpr_write_b32 a110, v251
  v_accvgpr_write_b32 a111, v252
  v_accvgpr_read_b32 v251, a112
  v_accvgpr_read_b32 v252, a113
  v_mul_f32_e64 v251, v251, v250
  v_mul_f32_e64 v252, v252, v250
  v_accvgpr_write_b32 a112, v251
  v_accvgpr_write_b32 a113, v252
  v_accvgpr_read_b32 v251, a114
  v_accvgpr_read_b32 v252, a115
  v_mul_f32_e64 v251, v251, v250
  v_mul_f32_e64 v252, v252, v250
  v_accvgpr_write_b32 a114, v251
  v_accvgpr_write_b32 a115, v252
  v_accvgpr_read_b32 v251, a116
  v_accvgpr_read_b32 v252, a117
  v_mul_f32_e64 v251, v251, v250
  v_mul_f32_e64 v252, v252, v250
  v_accvgpr_write_b32 a116, v251
  v_accvgpr_write_b32 a117, v252
  v_accvgpr_read_b32 v251, a118
  v_accvgpr_read_b32 v252, a119
  v_mul_f32_e64 v251, v251, v250
  v_mul_f32_e64 v252, v252, v250
  v_accvgpr_write_b32 a118, v251
  v_accvgpr_write_b32 a119, v252
  v_accvgpr_read_b32 v251, a120
  v_accvgpr_read_b32 v252, a121
  v_mul_f32_e64 v251, v251, v250
  v_mul_f32_e64 v252, v252, v250
  v_accvgpr_write_b32 a120, v251
  v_accvgpr_write_b32 a121, v252
  v_accvgpr_read_b32 v251, a122
  v_accvgpr_read_b32 v252, a123
  v_mul_f32_e64 v251, v251, v250
  v_mul_f32_e64 v252, v252, v250
  v_accvgpr_write_b32 a122, v251
  v_accvgpr_write_b32 a123, v252
  v_accvgpr_read_b32 v251, a124
  v_accvgpr_read_b32 v252, a125
  v_mul_f32_e64 v251, v251, v250
  v_mul_f32_e64 v252, v252, v250
  v_accvgpr_write_b32 a124, v251
  v_accvgpr_write_b32 a125, v252
  v_accvgpr_read_b32 v251, a126
  v_accvgpr_read_b32 v252, a127
  v_mul_f32_e64 v251, v251, v250
  v_mul_f32_e64 v252, v252, v250
  v_accvgpr_write_b32 a126, v251
  v_accvgpr_write_b32 a127, v252
  v_sub_f32_e64 v172, v172, v248
  v_sub_f32_e64 v173, v173, v248
  v_exp_f32_e64 v251, v172
  v_exp_f32_e32 v252, v173
  s_nop 0
  v_cvt_pk_bf16_f32 v208, v251, v252
  v_sub_f32_e64 v174, v174, v248
  v_sub_f32_e64 v175, v175, v248
  v_exp_f32_e64 v251, v174
  v_exp_f32_e32 v252, v175
  s_nop 0
  v_cvt_pk_bf16_f32 v209, v251, v252
  v_sub_f32_e64 v176, v176, v248
  v_sub_f32_e64 v177, v177, v248
  v_exp_f32_e64 v251, v176
  v_exp_f32_e32 v252, v177
  s_nop 0
  v_cvt_pk_bf16_f32 v210, v251, v252
  v_sub_f32_e64 v178, v178, v248
  v_sub_f32_e64 v179, v179, v248
  v_exp_f32_e64 v251, v178
  v_exp_f32_e32 v252, v179
  s_nop 0
  v_cvt_pk_bf16_f32 v211, v251, v252
  s_nop 1
  s_nop 0
  v_mfma_f32_16x16x32_bf16 v[216:219], v[236:239], v[208:211], 0
  s_nop 7
  s_nop 1
  s_setpc_b64 s[92:93]
RAREA_4:
  s_getpc_b64 s[92:93]
RPCA_4:
  s_sub_u32 s92, s92, RPCA_4-RETA_4
  s_subb_u32 s93, s93, 0
  s_branch RARE_4
RAREB_4:
  s_getpc_b64 s[92:93]
RPCB_4:
  s_nop 0
  s_sub_u32 s92, s92, RPCB_4-RETB_4
  s_subb_u32 s93, s93, 0
  s_branch RARE_4
RARE_4:
  s_nop 7
  s_nop 0
  v_max3_f32 v248, v180, v181, v182
  v_max3_f32 v248, v248, v183, v184
  v_max3_f32 v248, v248, v185, v186
  v_max_f32_e64 v248, v248, v187
  v_mov_b32_e32 v249, v248
  s_nop 1
  v_permlane16_swap_b32 v248, v249
  v_max_f32_e32 v248, v248, v249
  v_mov_b32_e32 v249, v248
  s_nop 1
  v_permlane32_swap_b32 v248, v249
  v_max_f32_e32 v248, v248, v249
  v_max_f32_e64 v248, 0, v248
  v_exp_f32_e64 v250, -v248
  v_sub_f32_e64 v160, v160, v248
  v_sub_f32_e64 v161, v161, v248
  v_sub_f32_e64 v162, v162, v248
  v_sub_f32_e64 v163, v163, v248
  v_mul_f32_e64 v244, v244, v250
  v_accvgpr_read_b32 v251, a128
  v_accvgpr_read_b32 v252, a129
  v_mul_f32_e64 v251, v251, v250
  v_mul_f32_e64 v252, v252, v250
  v_accvgpr_write_b32 a128, v251
  v_accvgpr_write_b32 a129, v252
  v_accvgpr_read_b32 v251, a130
  v_accvgpr_read_b32 v252, a131
  v_mul_f32_e64 v251, v251, v250
  v_mul_f32_e64 v252, v252, v250
  v_accvgpr_write_b32 a130, v251
  v_accvgpr_write_b32 a131, v252
  v_accvgpr_read_b32 v251, a132
  v_accvgpr_read_b32 v252, a133
  v_mul_f32_e64 v251, v251, v250
  v_mul_f32_e64 v252, v252, v250
  v_accvgpr_write_b32 a132, v251
  v_accvgpr_write_b32 a133, v252
  v_accvgpr_read_b32 v251, a134
  v_accvgpr_read_b32 v252, a135
  v_mul_f32_e64 v251, v251, v250
  v_mul_f32_e64 v252, v252, v250
  v_accvgpr_write_b32 a134, v251
  v_accvgpr_write_b32 a135, v252
  v_accvgpr_read_b32 v251, a136
  v_accvgpr_read_b32 v252, a137
  v_mul_f32_e64 v251, v251, v250
  v_mul_f32_e64 v252, v252, v250
  v_accvgpr_write_b32 a136, v251
  v_accvgpr_write_b32 a137, v252
  v_accvgpr_read_b32 v251, a138
  v_accvgpr_read_b32 v252, a139
  v_mul_f32_e64 v251, v251, v250
  v_mul_f32_e64 v252, v252, v250
  v_accvgpr_write_b32 a138, v251
  v_accvgpr_write_b32 a139, v252
  v_accvgpr_read_b32 v251, a140
  v_accvgpr_read_b32 v252, a141
  v_mul_f32_e64 v251, v251, v250
  v_mul_f32_e64 v252, v252, v250
  v_accvgpr_write_b32 a140, v251
  v_accvgpr_write_b32 a141, v252
  v_accvgpr_read_b32 v251, a142
  v_accvgpr_read_b32 v252, a143
  v_mul_f32_e64 v251, v251, v250
  v_mul_f32_e64 v252, v252, v250
  v_accvgpr_write_b32 a142, v251
  v_accvgpr_write_b32 a143, v252
  v_accvgpr_read_b32 v251, a144
  v_accvgpr_read_b32 v252, a145
  v_mul_f32_e64 v251, v251, v250
  v_mul_f32_e64 v252, v252, v250
  v_accvgpr_write_b32 a144, v251
  v_accvgpr_write_b32 a145, v252
  v_accvgpr_read_b32 v251, a146
  v_accvgpr_read_b32 v252, a147
  v_mul_f32_e64 v251, v251, v250
  v_mul_f32_e64 v252, v252, v250
  v_accvgpr_write_b32 a146, v251
  v_accvgpr_write_b32 a147, v252
  v_accvgpr_read_b32 v251, a148
  v_accvgpr_read_b32 v252, a149
  v_mul_f32_e64 v251, v251, v250
  v_mul_f32_e64 v252, v252, v250
  v_accvgpr_write_b32 a148, v251
  v_accvgpr_write_b32 a149, v252
  v_accvgpr_read_b32 v251, a150
  v_accvgpr_read_b32 v252, a151
  v_mul_f32_e64 v251, v251, v250
  v_mul_f32_e64 v252, v252, v250
  v_accvgpr_write_b32 a150, v251
  v_accvgpr_write_b32 a151, v252
  v_accvgpr_read_b32 v251, a152
  v_accvgpr_read_b32 v252, a153
  v_mul_f32_e64 v251, v251, v250
  v_mul_f32_e64 v252, v252, v250
  v_accvgpr_write_b32 a152, v251
  v_accvgpr_write_b32 a153, v252
  v_accvgpr_read_b32 v251, a154
  v_accvgpr_read_b32 v252, a155
  v_mul_f32_e64 v251, v251, v250
  v_mul_f32_e64 v252, v252, v250
  v_accvgpr_write_b32 a154, v251
  v_accvgpr_write_b32 a155, v252
  v_accvgpr_read_b32 v251, a156
  v_accvgpr_read_b32 v252, a157
  v_mul_f32_e64 v251, v251, v250
  v_mul_f32_e64 v252, v252, v250
  v_accvgpr_write_b32 a156, v251
  v_accvgpr_write_b32 a157, v252
  v_accvgpr_read_b32 v251, a158
  v_accvgpr_read_b32 v252, a159
  v_mul_f32_e64 v251, v251, v250
  v_mul_f32_e64 v252, v252, v250
  v_accvgpr_write_b32 a158, v251
  v_accvgpr_write_b32 a159, v252
  v_sub_f32_e64 v180, v180, v248
  v_sub_f32_e64 v181, v181, v248
  v_exp_f32_e64 v251, v180
  v_exp_f32_e32 v252, v181
  s_nop 0
  v_cvt_pk_bf16_f32 v204, v251, v252
  v_sub_f32_e64 v182, v182, v248
  v_sub_f32_e64 v183, v183, v248
  v_exp_f32_e64 v251, v182
  v_exp_f32_e32 v252, v183
  s_nop 0
  v_cvt_pk_bf16_f32 v205, v251, v252
  v_sub_f32_e64 v184, v184, v248
  v_sub_f32_e64 v185, v185, v248
  v_exp_f32_e64 v251, v184
  v_exp_f32_e32 v252, v185
  s_nop 0
  v_cvt_pk_bf16_f32 v206, v251, v252
  v_sub_f32_e64 v186, v186, v248
  v_sub_f32_e64 v187, v187, v248
  v_exp_f32_e64 v251, v186
  v_exp_f32_e32 v252, v187
  s_nop 0
  v_cvt_pk_bf16_f32 v207, v251, v252
  s_nop 1
  s_nop 0
  v_mfma_f32_16x16x32_bf16 v[216:219], v[236:239], v[204:207], 0
  s_nop 7
  s_nop 1
  s_setpc_b64 s[92:93]
RAREA_5:
  s_getpc_b64 s[92:93]
RPCA_5:
  s_sub_u32 s92, s92, RPCA_5-RETA_5
  s_subb_u32 s93, s93, 0
  s_branch RARE_5
RAREB_5:
  s_getpc_b64 s[92:93]
RPCB_5:
  s_nop 0
  s_sub_u32 s92, s92, RPCB_5-RETB_5
  s_subb_u32 s93, s93, 0
  s_branch RARE_5
RARE_5:
  s_nop 7
  s_nop 0
  v_max3_f32 v248, v188, v189, v190
  v_max3_f32 v248, v248, v191, v192
  v_max3_f32 v248, v248, v193, v194
  v_max_f32_e64 v248, v248, v195
  v_mov_b32_e32 v249, v248
  s_nop 1
  v_permlane16_swap_b32 v248, v249
  v_max_f32_e32 v248, v248, v249
  v_mov_b32_e32 v249, v248
  s_nop 1
  v_permlane32_swap_b32 v248, v249
  v_max_f32_e32 v248, v248, v249
  v_max_f32_e64 v248, 0, v248
  v_exp_f32_e64 v250, -v248
  v_sub_f32_e64 v164, v164, v248
  v_sub_f32_e64 v165, v165, v248
  v_sub_f32_e64 v166, v166, v248
  v_sub_f32_e64 v167, v167, v248
  v_mul_f32_e64 v245, v245, v250
  v_accvgpr_read_b32 v251, a160
  v_accvgpr_read_b32 v252, a161
  v_mul_f32_e64 v251, v251, v250
  v_mul_f32_e64 v252, v252, v250
  v_accvgpr_write_b32 a160, v251
  v_accvgpr_write_b32 a161, v252
  v_accvgpr_read_b32 v251, a162
  v_accvgpr_read_b32 v252, a163
  v_mul_f32_e64 v251, v251, v250
  v_mul_f32_e64 v252, v252, v250
  v_accvgpr_write_b32 a162, v251
  v_accvgpr_write_b32 a163, v252
  v_accvgpr_read_b32 v251, a164
  v_accvgpr_read_b32 v252, a165
  v_mul_f32_e64 v251, v251, v250
  v_mul_f32_e64 v252, v252, v250
  v_accvgpr_write_b32 a164, v251
  v_accvgpr_write_b32 a165, v252
  v_accvgpr_read_b32 v251, a166
  v_accvgpr_read_b32 v252, a167
  v_mul_f32_e64 v251, v251, v250
  v_mul_f32_e64 v252, v252, v250
  v_accvgpr_write_b32 a166, v251
  v_accvgpr_write_b32 a167, v252
  v_accvgpr_read_b32 v251, a168
  v_accvgpr_read_b32 v252, a169
  v_mul_f32_e64 v251, v251, v250
  v_mul_f32_e64 v252, v252, v250
  v_accvgpr_write_b32 a168, v251
  v_accvgpr_write_b32 a169, v252
  v_accvgpr_read_b32 v251, a170
  v_accvgpr_read_b32 v252, a171
  v_mul_f32_e64 v251, v251, v250
  v_mul_f32_e64 v252, v252, v250
  v_accvgpr_write_b32 a170, v251
  v_accvgpr_write_b32 a171, v252
  v_accvgpr_read_b32 v251, a172
  v_accvgpr_read_b32 v252, a173
  v_mul_f32_e64 v251, v251, v250
  v_mul_f32_e64 v252, v252, v250
  v_accvgpr_write_b32 a172, v251
  v_accvgpr_write_b32 a173, v252
  v_accvgpr_read_b32 v251, a174
  v_accvgpr_read_b32 v252, a175
  v_mul_f32_e64 v251, v251, v250
  v_mul_f32_e64 v252, v252, v250
  v_accvgpr_write_b32 a174, v251
  v_accvgpr_write_b32 a175, v252
  v_accvgpr_read_b32 v251, a176
  v_accvgpr_read_b32 v252, a177
  v_mul_f32_e64 v251, v251, v250
  v_mul_f32_e64 v252, v252, v250
  v_accvgpr_write_b32 a176, v251
  v_accvgpr_write_b32 a177, v252
  v_accvgpr_read_b32 v251, a178
  v_accvgpr_read_b32 v252, a179
  v_mul_f32_e64 v251, v251, v250
  v_mul_f32_e64 v252, v252, v250
  v_accvgpr_write_b32 a178, v251
  v_accvgpr_write_b32 a179, v252
  v_accvgpr_read_b32 v251, a180
  v_accvgpr_read_b32 v252, a181
  v_mul_f32_e64 v251, v251, v250
  v_mul_f32_e64 v252, v252, v250
  v_accvgpr_write_b32 a180, v251
  v_accvgpr_write_b32 a181, v252
  v_accvgpr_read_b32 v251, a182
  v_accvgpr_read_b32 v252, a183
  v_mul_f32_e64 v251, v251, v250
  v_mul_f32_e64 v252, v252, v250
  v_accvgpr_write_b32 a182, v251
  v_accvgpr_write_b32 a183, v252
  v_accvgpr_read_b32 v251, a184
  v_accvgpr_read_b32 v252, a185
  v_mul_f32_e64 v251, v251, v250
  v_mul_f32_e64 v252, v252, v250
  v_accvgpr_write_b32 a184, v251
  v_accvgpr_write_b32 a185, v252
  v_accvgpr_read_b32 v251, a186
  v_accvgpr_read_b32 v252, a187
  v_mul_f32_e64 v251, v251, v250
  v_mul_f32_e64 v252, v252, v250
  v_accvgpr_write_b32 a186, v251
  v_accvgpr_write_b32 a187, v252
  v_accvgpr_read_b32 v251, a188
  v_accvgpr_read_b32 v252, a189
  v_mul_f32_e64 v251, v251, v250
  v_mul_f32_e64 v252, v252, v250
  v_accvgpr_write_b32 a188, v251
  v_accvgpr_write_b32 a189, v252
  v_accvgpr_read_b32 v251, a190
  v_accvgpr_read_b32 v252, a191
  v_mul_f32_e64 v251, v251, v250
  v_mul_f32_e64 v252, v252, v250
  v_accvgpr_write_b32 a190, v251
  v_accvgpr_write_b32 a191, v252
  v_sub_f32_e64 v188, v188, v248
  v_sub_f32_e64 v189, v189, v248
  v_exp_f32_e64 v251, v188
  v_exp_f32_e32 v252, v189
  s_nop 0
  v_cvt_pk_bf16_f32 v208, v251, v252
  v_sub_f32_e64 v190, v190, v248
  v_sub_f32_e64 v191, v191, v248
  v_exp_f32_e64 v251, v190
  v_exp_f32_e32 v252, v191
  s_nop 0
  v_cvt_pk_bf16_f32 v209, v251, v252
  v_sub_f32_e64 v192, v192, v248
  v_sub_f32_e64 v193, v193, v248
  v_exp_f32_e64 v251, v192
  v_exp_f32_e32 v252, v193
  s_nop 0
  v_cvt_pk_bf16_f32 v210, v251, v252
  v_sub_f32_e64 v194, v194, v248
  v_sub_f32_e64 v195, v195, v248
  v_exp_f32_e64 v251, v194
  v_exp_f32_e32 v252, v195
  s_nop 0
  v_cvt_pk_bf16_f32 v211, v251, v252
  s_nop 1
  s_nop 0
  v_mfma_f32_16x16x32_bf16 v[216:219], v[236:239], v[208:211], 0
  s_nop 7
  s_nop 1
  s_setpc_b64 s[92:93]
RAREA_6:
  s_getpc_b64 s[92:93]
RPCA_6:
  s_sub_u32 s92, s92, RPCA_6-RETA_6
  s_subb_u32 s93, s93, 0
  s_branch RARE_6
RAREB_6:
  s_getpc_b64 s[92:93]
RPCB_6:
  s_nop 0
  s_sub_u32 s92, s92, RPCB_6-RETB_6
  s_subb_u32 s93, s93, 0
  s_branch RARE_6
RAREF_6:
  s_getpc_b64 s[92:93]
RPCF_6:
  s_nop 0
  s_sub_u32 s92, s92, RPCF_6-RETF_6
  s_subb_u32 s93, s93, 0
  s_branch RARE_6
RARE_6:
  s_nop 7
  s_nop 0
  v_max3_f32 v248, v196, v197, v198
  v_max3_f32 v248, v248, v199, v200
  v_max3_f32 v248, v248, v201, v202
  v_max_f32_e64 v248, v248, v203
  v_mov_b32_e32 v249, v248
  s_nop 1
  v_permlane16_swap_b32 v248, v249
  v_max_f32_e32 v248, v248, v249
  v_mov_b32_e32 v249, v248
  s_nop 1
  v_permlane32_swap_b32 v248, v249
  v_max_f32_e32 v248, v248, v249
  v_max_f32_e64 v248, 0, v248
  v_exp_f32_e64 v250, -v248
  v_sub_f32_e64 v168, v168, v248
  v_sub_f32_e64 v169, v169, v248
  v_sub_f32_e64 v170, v170, v248
  v_sub_f32_e64 v171, v171, v248
  v_mul_f32_e64 v246, v246, v250
  v_accvgpr_read_b32 v251, a192
  v_accvgpr_read_b32 v252, a193
  v_mul_f32_e64 v251, v251, v250
  v_mul_f32_e64 v252, v252, v250
  v_accvgpr_write_b32 a192, v251
  v_accvgpr_write_b32 a193, v252
  v_accvgpr_read_b32 v251, a194
  v_accvgpr_read_b32 v252, a195
  v_mul_f32_e64 v251, v251, v250
  v_mul_f32_e64 v252, v252, v250
  v_accvgpr_write_b32 a194, v251
  v_accvgpr_write_b32 a195, v252
  v_accvgpr_read_b32 v251, a196
  v_accvgpr_read_b32 v252, a197
  v_mul_f32_e64 v251, v251, v250
  v_mul_f32_e64 v252, v252, v250
  v_accvgpr_write_b32 a196, v251
  v_accvgpr_write_b32 a197, v252
  v_accvgpr_read_b32 v251, a198
  v_accvgpr_read_b32 v252, a199
  v_mul_f32_e64 v251, v251, v250
  v_mul_f32_e64 v252, v252, v250
  v_accvgpr_write_b32 a198, v251
  v_accvgpr_write_b32 a199, v252
  v_accvgpr_read_b32 v251, a200
  v_accvgpr_read_b32 v252, a201
  v_mul_f32_e64 v251, v251, v250
  v_mul_f32_e64 v252, v252, v250
  v_accvgpr_write_b32 a200, v251
  v_accvgpr_write_b32 a201, v252
  v_accvgpr_read_b32 v251, a202
  v_accvgpr_read_b32 v252, a203
  v_mul_f32_e64 v251, v251, v250
  v_mul_f32_e64 v252, v252, v250
  v_accvgpr_write_b32 a202, v251
  v_accvgpr_write_b32 a203, v252
  v_accvgpr_read_b32 v251, a204
  v_accvgpr_read_b32 v252, a205
  v_mul_f32_e64 v251, v251, v250
  v_mul_f32_e64 v252, v252, v250
  v_accvgpr_write_b32 a204, v251
  v_accvgpr_write_b32 a205, v252
  v_accvgpr_read_b32 v251, a206
  v_accvgpr_read_b32 v252, a207
  v_mul_f32_e64 v251, v251, v250
  v_mul_f32_e64 v252, v252, v250
  v_accvgpr_write_b32 a206, v251
  v_accvgpr_write_b32 a207, v252
  v_accvgpr_read_b32 v251, a208
  v_accvgpr_read_b32 v252, a209
  v_mul_f32_e64 v251, v251, v250
  v_mul_f32_e64 v252, v252, v250
  v_accvgpr_write_b32 a208, v251
  v_accvgpr_write_b32 a209, v252
  v_accvgpr_read_b32 v251, a210
  v_accvgpr_read_b32 v252, a211
  v_mul_f32_e64 v251, v251, v250
  v_mul_f32_e64 v252, v252, v250
  v_accvgpr_write_b32 a210, v251
  v_accvgpr_write_b32 a211, v252
  v_accvgpr_read_b32 v251, a212
  v_accvgpr_read_b32 v252, a213
  v_mul_f32_e64 v251, v251, v250
  v_mul_f32_e64 v252, v252, v250
  v_accvgpr_write_b32 a212, v251
  v_accvgpr_write_b32 a213, v252
  v_accvgpr_read_b32 v251, a214
  v_accvgpr_read_b32 v252, a215
  v_mul_f32_e64 v251, v251, v250
  v_mul_f32_e64 v252, v252, v250
  v_accvgpr_write_b32 a214, v251
  v_accvgpr_write_b32 a215, v252
  v_accvgpr_read_b32 v251, a216
  v_accvgpr_read_b32 v252, a217
  v_mul_f32_e64 v251, v251, v250
  v_mul_f32_e64 v252, v252, v250
  v_accvgpr_write_b32 a216, v251
  v_accvgpr_write_b32 a217, v252
  v_accvgpr_read_b32 v251, a218
  v_accvgpr_read_b32 v252, a219
  v_mul_f32_e64 v251, v251, v250
  v_mul_f32_e64 v252, v252, v250
  v_accvgpr_write_b32 a218, v251
  v_accvgpr_write_b32 a219, v252
  v_accvgpr_read_b32 v251, a220
  v_accvgpr_read_b32 v252, a221
  v_mul_f32_e64 v251, v251, v250
  v_mul_f32_e64 v252, v252, v250
  v_accvgpr_write_b32 a220, v251
  v_accvgpr_write_b32 a221, v252
  v_accvgpr_read_b32 v251, a222
  v_accvgpr_read_b32 v252, a223
  v_mul_f32_e64 v251, v251, v250
  v_mul_f32_e64 v252, v252, v250
  v_accvgpr_write_b32 a222, v251
  v_accvgpr_write_b32 a223, v252
  v_sub_f32_e64 v196, v196, v248
  v_sub_f32_e64 v197, v197, v248
  v_exp_f32_e64 v251, v196
  v_exp_f32_e32 v252, v197
  s_nop 0
  v_cvt_pk_bf16_f32 v212, v251, v252
  v_sub_f32_e64 v198, v198, v248
  v_sub_f32_e64 v199, v199, v248
  v_exp_f32_e64 v251, v198
  v_exp_f32_e32 v252, v199
  s_nop 0
  v_cvt_pk_bf16_f32 v213, v251, v252
  v_sub_f32_e64 v200, v200, v248
  v_sub_f32_e64 v201, v201, v248
  v_exp_f32_e64 v251, v200
  v_exp_f32_e32 v252, v201
  s_nop 0
  v_cvt_pk_bf16_f32 v214, v251, v252
  v_sub_f32_e64 v202, v202, v248
  v_sub_f32_e64 v203, v203, v248
  v_exp_f32_e64 v251, v202
  v_exp_f32_e32 v252, v203
  s_nop 0
  v_cvt_pk_bf16_f32 v215, v251, v252
  s_nop 1
  s_nop 0
  v_mfma_f32_16x16x32_bf16 v[216:219], v[236:239], v[212:215], 0
  s_nop 7
  s_nop 1
  s_setpc_b64 s[92:93]
CNT_SPIN:
  s_sub_u32 s52, s52, 1
  s_cbranch_scc1 CNT_OK
  s_sleep 8
  buffer_load_dword v253, off, s[32:35], 0 sc1
  s_waitcnt vmcnt(0)
  s_branch CNT_CHK
FO_SPIN:
  s_sub_u32 s52, s52, 1
  s_cbranch_scc1 FO_OK
  s_sleep 2
  s_nop 0
  buffer_load_dwordx4 v[200:203], off, s[40:43], s90 sc1
  s_waitcnt vmcnt(0)
  s_branch FO_CHK
K1_END:
  s_endpgm
.section .rodata,"a"
.p2align 6
.amdhsa_kernel standalone__gqa_block_cached__near_ridge_kernel
  .amdhsa_next_free_vgpr 512
  .amdhsa_next_free_sgpr 102
  .amdhsa_accum_offset 256
  .amdhsa_group_segment_fixed_size 0
  .amdhsa_kernarg_size 64
  .amdhsa_user_sgpr_count 2
  .amdhsa_user_sgpr_kernarg_segment_ptr 1
  .amdhsa_system_sgpr_workgroup_id_x 1
.end_amdhsa_kernel
```
